```python
import torch

def _softmax(x, axis=-1):
    return torch.softmax(x, dim=axis)
def _gelu(x):
    return torch.nn.functional.gelu(x, approximate="tanh")
def _silu(x):
    return torch.nn.functional.silu(x)
def _sigmoid(x):
    return torch.sigmoid(x)
def _layernorm(x, axis=-1, eps=1e-5):
    m = x.mean(dim=axis, keepdim=True)
    v = x.var(dim=axis, keepdim=True, unbiased=False)
    return (x - m) / torch.sqrt(v + eps)
def _scatter_add(tgt, idx, src, axis=0):
    return tgt.clone().index_add_(axis, idx, src)
def _segment_sum(src, seg, n):
    out = torch.zeros((n,) + src.shape[1:], dtype=src.dtype)
    return out.index_add_(0, seg, src)
def _pad(x, pw):
    flat = tuple(v for pair in reversed(pw) for v in pair)
    return torch.nn.functional.pad(x, flat)

kernel_name = 'parallel_sum__softmax_full_mha__dense_activation_gelu__prompt'

def setup_inputs():

    _w = (lambda a: (lambda t: t.to(torch.bfloat16) if t.is_floating_point() else t)(torch.as_tensor(a)))
    def _A_setup():
        B, S, D = 1, 2048, 512
        return {
            "x": _w((lambda *s: torch.randn(*s, dtype=torch.bfloat16) * 0.05)(B, S, D)),
            "wqkv": _w((lambda *s: torch.randn(*s, dtype=torch.bfloat16) * 0.05)(D, 3 * D)),
            "wo": _w((lambda *s: torch.randn(*s, dtype=torch.bfloat16) * 0.05)(D, D)),
        }
    _A_in = _A_setup()

    def _B_setup():
        B, S, D, F = 1, 2048, 512, 1792
        return {
            "x": _w((lambda *s: torch.randn(*s, dtype=torch.bfloat16) * 0.05)(B, S, D)),
            "w1": _w((lambda *s: torch.randn(*s, dtype=torch.bfloat16) * 0.8)(D, F) * (D ** -0.5)),
            "b1": _w((lambda *s: torch.randn(*s, dtype=torch.bfloat16) * 12.8)(F) * 0.01),
            "w2": _w((lambda *s: torch.randn(*s, dtype=torch.bfloat16) * 0.8)(F, D) * (F ** -0.5)),
            "b2": _w((lambda *s: torch.randn(*s, dtype=torch.bfloat16) * 12.8)(D) * 0.01),
        }
    _B_in = _B_setup()

    return {
        "A_x": _A_in["x"],
        "A_wqkv": _A_in["wqkv"],
        "A_wo": _A_in["wo"],
        "B_x": _B_in["x"],
        "B_w1": _B_in["w1"],
        "B_b1": _B_in["b1"],
        "B_w2": _B_in["w2"],
        "B_b2": _B_in["b2"],
    }

def reference(A_x, A_wqkv, A_wo, B_x, B_w1, B_b1, B_w2, B_b2):
    def _A_ref(x, wqkv, wo):
        B, S, D = x.shape
        H = 32; Dh = D // H
        qkv = (lambda x, *d: x.permute(*d))((x @ wqkv).reshape(B, S, 3, H, Dh), 2, 0, 3, 1, 4)
        q, k, v = qkv[0], qkv[1], qkv[2]
        scale = Dh ** -0.5
        scores = torch.einsum("bhqd,bhkd->bhqk", q, k) * scale
        p = _softmax(scores, axis=-1)
        o = torch.einsum("bhqk,bhkd->bhqd", p, v)
        return (lambda x, *d: x.permute(*d))(o, 0, 2, 1, 3).reshape(B, S, D) @ wo

    def _B_ref(x, w1, b1, w2, b2):
        h = torch.einsum("bsd,df->bsf", x, w1) + b1
        h = _gelu(h)
        return torch.einsum("bsf,fd->bsd", h, w2) + b2

    x = A_x
    xn = _layernorm(x, axis=-1)
    return x + _A_ref(xn, A_wqkv, A_wo) + _B_ref(xn, B_w1, B_b1, B_w2, B_b2)
```

```asm
; @launch grid=(256,1,1) block=(512,1,1) lds=163840
.amdgcn_target "amdgcn-amd-amdhsa--gfx950"
.text
.globl parallel_sum__softmax_full_mha__dense_activation_gelu__prompt_kernel
.p2align 8
.type parallel_sum__softmax_full_mha__dense_activation_gelu__prompt_kernel,@function
parallel_sum__softmax_full_mha__dense_activation_gelu__prompt_kernel:
L_code_start:
    s_cmp_ge_u32 s2, 256
    s_cbranch_scc1 L_k1_end
    s_load_dwordx16 s[4:19], s[0:1], 0
    s_load_dwordx4 s[20:23], s[0:1], 64
    s_load_dwordx2 s[24:25], s[0:1], 80
    v_lshrrev_b32 v176, 6, v0
    v_and_b32 v1, 63, v0
    v_readfirstlane_b32 s26, v176
    s_getpc_b64 s[96:97]
L_pc_anchor:
    s_sub_u32 s96, s96, L_pc_anchor-L_code_start
    s_subb_u32 s97, s97, 0
    s_lshr_b32 s98, s2, 3
    s_lshl_b32 s98, s98, 11
    v_and_b32 v176, 15, v1
    v_lshlrev_b32 v176, 7, v176
    v_add_u32 v176, s98, v176
    v_min_u32 v176, L_code_end-L_code_start-4, v176
    global_load_dword v0, v176, s[96:97]
    s_setprio 3
    s_bfe_u32 s51, s2, 0x20003
    s_and_b32 s62, s2, 3
    s_lshl_b32 s62, s62, 2
    s_add_u32 s45, s51, s62
    s_lshr_b32 s50, s2, 5
    s_and_b32 s27, s26, 3
    s_lshr_b32 s44, s26, 2
    s_lshl_b32 s74, s45, 2
    s_add_u32 s74, s74, s27
    v_lshrrev_b32 v178, 4, v1
    v_and_b32 v179, 15, v1
    v_xor_b32 v184, v179, v178
    v_lshlrev_b32 v184, 4, v184
    v_lshl_add_u32 v184, v178, 10, v184
    s_and_b32 s46, s50, 3
    s_lshl_b32 s61, s46, 6
    v_xor_b32 v184, s61, v184
    s_xor_b32 s63, s44, 0
    s_lshl_b32 s60, s74, 15
    s_lshl_b32 s61, s63, 9
    s_add_u32 s60, s60, s61
    s_lshl_b32 s61, s50, 12
    s_add_u32 s86, s60, s61
    s_add_u32 s87, s86, 256
    s_lshl_b32 s60, s63, 16
    s_lshl_b32 s61, s27, 13
    s_add_u32 s60, s60, s61
    s_lshl_b32 s61, s50, 10
    s_add_u32 s60, s60, s61
    s_add_u32 s90, s60, 32768
    s_add_u32 s91, s60, 65536
    s_and_b32 s60, s2, 4
    s_add_u32 s46, s46, s60
    v_bfe_u32 v252, v1, 3, 1
    v_mul_u32_u24 v252, 0, v252
    v_and_b32 v180, 3, v1
    v_lshl_add_u32 v252, v180, 7, v252
    v_bfe_u32 v180, v1, 2, 1
    v_lshl_add_u32 v252, v180, 10, v252
    s_lshr_b32 s61, s2, 3
    s_lshl_b32 s61, s61, 3
    s_add_u32 s61, s61, s26
    s_mul_i32 s63, s61, 3072
    s_lshl_b32 s60, s60, 7
    s_add_u32 s63, s63, s60
    s_add_u32 s63, s63, 1024
    s_waitcnt lgkmcnt(0)
    s_mov_b32 s28, s4
    s_and_b32 s29, s5, 0xffff
    s_mov_b32 s30, 2097152
    s_mov_b32 s31, 0x20000
    s_xor_b32 m0, s90, 0
    s_xor_b32 s60, s86, 0
    buffer_load_dwordx4 v184, s[28:31], s60 offen lds
    s_xor_b32 m0, s91, 0
    s_xor_b32 s60, s87, 0
    buffer_load_dwordx4 v184, s[28:31], s60 offen lds
    s_mov_b32 s92, s6
    s_and_b32 s93, s7, 0xffff
    s_mov_b32 s94, 1572864
    s_mov_b32 s95, 0x20000
    buffer_load_dword v0, v252, s[92:95], s63 offen
    v_mov_b32 v253, v252
    s_add_u32 s49, s63, 786432
    s_or_b32 s60, s2, s26
    s_cbranch_scc1 L_k1_tk
    s_memrealtime s[98:99]
    s_waitcnt lgkmcnt(0)
    s_or_b32 s98, s98, 1
    v_mov_b32 v11, 0
    v_mov_b32 v12, s98
    s_mov_b64 exec, 1
    global_store_dword v11, v12, s[22:23] sc1
    s_mov_b64 exec, -1
L_k1_tk:
    s_setprio 2
    s_lshl_b32 s61, s51, 3
    s_add_u32 s61, s61, s26
    s_mul_i32 s84, s61, 57344
    v_mul_u32_u24 v252, 3584, v179
    v_xor_b32 v185, 64, v184
    v_xor_b32 v186, 128, v184
    v_xor_b32 v187, 192, v184
    s_mov_b32 s32, s12
    s_and_b32 s33, s13, 0xffff
    s_mov_b32 s34, 1835008
    s_mov_b32 s35, 0x20000
    s_mov_b32 s36, s24
    s_and_b32 s37, s25, 0xffff
    s_mov_b32 s38, 268435456
    s_mov_b32 s39, 0x20000
    s_mov_b32 s40, s14
    s_and_b32 s41, s15, 0xffff
    s_mov_b32 s42, 3584
    s_mov_b32 s43, 0x20000
    v_lshrrev_b32 v177, 5, v1
    v_and_b32 v179, 3, v1
    v_bfe_u32 v180, v1, 2, 3
    v_lshlrev_b32 v181, 4, v179
    v_lshl_add_u32 v182, v177, 6, v181
    v_and_b32 v176, 31, v1
    v_lshlrev_b32 v2, 4, v1
    s_lshl_b32 s65, s27, 13
    v_mul_u32_u24 v3, 3584, v180
    v_add_u32 v3, v3, v182
    v_mul_u32_u24 v4, 3072, v180
    v_add_u32 v4, v4, v182
    v_lshl_add_u32 v183, v177, 8, v180
    v_mul_u32_u24 v8, 3584, v183
    v_add_u32 v8, v8, v181
    v_mov_b32 v10, 0x3f803f80
    v_mov_b32 v244, 0
    v_mov_b32 v245, 0
    s_mov_b32 s52, 0xffff0000
    s_mov_b32 s53, 0xffff0000
    v_lshlrev_b32 v6, 4, v176
    v_add_u32 v6, 65536, v6
    s_lshl_b32 s60, s27, 2
    v_add_u32 v5, s60, v6
    v_bfe_u32 v183, v1, 4, 1
    v_and_b32 v178, 1, v1
    v_cmp_eq_u32 vcc, v178, v183
    s_nop 1
    v_cndmask_b32 v216, 0, v10, vcc
    v_mov_b32 v217, v216
    v_mov_b32 v218, v216
    v_mov_b32 v219, v216
    v_bfe_u32 v191, v1, 2, 2
    v_lshlrev_b32 v189, 5, v183
    v_lshl_add_u32 v189, v179, 3, v189
    v_lshl_add_u32 v178, v191, 6, v189
    v_lshl_add_u32 v190, v177, 11, v178
    s_add_u32 s60, s27, 0
    s_and_b32 s60, s60, 3
    s_lshl_b32 s76, s60, 6
    s_lshl_b32 s61, s60, 12
    v_add_u32 v208, s61, v190
    v_add_u32 v212, 98304, v208
    s_add_u32 s60, s27, 1
    s_and_b32 s60, s60, 3
    s_lshl_b32 s77, s60, 6
    s_lshl_b32 s61, s60, 12
    v_add_u32 v209, s61, v190
    v_add_u32 v213, 98304, v209
    s_add_u32 s60, s27, 2
    s_and_b32 s60, s60, 3
    s_lshl_b32 s78, s60, 6
    s_lshl_b32 s61, s60, 12
    v_add_u32 v210, s61, v190
    v_add_u32 v214, 98304, v210
    s_add_u32 s60, s27, 3
    s_and_b32 s60, s60, 3
    s_lshl_b32 s79, s60, 6
    s_lshl_b32 s61, s60, 12
    v_add_u32 v211, s61, v190
    v_add_u32 v215, 98304, v211
    v_and_b32 v178, 15, v1
    v_lshlrev_b32 v188, 1, v177
    v_xor_b32 v178, v178, v188
    v_lshlrev_b32 v178, 4, v178
    v_lshl_add_u32 v178, v176, 8, v178
    s_add_u32 s60, s65, 32768
    v_add_u32 v178, s60, v178
    v_xor_b32 v228, s76, v178
    v_xor_b32 v229, 16, v228
    v_xor_b32 v230, s77, v178
    v_xor_b32 v231, 16, v230
    v_xor_b32 v232, s78, v178
    v_xor_b32 v233, 16, v232
    v_xor_b32 v234, s79, v178
    v_xor_b32 v235, 16, v234
    v_lshlrev_b32 v13, 1, v176
    s_lshl_b32 s60, s46, 8
    s_add_u32 s60, s60, s74
    s_lshl_b32 s68, s60, 10
    s_lshl_b32 s73, s46, 13
    s_lshl_b32 s60, s74, 7
    s_add_u32 s73, s73, s60
    s_lshl_b32 s60, s46, 13
    s_add_u32 s48, s73, s60
    s_lshl_b32 s72, s74, 12
    s_lshr_b32 s60, s50, 2
    s_lshl_b32 s60, s60, 11
    s_add_u32 s72, s72, s60
    s_lshl_b32 s60, s46, 8
    s_add_u32 s72, s72, s60
    s_add_u32 s72, s72, 20447232
    s_and_b32 s60, s2, 7
    s_lshl_b32 s47, s60, 13
    s_lshl_b32 s60, s60, 2
    s_lshr_b32 s61, s2, 6
    s_add_u32 s60, s60, s61
    s_lshl_b32 s60, s60, 16
    s_and_b32 s61, s26, 1
    s_lshl_b32 s61, s61, 15
    s_add_u32 s85, s60, s61
    s_bfe_u32 s61, s26, 0x10001
    s_mul_i32 s61, s61, 2097152
    s_add_u32 s85, s85, s61
    s_add_u32 s85, s85, 2097152
    s_and_b32 s61, s2, 0x38
    s_lshl_b32 s62, s27, 1
    s_add_u32 s61, s61, s62
    s_lshl_b32 s88, s61, 10
    s_add_u32 s88, s88, s60
    s_and_b32 s89, s2, 0x38
    s_lshl_b32 s89, s89, 7
    s_add_u32 s89, s89, s47
    s_add_u32 s89, s89, 20316160
    s_lshl_b32 s47, s47, 1
    s_add_u32 s47, s47, 20185088
    s_mul_i32 s62, s27, 229376
    s_mul_i32 s63, s27, 196608
    s_lshl_b32 s61, s46, 7
    s_add_u32 s63, s63, s61
    s_cmp_lt_u32 s50, 4
    s_cbranch_scc1 L_k1_y
    s_add_u32 s56, s63, 2048
    s_lshl_b32 s61, s46, 8
    s_add_u32 s57, s61, s62
    s_add_u32 s58, s57, 128
    s_lshl_b32 s60, s44, 7
    s_add_u32 s70, s61, s60
    s_mov_b32 s71, s70
    s_add_u32 s84, s84, s61
    s_mul_i32 s60, s74, 147456
    s_add_u32 s60, s60, 6324224
    s_lshr_b32 s61, s70, 6
    s_lshl_b32 s61, s61, 11
    s_add_u32 s66, s60, s61
    s_lshr_b32 s61, s71, 6
    s_lshl_b32 s61, s61, 11
    s_add_u32 s67, s60, s61
    v_and_b32 v178, 15, v1
    v_lshl_add_u32 v178, v177, 4, v178
    v_lshlrev_b32 v178, 4, v178
    v_lshl_add_u32 v7, v183, 16, v178
    v_lshl_add_u32 v9, v177, 2, v191
    v_lshl_add_u32 v9, v9, 8, v189
    s_lshl_b32 s60, s27, 12
    s_add_u32 s60, s60, 77824
    v_add_u32 v9, s60, v9
    v_lshrrev_b32 v8, 4, v1
    v_lshlrev_b32 v8, 10, v8
    v_and_b32 v178, 15, v1
    v_lshl_add_u32 v8, v178, 4, v8
    s_lshl_b32 s62, s45, 3
    s_add_u32 s62, s62, s46
    s_cmp_lt_u32 s62, 16
    s_cselect_b32 s80, s8, s16
    s_cselect_b32 s81, s9, s17
    s_and_b32 s81, s81, 0xffff
    s_mov_b32 s63, 524288
    s_cmp_lt_u32 s62, 16
    s_cselect_b32 s82, s63, 1835008
    s_mov_b32 s83, 0x20000
    s_cselect_b32 s63, 0, 16
    s_sub_u32 s60, s62, s63
    s_lshl_b32 s60, s60, 15
    s_lshl_b32 s61, s27, 8
    s_add_u32 s54, s60, s61
    s_mul_i32 s60, s27, 576
    s_lshl_b32 s61, s62, 1
    s_add_u32 s60, s60, s61
    s_lshl_b32 s60, s60, 10
    s_add_u32 s55, s60, 16777216
    s_cmp_lt_u32 s62, 72
    s_cselect_b32 s55, s55, 268435456
    s_lshl_b32 s60, s27, 14
    s_lshl_b32 s61, s62, 7
    s_add_u32 s60, s60, s61
    s_add_u32 s59, s60, 20709376
    s_cmp_eq_u32 s44, 0
    s_cbranch_scc0 L_k1_bx
    s_xor_b32 m0, s90, 1024
    s_xor_b32 s60, s86, 4096
    buffer_load_dwordx4 v185, s[28:31], s60 offen lds
    s_xor_b32 m0, s91, 1024
    s_xor_b32 s60, s87, 4096
    buffer_load_dwordx4 v185, s[28:31], s60 offen lds
    s_xor_b32 m0, s90, 2048
    s_xor_b32 s60, s86, 8192
    buffer_load_dwordx4 v186, s[28:31], s60 offen lds
    s_xor_b32 m0, s91, 2048
    s_xor_b32 s60, s87, 8192
    buffer_load_dwordx4 v186, s[28:31], s60 offen lds
    s_xor_b32 m0, s90, 3072
    s_xor_b32 s60, s86, 12288
    buffer_load_dwordx4 v187, s[28:31], s60 offen lds
    s_xor_b32 m0, s91, 3072
    s_xor_b32 s60, s87, 12288
    buffer_load_dwordx4 v187, s[28:31], s60 offen lds
    s_xor_b32 m0, s90, 4096
    s_xor_b32 s60, s86, 16384
    buffer_load_dwordx4 v184, s[28:31], s60 offen lds
    s_xor_b32 m0, s91, 4096
    s_xor_b32 s60, s87, 16384
    buffer_load_dwordx4 v184, s[28:31], s60 offen lds
    s_xor_b32 m0, s90, 5120
    s_xor_b32 s60, s86, 20480
    buffer_load_dwordx4 v185, s[28:31], s60 offen lds
    s_xor_b32 m0, s91, 5120
    s_xor_b32 s60, s87, 20480
    buffer_load_dwordx4 v185, s[28:31], s60 offen lds
    s_xor_b32 m0, s90, 6144
    s_xor_b32 s60, s86, 24576
    buffer_load_dwordx4 v186, s[28:31], s60 offen lds
    s_xor_b32 m0, s91, 6144
    s_xor_b32 s60, s87, 24576
    buffer_load_dwordx4 v186, s[28:31], s60 offen lds
    s_xor_b32 m0, s90, 7168
    s_xor_b32 s60, s86, 28672
    buffer_load_dwordx4 v187, s[28:31], s60 offen lds
    s_xor_b32 m0, s91, 7168
    s_xor_b32 s60, s87, 28672
    buffer_load_dwordx4 v187, s[28:31], s60 offen lds
    s_waitcnt vmcnt(0)
    s_waitcnt lgkmcnt(0)
    s_barrier
    s_add_u32 m0, s65, 0
    s_mov_b32 s60, s56
    buffer_load_dwordx4 v4, s[92:95], s60 offen lds
    s_add_u32 m0, s65, 1024
    s_addk_i32 s60, 24576
    buffer_load_dwordx4 v4, s[92:95], s60 offen lds
    s_add_u32 m0, s65, 2048
    s_addk_i32 s60, 24576
    buffer_load_dwordx4 v4, s[92:95], s60 offen lds
    s_add_u32 m0, s65, 3072
    s_addk_i32 s60, 24576
    buffer_load_dwordx4 v4, s[92:95], s60 offen lds
    s_add_u32 m0, s65, 4096
    s_addk_i32 s60, 24576
    buffer_load_dwordx4 v4, s[92:95], s60 offen lds
    s_add_u32 m0, s65, 5120
    s_addk_i32 s60, 24576
    buffer_load_dwordx4 v4, s[92:95], s60 offen lds
    s_add_u32 m0, s65, 6144
    s_addk_i32 s60, 24576
    buffer_load_dwordx4 v4, s[92:95], s60 offen lds
    s_add_u32 m0, s65, 7168
    s_addk_i32 s60, 24576
    buffer_load_dwordx4 v4, s[92:95], s60 offen lds
    ds_read_b128 v[16:19], v228 offset:0
    ds_read_b128 v[20:23], v229 offset:0
    ds_read_b128 v[24:27], v228 offset:32768
    ds_read_b128 v[28:31], v229 offset:32768
    ds_read_b128 v[32:35], v230 offset:0
    ds_read_b128 v[36:39], v231 offset:0
    ds_read_b128 v[40:43], v230 offset:32768
    ds_read_b128 v[44:47], v231 offset:32768
    ds_read_b128 v[48:51], v232 offset:0
    ds_read_b128 v[52:55], v233 offset:0
    ds_read_b128 v[56:59], v232 offset:32768
    ds_read_b128 v[60:63], v233 offset:32768
    ds_read_b128 v[64:67], v234 offset:0
    ds_read_b128 v[68:71], v235 offset:0
    ds_read_b128 v[72:75], v234 offset:32768
    ds_read_b128 v[76:79], v235 offset:32768
    v_add_u32 v228, 65536, v228
    v_add_u32 v229, 65536, v229
    v_add_u32 v230, 65536, v230
    v_add_u32 v231, 65536, v231
    v_add_u32 v232, 65536, v232
    v_add_u32 v233, 65536, v233
    v_add_u32 v234, 65536, v234
    v_add_u32 v235, 65536, v235
    buffer_load_dword v0, v253, s[92:95], s49 offen
    s_waitcnt lgkmcnt(15)
    v_dot2c_f32_bf16 v244, v16, v10
    v_dot2c_f32_bf16 v245, v16, v16
    v_dot2c_f32_bf16 v244, v17, v10
    v_dot2c_f32_bf16 v245, v17, v17
    v_dot2c_f32_bf16 v244, v18, v10
    v_dot2c_f32_bf16 v245, v18, v18
    v_dot2c_f32_bf16 v244, v19, v10
    v_dot2c_f32_bf16 v245, v19, v19
    s_waitcnt lgkmcnt(14)
    v_dot2c_f32_bf16 v244, v20, v10
    v_dot2c_f32_bf16 v245, v20, v20
    v_dot2c_f32_bf16 v244, v21, v10
    v_dot2c_f32_bf16 v245, v21, v21
    v_dot2c_f32_bf16 v244, v22, v10
    v_dot2c_f32_bf16 v245, v22, v22
    v_dot2c_f32_bf16 v244, v23, v10
    v_dot2c_f32_bf16 v245, v23, v23
    s_waitcnt lgkmcnt(13)
    v_dot2c_f32_bf16 v244, v24, v10
    v_dot2c_f32_bf16 v245, v24, v24
    v_dot2c_f32_bf16 v244, v25, v10
    v_dot2c_f32_bf16 v245, v25, v25
    v_dot2c_f32_bf16 v244, v26, v10
    v_dot2c_f32_bf16 v245, v26, v26
    v_dot2c_f32_bf16 v244, v27, v10
    v_dot2c_f32_bf16 v245, v27, v27
    s_waitcnt lgkmcnt(12)
    v_dot2c_f32_bf16 v244, v28, v10
    v_dot2c_f32_bf16 v245, v28, v28
    v_dot2c_f32_bf16 v244, v29, v10
    v_dot2c_f32_bf16 v245, v29, v29
    v_dot2c_f32_bf16 v244, v30, v10
    v_dot2c_f32_bf16 v245, v30, v30
    v_dot2c_f32_bf16 v244, v31, v10
    v_dot2c_f32_bf16 v245, v31, v31
    s_waitcnt lgkmcnt(11)
    v_dot2c_f32_bf16 v244, v32, v10
    v_dot2c_f32_bf16 v245, v32, v32
    v_dot2c_f32_bf16 v244, v33, v10
    v_dot2c_f32_bf16 v245, v33, v33
    v_dot2c_f32_bf16 v244, v34, v10
    v_dot2c_f32_bf16 v245, v34, v34
    v_dot2c_f32_bf16 v244, v35, v10
    v_dot2c_f32_bf16 v245, v35, v35
    s_waitcnt lgkmcnt(10)
    v_dot2c_f32_bf16 v244, v36, v10
    v_dot2c_f32_bf16 v245, v36, v36
    v_dot2c_f32_bf16 v244, v37, v10
    v_dot2c_f32_bf16 v245, v37, v37
    v_dot2c_f32_bf16 v244, v38, v10
    v_dot2c_f32_bf16 v245, v38, v38
    v_dot2c_f32_bf16 v244, v39, v10
    v_dot2c_f32_bf16 v245, v39, v39
    s_waitcnt lgkmcnt(9)
    v_dot2c_f32_bf16 v244, v40, v10
    v_dot2c_f32_bf16 v245, v40, v40
    v_dot2c_f32_bf16 v244, v41, v10
    v_dot2c_f32_bf16 v245, v41, v41
    v_dot2c_f32_bf16 v244, v42, v10
    v_dot2c_f32_bf16 v245, v42, v42
    v_dot2c_f32_bf16 v244, v43, v10
    v_dot2c_f32_bf16 v245, v43, v43
    s_waitcnt lgkmcnt(8)
    v_dot2c_f32_bf16 v244, v44, v10
    v_dot2c_f32_bf16 v245, v44, v44
    v_dot2c_f32_bf16 v244, v45, v10
    v_dot2c_f32_bf16 v245, v45, v45
    v_dot2c_f32_bf16 v244, v46, v10
    v_dot2c_f32_bf16 v245, v46, v46
    v_dot2c_f32_bf16 v244, v47, v10
    v_dot2c_f32_bf16 v245, v47, v47
    s_waitcnt lgkmcnt(7)
    v_dot2c_f32_bf16 v244, v48, v10
    v_dot2c_f32_bf16 v245, v48, v48
    v_dot2c_f32_bf16 v244, v49, v10
    v_dot2c_f32_bf16 v245, v49, v49
    v_dot2c_f32_bf16 v244, v50, v10
    v_dot2c_f32_bf16 v245, v50, v50
    v_dot2c_f32_bf16 v244, v51, v10
    v_dot2c_f32_bf16 v245, v51, v51
    s_waitcnt lgkmcnt(6)
    v_dot2c_f32_bf16 v244, v52, v10
    v_dot2c_f32_bf16 v245, v52, v52
    v_dot2c_f32_bf16 v244, v53, v10
    v_dot2c_f32_bf16 v245, v53, v53
    v_dot2c_f32_bf16 v244, v54, v10
    v_dot2c_f32_bf16 v245, v54, v54
    v_dot2c_f32_bf16 v244, v55, v10
    v_dot2c_f32_bf16 v245, v55, v55
    s_waitcnt lgkmcnt(5)
    v_dot2c_f32_bf16 v244, v56, v10
    v_dot2c_f32_bf16 v245, v56, v56
    v_dot2c_f32_bf16 v244, v57, v10
    v_dot2c_f32_bf16 v245, v57, v57
    v_dot2c_f32_bf16 v244, v58, v10
    v_dot2c_f32_bf16 v245, v58, v58
    v_dot2c_f32_bf16 v244, v59, v10
    v_dot2c_f32_bf16 v245, v59, v59
    s_waitcnt lgkmcnt(4)
    v_dot2c_f32_bf16 v244, v60, v10
    v_dot2c_f32_bf16 v245, v60, v60
    v_dot2c_f32_bf16 v244, v61, v10
    v_dot2c_f32_bf16 v245, v61, v61
    v_dot2c_f32_bf16 v244, v62, v10
    v_dot2c_f32_bf16 v245, v62, v62
    v_dot2c_f32_bf16 v244, v63, v10
    v_dot2c_f32_bf16 v245, v63, v63
    s_waitcnt lgkmcnt(3)
    v_dot2c_f32_bf16 v244, v64, v10
    v_dot2c_f32_bf16 v245, v64, v64
    v_dot2c_f32_bf16 v244, v65, v10
    v_dot2c_f32_bf16 v245, v65, v65
    v_dot2c_f32_bf16 v244, v66, v10
    v_dot2c_f32_bf16 v245, v66, v66
    v_dot2c_f32_bf16 v244, v67, v10
    v_dot2c_f32_bf16 v245, v67, v67
    s_waitcnt lgkmcnt(2)
    v_dot2c_f32_bf16 v244, v68, v10
    v_dot2c_f32_bf16 v245, v68, v68
    v_dot2c_f32_bf16 v244, v69, v10
    v_dot2c_f32_bf16 v245, v69, v69
    v_dot2c_f32_bf16 v244, v70, v10
    v_dot2c_f32_bf16 v245, v70, v70
    v_dot2c_f32_bf16 v244, v71, v10
    v_dot2c_f32_bf16 v245, v71, v71
    s_waitcnt lgkmcnt(1)
    v_dot2c_f32_bf16 v244, v72, v10
    v_dot2c_f32_bf16 v245, v72, v72
    v_dot2c_f32_bf16 v244, v73, v10
    v_dot2c_f32_bf16 v245, v73, v73
    v_dot2c_f32_bf16 v244, v74, v10
    v_dot2c_f32_bf16 v245, v74, v74
    v_dot2c_f32_bf16 v244, v75, v10
    v_dot2c_f32_bf16 v245, v75, v75
    s_waitcnt lgkmcnt(0)
    v_dot2c_f32_bf16 v244, v76, v10
    v_dot2c_f32_bf16 v245, v76, v76
    v_dot2c_f32_bf16 v244, v77, v10
    v_dot2c_f32_bf16 v245, v77, v77
    v_dot2c_f32_bf16 v244, v78, v10
    v_dot2c_f32_bf16 v245, v78, v78
    v_dot2c_f32_bf16 v244, v79, v10
    v_dot2c_f32_bf16 v245, v79, v79
    v_bfe_u32 v11, v1, 2, 2
    v_mul_u32_u24 v11, 3072, v11
    v_and_b32 v12, 3, v1
    v_lshl_add_u32 v11, v12, 7, v11
    s_lshr_b32 s61, s2, 3
    s_lshl_b32 s61, s61, 2
    s_add_u32 s61, s61, s27
    s_mul_i32 s61, s61, 12288
    s_and_b32 s62, s2, 4
    s_lshl_b32 s62, s62, 7
    s_add_u32 s61, s61, s62
    buffer_load_dword v0, v11, s[92:95], s61 offen
    buffer_load_dword v0, v252, s[32:35], s84 offen
    buffer_load_ushort v248, v13, s[40:43], s70 offen offset:0
    buffer_load_ushort v249, v13, s[40:43], s70 offen offset:64
    buffer_load_ushort v250, v13, s[40:43], s71 offen offset:0
    buffer_load_ushort v251, v13, s[40:43], s71 offen offset:64
    s_waitcnt vmcnt(7)
    s_waitcnt lgkmcnt(0)
    s_barrier
    s_setprio 0
    s_add_u32 m0, s65, 32768
    s_add_u32 s60, s56, 786432
    buffer_load_dwordx4 v4, s[92:95], s60 offen lds
    s_add_u32 m0, s65, 33792
    s_addk_i32 s60, 24576
    buffer_load_dwordx4 v4, s[92:95], s60 offen lds
    s_add_u32 m0, s65, 34816
    s_addk_i32 s60, 24576
    buffer_load_dwordx4 v4, s[92:95], s60 offen lds
    s_add_u32 m0, s65, 35840
    s_addk_i32 s60, 24576
    buffer_load_dwordx4 v4, s[92:95], s60 offen lds
    s_add_u32 m0, s65, 36864
    s_addk_i32 s60, 24576
    buffer_load_dwordx4 v4, s[92:95], s60 offen lds
    s_add_u32 m0, s65, 37888
    s_addk_i32 s60, 24576
    buffer_load_dwordx4 v4, s[92:95], s60 offen lds
    s_add_u32 m0, s65, 38912
    s_addk_i32 s60, 24576
    buffer_load_dwordx4 v4, s[92:95], s60 offen lds
    s_add_u32 m0, s65, 39936
    s_addk_i32 s60, 24576
    buffer_load_dwordx4 v4, s[92:95], s60 offen lds
    v_mov_b32 v11, 0
    global_load_dword v253, v11, s[22:23] sc1
    ds_read_b128 v[80:83], v228 offset:0
    ds_read_b128 v[84:87], v229 offset:0
    ds_read_b128 v[88:91], v228 offset:32768
    ds_read_b128 v[92:95], v229 offset:32768
    ds_read_b128 v[96:99], v230 offset:0
    ds_read_b128 v[100:103], v231 offset:0
    ds_read_b128 v[104:107], v230 offset:32768
    ds_read_b128 v[108:111], v231 offset:32768
    ds_read_b128 v[112:115], v232 offset:0
    ds_read_b128 v[116:119], v233 offset:0
    ds_read_b128 v[120:123], v232 offset:32768
    ds_read_b128 v[124:127], v233 offset:32768
    ds_read_b128 v[128:131], v234 offset:0
    ds_read_b128 v[132:135], v235 offset:0
    ds_read_b128 v[136:139], v234 offset:32768
    ds_read_b128 v[140:143], v235 offset:32768
    s_lshl_b32 s61, s26, 9
    s_add_u32 s61, s61, 69632
    v_lshl_add_u32 v11, v1, 2, s61
    ds_write_b32 v11, v244
    ds_write_b32 v11, v245 offset:256
    v_mov_b32 v11, 96256
    v_mov_b32 v12, 0
    ds_write_b32 v11, v12 offset:0
    ds_write_b32 v11, v12 offset:4
    ds_write_b32 v11, v12 offset:8
    ds_write_b32 v11, v12 offset:12
    ds_write_b32 v11, v12 offset:20
    ds_write_b32 v11, v12 offset:24
    ds_write_b32 v11, v12 offset:28
    v_mov_b32 v12, -1
    ds_write_b32 v11, v12 offset:16
    s_waitcnt vmcnt(1)
    s_waitcnt lgkmcnt(0)
    s_barrier
    s_add_u32 m0, s65, 98304
    s_mov_b32 s60, s57
    buffer_load_dwordx4 v3, s[32:35], s60 offen lds
    s_add_u32 m0, s65, 99328
    s_addk_i32 s60, 28672
    buffer_load_dwordx4 v3, s[32:35], s60 offen lds
    s_add_u32 m0, s65, 100352
    s_addk_i32 s60, 28672
    buffer_load_dwordx4 v3, s[32:35], s60 offen lds
    s_add_u32 m0, s65, 101376
    s_addk_i32 s60, 28672
    buffer_load_dwordx4 v3, s[32:35], s60 offen lds
    s_add_u32 m0, s65, 102400
    s_addk_i32 s60, 28672
    buffer_load_dwordx4 v3, s[32:35], s60 offen lds
    s_add_u32 m0, s65, 103424
    s_addk_i32 s60, 28672
    buffer_load_dwordx4 v3, s[32:35], s60 offen lds
    s_add_u32 m0, s65, 104448
    s_addk_i32 s60, 28672
    buffer_load_dwordx4 v3, s[32:35], s60 offen lds
    s_add_u32 m0, s65, 105472
    s_addk_i32 s60, 28672
    buffer_load_dwordx4 v3, s[32:35], s60 offen lds
    s_add_u32 m0, s65, 131072
    s_add_u32 s60, s57, 917504
    buffer_load_dwordx4 v3, s[32:35], s60 offen lds
    s_add_u32 m0, s65, 132096
    s_addk_i32 s60, 28672
    buffer_load_dwordx4 v3, s[32:35], s60 offen lds
    s_add_u32 m0, s65, 133120
    s_addk_i32 s60, 28672
    buffer_load_dwordx4 v3, s[32:35], s60 offen lds
    s_add_u32 m0, s65, 134144
    s_addk_i32 s60, 28672
    buffer_load_dwordx4 v3, s[32:35], s60 offen lds
    s_add_u32 m0, s65, 135168
    s_addk_i32 s60, 28672
    buffer_load_dwordx4 v3, s[32:35], s60 offen lds
    s_add_u32 m0, s65, 136192
    s_addk_i32 s60, 28672
    buffer_load_dwordx4 v3, s[32:35], s60 offen lds
    s_add_u32 m0, s65, 137216
    s_addk_i32 s60, 28672
    buffer_load_dwordx4 v3, s[32:35], s60 offen lds
    s_add_u32 m0, s65, 138240
    s_addk_i32 s60, 28672
    buffer_load_dwordx4 v3, s[32:35], s60 offen lds
    v_and_b32 v11, 31, v1
    v_mul_u32_u24 v11, 3584, v11
    s_lshl_b32 s61, s51, 2
    s_add_u32 s61, s61, s27
    s_mul_i32 s61, s61, 114688
    s_add_u32 s61, s61, s70
    buffer_load_dword v0, v11, s[32:35], s61 offen offset:128
    v_lshlrev_b32 v11, 7, v1
    s_mul_i32 s61, s27, 7936
    s_add_u32 s61, s61, s54
    buffer_load_dword v0, v11, s[80:83], s61 offen
    v_mov_b32 v228, 0
    v_mov_b32 v232, 0
    v_mov_b32 v236, 0
    v_mov_b32 v229, 0
    v_mov_b32 v233, 0
    v_mov_b32 v237, 0
    v_mov_b32 v230, 0
    v_mov_b32 v234, 0
    v_mov_b32 v238, 0
    v_mov_b32 v231, 0
    v_mov_b32 v235, 0
    v_mov_b32 v239, 0
    s_xor_b32 s61, s26, 4
    s_lshl_b32 s61, s61, 9
    s_add_u32 s61, s61, 69632
    v_lshl_add_u32 v153, v1, 2, s61
    ds_read_b32 v154, v153
    ds_read_b32 v155, v153 offset:256
    s_waitcnt lgkmcnt(0)
    v_add_f32 v244, v244, v154
    v_add_f32 v245, v245, v155
    v_mov_b32 v154, v244
    v_mov_b32 v155, v245
    s_nop 0
    v_permlane32_swap_b32 v244, v154
    v_permlane32_swap_b32 v245, v155
    v_add_f32 v244, v244, v154
    v_add_f32 v245, v245, v155
    v_mul_f32 v244, 0x3b000000, v244
    v_mul_f32 v245, 0x3b000000, v245
    v_fma_f32 v245, -v244, v244, v245
    v_max_f32 v245, 0, v245
    v_cvt_pk_bf16_f32 v154, v245, -v244
    v_lshlrev_b32 v155, 16, v154
    v_add_f32 v155, 0x3727c5ac, v155
    v_cvt_pk_bf16_f32 v155, v155, v155
    v_lshlrev_b32 v155, 16, v155
    v_sqrt_f32 v155, v155
    s_nop 0
    v_cvt_pk_bf16_f32 v155, v155, v155
    v_and_b32 v241, 0xffff0000, v155
    v_rcp_f32 v240, v241
    v_lshrrev_b32 v155, 16, v154
    v_cmp_gt_u32 vcc, 32, v1
    v_lshl_or_b32 v156, v155, 16, v155
    v_or_b32 v157, v241, v155
    v_cndmask_b32 v228, 0, v156, vcc
    v_cndmask_b32 v229, 0, v157, vcc
    v_mul_f32 v242, 0xc0135761, v240
    v_mul_f32 v243, v240, v240
    v_mul_f32 v243, v243, v240
    v_mul_f32 v243, 0xbdd2d3e8, v243
    s_waitcnt vmcnt(18)
    v_readfirstlane_b32 s100, v253
    s_nop 0
    s_cmp_lg_u32 s100, 0
    s_cbranch_scc1 L_k1_ttx0d
    s_mov_b32 s62, 0x40000
    v_mov_b32 v11, 0
L_k1_ttx0:
    global_load_dword v253, v11, s[22:23] sc1
    s_waitcnt vmcnt(0)
    v_readfirstlane_b32 s100, v253
    s_sub_u32 s62, s62, 1
    s_cbranch_scc1 L_k1_ttx0d
    s_cmp_eq_u32 s100, 0
    s_cbranch_scc1 L_k1_ttx0
L_k1_ttx0d:
    s_waitcnt vmcnt(10)
    s_waitcnt lgkmcnt(0)
    s_barrier
    s_setprio 3
    ds_read_b64_tr_b16 v[144:145], v212 offset:0
    ds_read_b64_tr_b16 v[146:147], v212 offset:256
    ds_read_b64_tr_b16 v[148:149], v212 offset:512
    ds_read_b64_tr_b16 v[150:151], v212 offset:768
    ds_read_b64_tr_b16 v[152:153], v212 offset:1024
    ds_read_b64_tr_b16 v[154:155], v212 offset:1280
    ds_read_b64_tr_b16 v[156:157], v212 offset:1536
    ds_read_b64_tr_b16 v[158:159], v212 offset:1792
    ds_read_b64_tr_b16 v[160:161], v212 offset:16384
    ds_read_b64_tr_b16 v[162:163], v212 offset:16640
    ds_read_b64_tr_b16 v[164:165], v212 offset:16896
    ds_read_b64_tr_b16 v[166:167], v212 offset:17152
    ds_read_b64_tr_b16 v[168:169], v212 offset:17408
    ds_read_b64_tr_b16 v[170:171], v212 offset:17664
    s_waitcnt lgkmcnt(12)
    v_mfma_f32_32x32x16_bf16 v[176:191], v[144:147], v[16:19], 0
    v_mfma_f32_16x16x32_bf16 v[220:223], v[216:219], v[144:147], 0
    ds_read_b64_tr_b16 v[172:173], v212 offset:17920
    ds_read_b64_tr_b16 v[174:175], v212 offset:18176
    s_waitcnt lgkmcnt(12)
    v_mfma_f32_32x32x16_bf16 v[192:207], v[148:151], v[16:19], 0
    v_mfma_f32_16x16x32_bf16 v[224:227], v[216:219], v[148:151], 0
    ds_read_b64_tr_b16 v[144:145], v213 offset:0
    ds_read_b64_tr_b16 v[146:147], v213 offset:256
    s_waitcnt lgkmcnt(12)
    v_mfma_f32_32x32x16_bf16 v[176:191], v[152:155], v[20:23], v[176:191]
    v_mfma_f32_16x16x32_bf16 v[220:223], v[216:219], v[152:155], v[220:223]
    ds_read_b64_tr_b16 v[148:149], v213 offset:512
    ds_read_b64_tr_b16 v[150:151], v213 offset:768
    s_waitcnt lgkmcnt(12)
    v_mfma_f32_32x32x16_bf16 v[192:207], v[156:159], v[20:23], v[192:207]
    v_mfma_f32_16x16x32_bf16 v[224:227], v[216:219], v[156:159], v[224:227]
    ds_read_b64_tr_b16 v[152:153], v213 offset:1024
    ds_read_b64_tr_b16 v[154:155], v213 offset:1280
    s_waitcnt lgkmcnt(12)
    v_mfma_f32_32x32x16_bf16 v[176:191], v[160:163], v[24:27], v[176:191]
    v_mfma_f32_16x16x32_bf16 v[220:223], v[216:219], v[160:163], v[220:223]
    ds_read_b64_tr_b16 v[156:157], v213 offset:1536
    ds_read_b64_tr_b16 v[158:159], v213 offset:1792
    s_waitcnt lgkmcnt(12)
    v_mfma_f32_32x32x16_bf16 v[192:207], v[164:167], v[24:27], v[192:207]
    v_mfma_f32_16x16x32_bf16 v[224:227], v[216:219], v[164:167], v[224:227]
    ds_read_b64_tr_b16 v[160:161], v213 offset:16384
    ds_read_b64_tr_b16 v[162:163], v213 offset:16640
    s_waitcnt lgkmcnt(12)
    v_mfma_f32_32x32x16_bf16 v[176:191], v[168:171], v[28:31], v[176:191]
    v_mfma_f32_16x16x32_bf16 v[220:223], v[216:219], v[168:171], v[220:223]
    ds_read_b64_tr_b16 v[164:165], v213 offset:16896
    ds_read_b64_tr_b16 v[166:167], v213 offset:17152
    s_waitcnt lgkmcnt(12)
    v_mfma_f32_32x32x16_bf16 v[192:207], v[172:175], v[28:31], v[192:207]
    v_mfma_f32_16x16x32_bf16 v[224:227], v[216:219], v[172:175], v[224:227]
    ds_read_b64_tr_b16 v[168:169], v213 offset:17408
    ds_read_b64_tr_b16 v[170:171], v213 offset:17664
    s_waitcnt lgkmcnt(12)
    v_mfma_f32_32x32x16_bf16 v[176:191], v[144:147], v[32:35], v[176:191]
    ds_read_b64_tr_b16 v[172:173], v213 offset:17920
    ds_read_b64_tr_b16 v[174:175], v213 offset:18176
    s_waitcnt lgkmcnt(12)
    v_mfma_f32_32x32x16_bf16 v[192:207], v[148:151], v[32:35], v[192:207]
    ds_read_b64_tr_b16 v[144:145], v214 offset:0
    ds_read_b64_tr_b16 v[146:147], v214 offset:256
    s_waitcnt lgkmcnt(12)
    v_mfma_f32_32x32x16_bf16 v[176:191], v[152:155], v[36:39], v[176:191]
    ds_read_b64_tr_b16 v[148:149], v214 offset:512
    ds_read_b64_tr_b16 v[150:151], v214 offset:768
    s_waitcnt lgkmcnt(12)
    v_mfma_f32_32x32x16_bf16 v[192:207], v[156:159], v[36:39], v[192:207]
    ds_read_b64_tr_b16 v[152:153], v214 offset:1024
    ds_read_b64_tr_b16 v[154:155], v214 offset:1280
    s_waitcnt lgkmcnt(12)
    v_mfma_f32_32x32x16_bf16 v[176:191], v[160:163], v[40:43], v[176:191]
    ds_read_b64_tr_b16 v[156:157], v214 offset:1536
    ds_read_b64_tr_b16 v[158:159], v214 offset:1792
    s_waitcnt lgkmcnt(12)
    v_mfma_f32_32x32x16_bf16 v[192:207], v[164:167], v[40:43], v[192:207]
    ds_read_b64_tr_b16 v[160:161], v214 offset:16384
    ds_read_b64_tr_b16 v[162:163], v214 offset:16640
    s_waitcnt lgkmcnt(12)
    v_mfma_f32_32x32x16_bf16 v[176:191], v[168:171], v[44:47], v[176:191]
    ds_read_b64_tr_b16 v[164:165], v214 offset:16896
    ds_read_b64_tr_b16 v[166:167], v214 offset:17152
    s_waitcnt lgkmcnt(12)
    v_mfma_f32_32x32x16_bf16 v[192:207], v[172:175], v[44:47], v[192:207]
    ds_read_b64_tr_b16 v[168:169], v214 offset:17408
    ds_read_b64_tr_b16 v[170:171], v214 offset:17664
    s_waitcnt lgkmcnt(12)
    v_mfma_f32_32x32x16_bf16 v[176:191], v[144:147], v[48:51], v[176:191]
    ds_read_b64_tr_b16 v[172:173], v214 offset:17920
    ds_read_b64_tr_b16 v[174:175], v214 offset:18176
    s_waitcnt lgkmcnt(12)
    v_mfma_f32_32x32x16_bf16 v[192:207], v[148:151], v[48:51], v[192:207]
    ds_read_b64_tr_b16 v[144:145], v215 offset:0
    ds_read_b64_tr_b16 v[146:147], v215 offset:256
    s_waitcnt lgkmcnt(12)
    v_mfma_f32_32x32x16_bf16 v[176:191], v[152:155], v[52:55], v[176:191]
    ds_read_b64_tr_b16 v[148:149], v215 offset:512
    ds_read_b64_tr_b16 v[150:151], v215 offset:768
    s_waitcnt lgkmcnt(12)
    v_mfma_f32_32x32x16_bf16 v[192:207], v[156:159], v[52:55], v[192:207]
    ds_read_b64_tr_b16 v[152:153], v215 offset:1024
    ds_read_b64_tr_b16 v[154:155], v215 offset:1280
    s_waitcnt lgkmcnt(12)
    v_mfma_f32_32x32x16_bf16 v[176:191], v[160:163], v[56:59], v[176:191]
    ds_read_b64_tr_b16 v[156:157], v215 offset:1536
    ds_read_b64_tr_b16 v[158:159], v215 offset:1792
    s_waitcnt lgkmcnt(12)
    v_mfma_f32_32x32x16_bf16 v[192:207], v[164:167], v[56:59], v[192:207]
    ds_read_b64_tr_b16 v[160:161], v215 offset:16384
    ds_read_b64_tr_b16 v[162:163], v215 offset:16640
    s_waitcnt lgkmcnt(12)
    v_mfma_f32_32x32x16_bf16 v[176:191], v[168:171], v[60:63], v[176:191]
    ds_read_b64_tr_b16 v[164:165], v215 offset:16896
    ds_read_b64_tr_b16 v[166:167], v215 offset:17152
    s_waitcnt lgkmcnt(12)
    v_mfma_f32_32x32x16_bf16 v[192:207], v[172:175], v[60:63], v[192:207]
    ds_read_b64_tr_b16 v[168:169], v215 offset:17408
    ds_read_b64_tr_b16 v[170:171], v215 offset:17664
    s_waitcnt lgkmcnt(12)
    v_mfma_f32_32x32x16_bf16 v[176:191], v[144:147], v[64:67], v[176:191]
    ds_read_b64_tr_b16 v[172:173], v215 offset:17920
    ds_read_b64_tr_b16 v[174:175], v215 offset:18176
    s_waitcnt lgkmcnt(12)
    v_mfma_f32_32x32x16_bf16 v[192:207], v[148:151], v[64:67], v[192:207]
    s_waitcnt lgkmcnt(10)
    v_mfma_f32_32x32x16_bf16 v[176:191], v[152:155], v[68:71], v[176:191]
    s_waitcnt lgkmcnt(8)
    v_mfma_f32_32x32x16_bf16 v[192:207], v[156:159], v[68:71], v[192:207]
    s_waitcnt vmcnt(2)
    s_waitcnt lgkmcnt(0)
    s_barrier
    ds_read_b64_tr_b16 v[144:145], v212 offset:32768
    ds_read_b64_tr_b16 v[146:147], v212 offset:33024
    ds_read_b64_tr_b16 v[148:149], v212 offset:33280
    ds_read_b64_tr_b16 v[150:151], v212 offset:33536
    ds_read_b64_tr_b16 v[152:153], v212 offset:33792
    ds_read_b64_tr_b16 v[154:155], v212 offset:34048
    v_mfma_f32_32x32x16_bf16 v[176:191], v[160:163], v[72:75], v[176:191]
    ds_read_b64_tr_b16 v[156:157], v212 offset:34304
    ds_read_b64_tr_b16 v[158:159], v212 offset:34560
    v_mfma_f32_32x32x16_bf16 v[192:207], v[164:167], v[72:75], v[192:207]
    ds_read_b64_tr_b16 v[160:161], v212 offset:49152
    ds_read_b64_tr_b16 v[162:163], v212 offset:49408
    v_mfma_f32_32x32x16_bf16 v[176:191], v[168:171], v[76:79], v[176:191]
    ds_read_b64_tr_b16 v[164:165], v212 offset:49664
    ds_read_b64_tr_b16 v[166:167], v212 offset:49920
    v_mfma_f32_32x32x16_bf16 v[192:207], v[172:175], v[76:79], v[192:207]
    ds_read_b64_tr_b16 v[168:169], v212 offset:50176
    ds_read_b64_tr_b16 v[170:171], v212 offset:50432
    s_waitcnt lgkmcnt(12)
    v_mfma_f32_32x32x16_bf16 v[176:191], v[144:147], v[80:83], v[176:191]
    v_mfma_f32_16x16x32_bf16 v[220:223], v[216:219], v[144:147], v[220:223]
    ds_read_b64_tr_b16 v[172:173], v212 offset:50688
    ds_read_b64_tr_b16 v[174:175], v212 offset:50944
    s_waitcnt lgkmcnt(12)
    v_mfma_f32_32x32x16_bf16 v[192:207], v[148:151], v[80:83], v[192:207]
    v_mfma_f32_16x16x32_bf16 v[224:227], v[216:219], v[148:151], v[224:227]
    ds_read_b64_tr_b16 v[144:145], v213 offset:32768
    ds_read_b64_tr_b16 v[146:147], v213 offset:33024
    s_waitcnt lgkmcnt(12)
    v_mfma_f32_32x32x16_bf16 v[176:191], v[152:155], v[84:87], v[176:191]
    v_mfma_f32_16x16x32_bf16 v[220:223], v[216:219], v[152:155], v[220:223]
    ds_read_b64_tr_b16 v[148:149], v213 offset:33280
    ds_read_b64_tr_b16 v[150:151], v213 offset:33536
    s_waitcnt lgkmcnt(12)
    v_mfma_f32_32x32x16_bf16 v[192:207], v[156:159], v[84:87], v[192:207]
    v_mfma_f32_16x16x32_bf16 v[224:227], v[216:219], v[156:159], v[224:227]
    ds_read_b64_tr_b16 v[152:153], v213 offset:33792
    ds_read_b64_tr_b16 v[154:155], v213 offset:34048
    s_waitcnt lgkmcnt(12)
    v_mfma_f32_32x32x16_bf16 v[176:191], v[160:163], v[88:91], v[176:191]
    v_mfma_f32_16x16x32_bf16 v[220:223], v[216:219], v[160:163], v[220:223]
    ds_read_b64_tr_b16 v[156:157], v213 offset:34304
    ds_read_b64_tr_b16 v[158:159], v213 offset:34560
    s_waitcnt lgkmcnt(12)
    v_mfma_f32_32x32x16_bf16 v[192:207], v[164:167], v[88:91], v[192:207]
    v_mfma_f32_16x16x32_bf16 v[224:227], v[216:219], v[164:167], v[224:227]
    ds_read_b64_tr_b16 v[160:161], v213 offset:49152
    ds_read_b64_tr_b16 v[162:163], v213 offset:49408
    s_waitcnt lgkmcnt(12)
    v_mfma_f32_32x32x16_bf16 v[176:191], v[168:171], v[92:95], v[176:191]
    v_mfma_f32_16x16x32_bf16 v[220:223], v[216:219], v[168:171], v[220:223]
    ds_read_b64_tr_b16 v[164:165], v213 offset:49664
    ds_read_b64_tr_b16 v[166:167], v213 offset:49920
    s_waitcnt lgkmcnt(12)
    v_mfma_f32_32x32x16_bf16 v[192:207], v[172:175], v[92:95], v[192:207]
    v_mfma_f32_16x16x32_bf16 v[224:227], v[216:219], v[172:175], v[224:227]
    ds_read_b64_tr_b16 v[168:169], v213 offset:50176
    ds_read_b64_tr_b16 v[170:171], v213 offset:50432
    s_waitcnt lgkmcnt(12)
    v_mfma_f32_32x32x16_bf16 v[176:191], v[144:147], v[96:99], v[176:191]
    ds_read_b64_tr_b16 v[172:173], v213 offset:50688
    ds_read_b64_tr_b16 v[174:175], v213 offset:50944
    s_waitcnt lgkmcnt(12)
    v_mfma_f32_32x32x16_bf16 v[192:207], v[148:151], v[96:99], v[192:207]
    ds_read_b64_tr_b16 v[144:145], v214 offset:32768
    ds_read_b64_tr_b16 v[146:147], v214 offset:33024
    s_waitcnt lgkmcnt(12)
    v_mfma_f32_32x32x16_bf16 v[176:191], v[152:155], v[100:103], v[176:191]
    ds_read_b64_tr_b16 v[148:149], v214 offset:33280
    ds_read_b64_tr_b16 v[150:151], v214 offset:33536
    s_waitcnt lgkmcnt(12)
    v_mfma_f32_32x32x16_bf16 v[192:207], v[156:159], v[100:103], v[192:207]
    ds_read_b64_tr_b16 v[152:153], v214 offset:33792
    ds_read_b64_tr_b16 v[154:155], v214 offset:34048
    s_waitcnt lgkmcnt(12)
    v_mfma_f32_32x32x16_bf16 v[176:191], v[160:163], v[104:107], v[176:191]
    ds_read_b64_tr_b16 v[156:157], v214 offset:34304
    ds_read_b64_tr_b16 v[158:159], v214 offset:34560
    s_waitcnt lgkmcnt(12)
    v_mfma_f32_32x32x16_bf16 v[192:207], v[164:167], v[104:107], v[192:207]
    ds_read_b64_tr_b16 v[160:161], v214 offset:49152
    ds_read_b64_tr_b16 v[162:163], v214 offset:49408
    s_waitcnt lgkmcnt(12)
    v_mfma_f32_32x32x16_bf16 v[176:191], v[168:171], v[108:111], v[176:191]
    ds_read_b64_tr_b16 v[164:165], v214 offset:49664
    ds_read_b64_tr_b16 v[166:167], v214 offset:49920
    s_waitcnt lgkmcnt(12)
    v_mfma_f32_32x32x16_bf16 v[192:207], v[172:175], v[108:111], v[192:207]
    ds_read_b64_tr_b16 v[168:169], v214 offset:50176
    ds_read_b64_tr_b16 v[170:171], v214 offset:50432
    s_waitcnt lgkmcnt(12)
    v_mfma_f32_32x32x16_bf16 v[176:191], v[144:147], v[112:115], v[176:191]
    ds_read_b64_tr_b16 v[172:173], v214 offset:50688
    ds_read_b64_tr_b16 v[174:175], v214 offset:50944
    s_waitcnt lgkmcnt(12)
    v_mfma_f32_32x32x16_bf16 v[192:207], v[148:151], v[112:115], v[192:207]
    v_cndmask_b32 v11, v220, v221, s[52:53]
    ds_write_b32 v5, v11 offset:1024
    ds_read_b64_tr_b16 v[144:145], v215 offset:32768
    ds_read_b64_tr_b16 v[146:147], v215 offset:33024
    s_waitcnt lgkmcnt(13)
    v_mfma_f32_32x32x16_bf16 v[176:191], v[152:155], v[116:119], v[176:191]
    ds_read_b64_tr_b16 v[148:149], v215 offset:33280
    ds_read_b64_tr_b16 v[150:151], v215 offset:33536
    s_waitcnt lgkmcnt(13)
    v_mfma_f32_32x32x16_bf16 v[192:207], v[156:159], v[116:119], v[192:207]
    v_cndmask_b32 v12, v224, v225, s[52:53]
    ds_write_b32 v5, v12 offset:1536
    ds_read_b64_tr_b16 v[152:153], v215 offset:33792
    ds_read_b64_tr_b16 v[154:155], v215 offset:34048
    s_waitcnt lgkmcnt(14)
    v_mfma_f32_32x32x16_bf16 v[176:191], v[160:163], v[120:123], v[176:191]
    ds_read_b64_tr_b16 v[156:157], v215 offset:34304
    ds_read_b64_tr_b16 v[158:159], v215 offset:34560
    s_waitcnt lgkmcnt(14)
    v_mfma_f32_32x32x16_bf16 v[192:207], v[164:167], v[120:123], v[192:207]
    ds_read_b64_tr_b16 v[160:161], v215 offset:49152
    ds_read_b64_tr_b16 v[162:163], v215 offset:49408
    s_waitcnt lgkmcnt(14)
    v_mfma_f32_32x32x16_bf16 v[176:191], v[168:171], v[124:127], v[176:191]
    ds_read_b64_tr_b16 v[164:165], v215 offset:49664
    ds_read_b64_tr_b16 v[166:167], v215 offset:49920
    s_waitcnt lgkmcnt(14)
    v_mfma_f32_32x32x16_bf16 v[192:207], v[172:175], v[124:127], v[192:207]
    ds_read_b64_tr_b16 v[168:169], v215 offset:50176
    ds_read_b64_tr_b16 v[170:171], v215 offset:50432
    s_waitcnt lgkmcnt(13)
    v_mfma_f32_32x32x16_bf16 v[176:191], v[144:147], v[128:131], v[176:191]
    ds_read_b64_tr_b16 v[172:173], v215 offset:50688
    ds_read_b64_tr_b16 v[174:175], v215 offset:50944
    s_waitcnt lgkmcnt(13)
    v_mfma_f32_32x32x16_bf16 v[192:207], v[148:151], v[128:131], v[192:207]
    s_waitcnt lgkmcnt(10)
    v_mfma_f32_32x32x16_bf16 v[176:191], v[152:155], v[132:135], v[176:191]
    s_waitcnt lgkmcnt(8)
    v_mfma_f32_32x32x16_bf16 v[192:207], v[156:159], v[132:135], v[192:207]
    s_waitcnt lgkmcnt(0)
    s_barrier
    v_mfma_f32_32x32x16_bf16 v[176:191], v[160:163], v[136:139], v[176:191]
    v_mfma_f32_32x32x16_bf16 v[192:207], v[164:167], v[136:139], v[192:207]
    v_mfma_f32_32x32x16_bf16 v[176:191], v[168:171], v[140:143], v[176:191]
    v_mfma_f32_32x32x16_bf16 v[192:207], v[172:175], v[140:143], v[192:207]
    s_setprio 0
    ds_read_b128 v[160:163], v6 offset:1024
    ds_read_b128 v[164:167], v6 offset:1536
    s_waitcnt lgkmcnt(0)
    v_add_f32 v160, v160, v161
    v_add_f32 v162, v162, v163
    v_add_f32 v144, v160, v162
    v_and_b32 v145, 0xffff0000, v144
    v_sub_f32 v146, v144, v145
    v_and_b32 v147, 0xffff0000, v146
    v_sub_f32 v146, v146, v147
    v_lshrrev_b32 v145, 16, v145
    v_or_b32 v232, v145, v147
    v_lshrrev_b32 v146, 16, v146
    v_lshl_or_b32 v233, v248, 16, v146
    v_add_f32 v164, v164, v165
    v_add_f32 v166, v166, v167
    v_add_f32 v144, v164, v166
    v_and_b32 v145, 0xffff0000, v144
    v_sub_f32 v146, v144, v145
    v_and_b32 v147, 0xffff0000, v146
    v_sub_f32 v146, v146, v147
    v_lshrrev_b32 v145, 16, v145
    v_or_b32 v236, v145, v147
    v_lshrrev_b32 v146, 16, v146
    v_lshl_or_b32 v237, v249, 16, v146
    v_mfma_f32_32x32x16_bf16 v[176:191], v[232:235], v[228:231], v[176:191]
    s_nop 0
    v_mfma_f32_32x32x16_bf16 v[192:207], v[236:239], v[228:231], v[192:207]
    s_nop 9
    v_mul_f32 v144, v176, v176
    v_mul_f32 v145, v177, v177
    v_mul_f32 v146, v178, v178
    v_mul_f32 v147, v179, v179
    v_mul_f32 v148, v180, v180
    v_mul_f32 v149, v181, v181
    v_mul_f32 v150, v182, v182
    v_mul_f32 v151, v183, v183
    v_fma_f32 v144, v144, v243, v242
    v_fma_f32 v145, v145, v243, v242
    v_fma_f32 v146, v146, v243, v242
    v_fma_f32 v147, v147, v243, v242
    v_fma_f32 v148, v148, v243, v242
    v_fma_f32 v149, v149, v243, v242
    v_fma_f32 v150, v150, v243, v242
    v_fma_f32 v151, v151, v243, v242
    v_mul_f32 v144, v144, v176
    v_mul_f32 v145, v145, v177
    v_mul_f32 v146, v146, v178
    v_mul_f32 v147, v147, v179
    v_mul_f32 v148, v148, v180
    v_mul_f32 v149, v149, v181
    v_mul_f32 v150, v150, v182
    v_mul_f32 v151, v151, v183
    v_exp_f32 v144, v144
    v_exp_f32 v145, v145
    v_exp_f32 v146, v146
    v_exp_f32 v147, v147
    v_exp_f32 v148, v148
    v_exp_f32 v149, v149
    v_exp_f32 v150, v150
    v_exp_f32 v151, v151
    v_fma_f32 v144, v144, v241, v241
    v_fma_f32 v145, v145, v241, v241
    v_fma_f32 v146, v146, v241, v241
    v_fma_f32 v147, v147, v241, v241
    v_fma_f32 v148, v148, v241, v241
    v_fma_f32 v149, v149, v241, v241
    v_fma_f32 v150, v150, v241, v241
    v_fma_f32 v151, v151, v241, v241
    v_rcp_f32 v144, v144
    v_rcp_f32 v145, v145
    v_rcp_f32 v146, v146
    v_rcp_f32 v147, v147
    v_rcp_f32 v148, v148
    v_rcp_f32 v149, v149
    v_rcp_f32 v150, v150
    v_rcp_f32 v151, v151
    v_mul_f32 v144, v144, v176
    v_mul_f32 v145, v145, v177
    v_mul_f32 v146, v146, v178
    v_mul_f32 v147, v147, v179
    v_mul_f32 v148, v148, v180
    v_mul_f32 v149, v149, v181
    v_mul_f32 v150, v150, v182
    v_mul_f32 v151, v151, v183
    v_cvt_pk_bf16_f32 v160, v144, v145
    v_cvt_pk_bf16_f32 v161, v146, v147
    v_cvt_pk_bf16_f32 v162, v148, v149
    v_cvt_pk_bf16_f32 v163, v150, v151
    buffer_store_dwordx4 v[160:163], v2, s[36:39], s66 offen offset:0 sc1
    v_mul_f32 v144, v184, v184
    v_mul_f32 v145, v185, v185
    v_mul_f32 v146, v186, v186
    v_mul_f32 v147, v187, v187
    v_mul_f32 v148, v188, v188
    v_mul_f32 v149, v189, v189
    v_mul_f32 v150, v190, v190
    v_mul_f32 v151, v191, v191
    v_fma_f32 v144, v144, v243, v242
    v_fma_f32 v145, v145, v243, v242
    v_fma_f32 v146, v146, v243, v242
    v_fma_f32 v147, v147, v243, v242
    v_fma_f32 v148, v148, v243, v242
    v_fma_f32 v149, v149, v243, v242
    v_fma_f32 v150, v150, v243, v242
    v_fma_f32 v151, v151, v243, v242
    v_mul_f32 v144, v144, v184
    v_mul_f32 v145, v145, v185
    v_mul_f32 v146, v146, v186
    v_mul_f32 v147, v147, v187
    v_mul_f32 v148, v148, v188
    v_mul_f32 v149, v149, v189
    v_mul_f32 v150, v150, v190
    v_mul_f32 v151, v151, v191
    v_exp_f32 v144, v144
    v_exp_f32 v145, v145
    v_exp_f32 v146, v146
    v_exp_f32 v147, v147
    v_exp_f32 v148, v148
    v_exp_f32 v149, v149
    v_exp_f32 v150, v150
    v_exp_f32 v151, v151
    v_fma_f32 v144, v144, v241, v241
    v_fma_f32 v145, v145, v241, v241
    v_fma_f32 v146, v146, v241, v241
    v_fma_f32 v147, v147, v241, v241
    v_fma_f32 v148, v148, v241, v241
    v_fma_f32 v149, v149, v241, v241
    v_fma_f32 v150, v150, v241, v241
    v_fma_f32 v151, v151, v241, v241
    v_rcp_f32 v144, v144
    v_rcp_f32 v145, v145
    v_rcp_f32 v146, v146
    v_rcp_f32 v147, v147
    v_rcp_f32 v148, v148
    v_rcp_f32 v149, v149
    s_waitcnt lgkmcnt(0)
    s_barrier
    v_rcp_f32 v150, v150
    v_rcp_f32 v151, v151
    v_mul_f32 v144, v144, v184
    v_mul_f32 v145, v145, v185
    v_mul_f32 v146, v146, v186
    v_mul_f32 v147, v147, v187
    v_mul_f32 v148, v148, v188
    v_mul_f32 v149, v149, v189
    v_mul_f32 v150, v150, v190
    v_mul_f32 v151, v151, v191
    v_cvt_pk_bf16_f32 v164, v144, v145
    v_cvt_pk_bf16_f32 v165, v146, v147
    v_cvt_pk_bf16_f32 v166, v148, v149
    v_cvt_pk_bf16_f32 v167, v150, v151
    buffer_store_dwordx4 v[164:167], v2, s[36:39], s66 offen offset:1024 sc1
    v_mul_f32 v144, v192, v192
    v_mul_f32 v145, v193, v193
    v_mul_f32 v146, v194, v194
    v_mul_f32 v147, v195, v195
    v_mul_f32 v148, v196, v196
    v_mul_f32 v149, v197, v197
    v_mul_f32 v150, v198, v198
    v_mul_f32 v151, v199, v199
    v_fma_f32 v144, v144, v243, v242
    v_fma_f32 v145, v145, v243, v242
    v_fma_f32 v146, v146, v243, v242
    v_fma_f32 v147, v147, v243, v242
    v_fma_f32 v148, v148, v243, v242
    v_fma_f32 v149, v149, v243, v242
    v_fma_f32 v150, v150, v243, v242
    v_fma_f32 v151, v151, v243, v242
    v_mul_f32 v144, v144, v192
    v_mul_f32 v145, v145, v193
    v_mul_f32 v146, v146, v194
    v_mul_f32 v147, v147, v195
    v_mul_f32 v148, v148, v196
    v_mul_f32 v149, v149, v197
    v_mul_f32 v150, v150, v198
    v_mul_f32 v151, v151, v199
    v_exp_f32 v144, v144
    v_exp_f32 v145, v145
    v_exp_f32 v146, v146
    v_exp_f32 v147, v147
    v_exp_f32 v148, v148
    v_exp_f32 v149, v149
    v_exp_f32 v150, v150
    v_exp_f32 v151, v151
    v_fma_f32 v144, v144, v241, v241
    v_fma_f32 v145, v145, v241, v241
    v_fma_f32 v146, v146, v241, v241
    v_fma_f32 v147, v147, v241, v241
    v_fma_f32 v148, v148, v241, v241
    v_fma_f32 v149, v149, v241, v241
    v_fma_f32 v150, v150, v241, v241
    v_fma_f32 v151, v151, v241, v241
    v_rcp_f32 v144, v144
    v_rcp_f32 v145, v145
    v_rcp_f32 v146, v146
    v_rcp_f32 v147, v147
    v_rcp_f32 v148, v148
    v_rcp_f32 v149, v149
    v_rcp_f32 v150, v150
    v_rcp_f32 v151, v151
    v_mul_f32 v144, v144, v192
    v_mul_f32 v145, v145, v193
    v_mul_f32 v146, v146, v194
    v_mul_f32 v147, v147, v195
    v_mul_f32 v148, v148, v196
    v_mul_f32 v149, v149, v197
    v_mul_f32 v150, v150, v198
    v_mul_f32 v151, v151, v199
    v_cvt_pk_bf16_f32 v168, v144, v145
    v_cvt_pk_bf16_f32 v169, v146, v147
    v_cvt_pk_bf16_f32 v170, v148, v149
    v_cvt_pk_bf16_f32 v171, v150, v151
    buffer_store_dwordx4 v[168:171], v2, s[36:39], s66 offen offset:2048 sc1
    v_mul_f32 v144, v200, v200
    v_mul_f32 v145, v201, v201
    v_mul_f32 v146, v202, v202
    v_mul_f32 v147, v203, v203
    v_mul_f32 v148, v204, v204
    v_mul_f32 v149, v205, v205
    v_mul_f32 v150, v206, v206
    v_mul_f32 v151, v207, v207
    v_fma_f32 v144, v144, v243, v242
    v_fma_f32 v145, v145, v243, v242
    v_fma_f32 v146, v146, v243, v242
    v_fma_f32 v147, v147, v243, v242
    v_fma_f32 v148, v148, v243, v242
    v_fma_f32 v149, v149, v243, v242
    v_fma_f32 v150, v150, v243, v242
    v_fma_f32 v151, v151, v243, v242
    v_mul_f32 v144, v144, v200
    v_mul_f32 v145, v145, v201
    v_mul_f32 v146, v146, v202
    v_mul_f32 v147, v147, v203
    v_mul_f32 v148, v148, v204
    v_mul_f32 v149, v149, v205
    v_mul_f32 v150, v150, v206
    v_mul_f32 v151, v151, v207
    v_exp_f32 v144, v144
    v_exp_f32 v145, v145
    v_exp_f32 v146, v146
    v_exp_f32 v147, v147
    v_exp_f32 v148, v148
    v_exp_f32 v149, v149
    v_exp_f32 v150, v150
    v_exp_f32 v151, v151
    v_fma_f32 v144, v144, v241, v241
    v_fma_f32 v145, v145, v241, v241
    v_fma_f32 v146, v146, v241, v241
    v_fma_f32 v147, v147, v241, v241
    v_fma_f32 v148, v148, v241, v241
    v_fma_f32 v149, v149, v241, v241
    v_fma_f32 v150, v150, v241, v241
    v_fma_f32 v151, v151, v241, v241
    v_rcp_f32 v144, v144
    v_rcp_f32 v145, v145
    v_rcp_f32 v146, v146
    v_rcp_f32 v147, v147
    v_rcp_f32 v148, v148
    v_rcp_f32 v149, v149
    v_rcp_f32 v150, v150
    v_rcp_f32 v151, v151
    v_mul_f32 v144, v144, v200
    v_mul_f32 v145, v145, v201
    v_mul_f32 v146, v146, v202
    v_mul_f32 v147, v147, v203
    v_mul_f32 v148, v148, v204
    v_mul_f32 v149, v149, v205
    v_mul_f32 v150, v150, v206
    v_mul_f32 v151, v151, v207
    v_cvt_pk_bf16_f32 v172, v144, v145
    v_cvt_pk_bf16_f32 v173, v146, v147
    v_cvt_pk_bf16_f32 v174, v148, v149
    v_cvt_pk_bf16_f32 v175, v150, v151
    buffer_store_dwordx4 v[172:175], v2, s[36:39], s66 offen offset:3072 sc1
    v_lshlrev_b32 v14, 8, v1
    s_cmp_eq_u32 s27, 0
    s_cselect_b32 s62, s47, 268435456
    buffer_load_dword v254, v14, s[36:39], s62 offen offset:0 sc1
    buffer_load_dword v255, v14, s[36:39], s62 offen offset:128 sc1
    s_waitcnt lgkmcnt(0)
    s_barrier
    s_waitcnt vmcnt(0)
    s_add_u32 s61, s72, 0
    v_lshlrev_b32 v11, 2, v1
    v_mov_b32 v12, s100
    s_mov_b32 exec_hi, 0
    buffer_store_dword v12, v11, s[36:39], s61 offen sc1
    s_mov_b64 exec, -1
    s_cmp_lg_u32 s27, 0
    s_cbranch_scc1 L_k1_fkvx0x
    s_mov_b32 s62, 0x40000
L_k1_fkvx0:
    v_xor_b32 v254, s100, v254
    v_xor_b32 v255, s100, v255
    v_or_b32 v254, v254, v255
    v_cmp_ne_u32 vcc, 0, v254
    s_sub_u32 s62, s62, 1
    s_cbranch_scc1 L_k1_fkvx0d
    s_nop 3
    s_cbranch_vccz L_k1_fkvx0d
    s_sleep 4
    buffer_load_dword v254, v14, s[36:39], s47 offen offset:0 sc1
    buffer_load_dword v255, v14, s[36:39], s47 offen offset:128 sc1
    s_waitcnt vmcnt(0)
    s_branch L_k1_fkvx0
L_k1_fkvx0d:
    v_mov_b32 v254, 96256
    v_mov_b32 v255, 1
    ds_write_b32 v254, v255 offset:28
L_k1_fkvx0x:
    v_mov_b32 v11, 96256
L_k1_qwx028:
    ds_read_b32 v12, v11 offset:28
    s_waitcnt lgkmcnt(0)
    v_readfirstlane_b32 s62, v12
    s_nop 0
    s_cmp_eq_u32 s62, 0
    s_cbranch_scc1 L_k1_qwx028
    s_add_u32 s63, s85, 0
    s_add_u32 m0, s65, 131072
    s_nop 0
    buffer_load_dwordx4 v2, s[36:39], s63 offen offset:0 sc1 lds
    s_add_u32 m0, s65, 131072
    s_nop 0
    buffer_load_dwordx4 v2, s[36:39], s63 offen offset:1024 sc1 lds
    s_add_u32 m0, s65, 131072
    s_nop 0
    buffer_load_dwordx4 v2, s[36:39], s63 offen offset:2048 sc1 lds
    s_add_u32 m0, s65, 131072
    s_nop 0
    buffer_load_dwordx4 v2, s[36:39], s63 offen offset:3072 sc1 lds
    s_add_u32 s63, s85, 4096
    s_add_u32 m0, s65, 135168
    s_nop 0
    buffer_load_dwordx4 v2, s[36:39], s63 offen offset:0 sc1 lds
    s_add_u32 m0, s65, 135168
    s_nop 0
    buffer_load_dwordx4 v2, s[36:39], s63 offen offset:1024 sc1 lds
    s_add_u32 m0, s65, 135168
    s_nop 0
    buffer_load_dwordx4 v2, s[36:39], s63 offen offset:2048 sc1 lds
    s_add_u32 m0, s65, 135168
    s_nop 0
    buffer_load_dwordx4 v2, s[36:39], s63 offen offset:3072 sc1 lds
    v_and_b32 v14, 7, v1
    v_lshlrev_b32 v14, 7, v14
    s_cmp_eq_u32 s27, 0
    s_cselect_b32 s62, s89, 268435456
    buffer_load_dword v254, v14, s[36:39], s62 offen offset:0 sc1
    s_add_u32 s63, s85, 8192
    s_add_u32 m0, s65, 0
    s_nop 0
    buffer_load_dwordx4 v2, s[36:39], s63 offen offset:0 sc1 lds
    s_add_u32 m0, s65, 0
    s_nop 0
    buffer_load_dwordx4 v2, s[36:39], s63 offen offset:1024 sc1 lds
    s_add_u32 m0, s65, 0
    s_nop 0
    buffer_load_dwordx4 v2, s[36:39], s63 offen offset:2048 sc1 lds
    s_add_u32 m0, s65, 0
    s_nop 0
    buffer_load_dwordx4 v2, s[36:39], s63 offen offset:3072 sc1 lds
    s_add_u32 s63, s85, 12288
    s_add_u32 m0, s65, 4096
    s_nop 0
    buffer_load_dwordx4 v2, s[36:39], s63 offen offset:0 sc1 lds
    s_add_u32 m0, s65, 4096
    s_nop 0
    buffer_load_dwordx4 v2, s[36:39], s63 offen offset:1024 sc1 lds
    s_add_u32 m0, s65, 4096
    s_nop 0
    buffer_load_dwordx4 v2, s[36:39], s63 offen offset:2048 sc1 lds
    s_add_u32 m0, s65, 4096
    s_nop 0
    buffer_load_dwordx4 v2, s[36:39], s63 offen offset:3072 sc1 lds
    s_waitcnt vmcnt(9)
    v_mov_b32 v11, 96256
    v_mov_b32 v12, 1
    s_mov_b64 exec, 1
    ds_add_u32 v11, v12 offset:0
    s_mov_b64 exec, -1
    s_cmp_lg_u32 s27, 0
    s_cbranch_scc1 L_k1_fqx0x
    s_mov_b32 s62, 0x40000
    s_waitcnt vmcnt(8)
L_k1_fqx0:
    v_xor_b32 v254, s100, v254
    v_cmp_ne_u32 vcc, 0, v254
    s_sub_u32 s62, s62, 1
    s_cbranch_scc1 L_k1_fqx0d
    s_nop 3
    s_cbranch_vccz L_k1_fqx0d
    s_sleep 4
    buffer_load_dword v254, v14, s[36:39], s89 offen offset:0 sc1
    s_waitcnt vmcnt(0)
    s_branch L_k1_fqx0
L_k1_fqx0d:
    v_mov_b32 v254, 96256
    v_mov_b32 v255, 1
    ds_write_b32 v254, v255 offset:20
L_k1_fqx0x:
    v_mov_b32 v11, 96256
L_k1_qwx020:
    ds_read_b32 v12, v11 offset:20
    s_waitcnt lgkmcnt(0)
    v_readfirstlane_b32 s62, v12
    s_nop 0
    s_cmp_eq_u32 s62, 0
    s_cbranch_scc1 L_k1_qwx020
    buffer_load_dwordx4 v[16:19], v2, s[36:39], s88 offen offset:0 sc1
    buffer_load_dwordx4 v[20:23], v2, s[36:39], s88 offen offset:1024 sc1
    s_mov_b32 s96, s85
    s_mov_b32 s97, 1
    s_mov_b32 s94, 268435456
    s_mov_b32 s95, 268435456
    s_branch L_p2
L_k1_bx:
    s_nop 4
    s_setprio 1
    s_xor_b32 m0, s90, 1024
    s_xor_b32 s60, s86, 4096
    buffer_load_dwordx4 v185, s[28:31], s60 offen lds
    s_xor_b32 m0, s91, 1024
    s_xor_b32 s60, s87, 4096
    buffer_load_dwordx4 v185, s[28:31], s60 offen lds
    s_xor_b32 m0, s90, 2048
    s_xor_b32 s60, s86, 8192
    buffer_load_dwordx4 v186, s[28:31], s60 offen lds
    s_xor_b32 m0, s91, 2048
    s_xor_b32 s60, s87, 8192
    buffer_load_dwordx4 v186, s[28:31], s60 offen lds
    s_xor_b32 m0, s90, 3072
    s_xor_b32 s60, s86, 12288
    buffer_load_dwordx4 v187, s[28:31], s60 offen lds
    s_xor_b32 m0, s91, 3072
    s_xor_b32 s60, s87, 12288
    buffer_load_dwordx4 v187, s[28:31], s60 offen lds
    s_xor_b32 m0, s90, 4096
    s_xor_b32 s60, s86, 16384
    buffer_load_dwordx4 v184, s[28:31], s60 offen lds
    s_xor_b32 m0, s91, 4096
    s_xor_b32 s60, s87, 16384
    buffer_load_dwordx4 v184, s[28:31], s60 offen lds
    s_xor_b32 m0, s90, 5120
    s_xor_b32 s60, s86, 20480
    buffer_load_dwordx4 v185, s[28:31], s60 offen lds
    s_xor_b32 m0, s91, 5120
    s_xor_b32 s60, s87, 20480
    buffer_load_dwordx4 v185, s[28:31], s60 offen lds
    s_xor_b32 m0, s90, 6144
    s_xor_b32 s60, s86, 24576
    buffer_load_dwordx4 v186, s[28:31], s60 offen lds
    s_xor_b32 m0, s91, 6144
    s_xor_b32 s60, s87, 24576
    buffer_load_dwordx4 v186, s[28:31], s60 offen lds
    s_xor_b32 m0, s90, 7168
    s_xor_b32 s60, s86, 28672
    buffer_load_dwordx4 v187, s[28:31], s60 offen lds
    s_xor_b32 m0, s91, 7168
    s_xor_b32 s60, s87, 28672
    buffer_load_dwordx4 v187, s[28:31], s60 offen lds
    s_waitcnt lgkmcnt(0)
    s_barrier
    ds_read_b128 v[16:19], v228 offset:0
    ds_read_b128 v[20:23], v229 offset:0
    ds_read_b128 v[24:27], v228 offset:32768
    ds_read_b128 v[28:31], v229 offset:32768
    ds_read_b128 v[32:35], v230 offset:0
    ds_read_b128 v[36:39], v231 offset:0
    ds_read_b128 v[40:43], v230 offset:32768
    ds_read_b128 v[44:47], v231 offset:32768
    ds_read_b128 v[48:51], v232 offset:0
    ds_read_b128 v[52:55], v233 offset:0
    ds_read_b128 v[56:59], v232 offset:32768
    ds_read_b128 v[60:63], v233 offset:32768
    ds_read_b128 v[64:67], v234 offset:0
    ds_read_b128 v[68:71], v235 offset:0
    ds_read_b128 v[72:75], v234 offset:32768
    ds_read_b128 v[76:79], v235 offset:32768
    v_add_u32 v228, 65536, v228
    v_add_u32 v229, 65536, v229
    v_add_u32 v230, 65536, v230
    v_add_u32 v231, 65536, v231
    v_add_u32 v232, 65536, v232
    v_add_u32 v233, 65536, v233
    v_add_u32 v234, 65536, v234
    v_add_u32 v235, 65536, v235
    s_waitcnt vmcnt(0)
    ds_read_b128 v[80:83], v228 offset:0
    ds_read_b128 v[84:87], v229 offset:0
    ds_read_b128 v[88:91], v228 offset:32768
    ds_read_b128 v[92:95], v229 offset:32768
    ds_read_b128 v[96:99], v230 offset:0
    ds_read_b128 v[100:103], v231 offset:0
    ds_read_b128 v[104:107], v230 offset:32768
    ds_read_b128 v[108:111], v231 offset:32768
    ds_read_b128 v[112:115], v232 offset:0
    ds_read_b128 v[116:119], v233 offset:0
    ds_read_b128 v[120:123], v232 offset:32768
    ds_read_b128 v[124:127], v233 offset:32768
    ds_read_b128 v[128:131], v234 offset:0
    ds_read_b128 v[132:135], v235 offset:0
    ds_read_b128 v[136:139], v234 offset:32768
    ds_read_b128 v[140:143], v235 offset:32768
    s_waitcnt lgkmcnt(15)
    v_dot2c_f32_bf16 v244, v80, v10
    v_dot2c_f32_bf16 v245, v80, v80
    v_dot2c_f32_bf16 v244, v81, v10
    v_dot2c_f32_bf16 v245, v81, v81
    v_dot2c_f32_bf16 v244, v82, v10
    v_dot2c_f32_bf16 v245, v82, v82
    v_dot2c_f32_bf16 v244, v83, v10
    v_dot2c_f32_bf16 v245, v83, v83
    s_waitcnt lgkmcnt(14)
    v_dot2c_f32_bf16 v244, v84, v10
    v_dot2c_f32_bf16 v245, v84, v84
    v_dot2c_f32_bf16 v244, v85, v10
    v_dot2c_f32_bf16 v245, v85, v85
    v_dot2c_f32_bf16 v244, v86, v10
    v_dot2c_f32_bf16 v245, v86, v86
    v_dot2c_f32_bf16 v244, v87, v10
    v_dot2c_f32_bf16 v245, v87, v87
    s_waitcnt lgkmcnt(13)
    v_dot2c_f32_bf16 v244, v88, v10
    v_dot2c_f32_bf16 v245, v88, v88
    v_dot2c_f32_bf16 v244, v89, v10
    v_dot2c_f32_bf16 v245, v89, v89
    v_dot2c_f32_bf16 v244, v90, v10
    v_dot2c_f32_bf16 v245, v90, v90
    v_dot2c_f32_bf16 v244, v91, v10
    v_dot2c_f32_bf16 v245, v91, v91
    s_waitcnt lgkmcnt(12)
    v_dot2c_f32_bf16 v244, v92, v10
    v_dot2c_f32_bf16 v245, v92, v92
    v_dot2c_f32_bf16 v244, v93, v10
    v_dot2c_f32_bf16 v245, v93, v93
    v_dot2c_f32_bf16 v244, v94, v10
    v_dot2c_f32_bf16 v245, v94, v94
    v_dot2c_f32_bf16 v244, v95, v10
    v_dot2c_f32_bf16 v245, v95, v95
    s_waitcnt lgkmcnt(11)
    v_dot2c_f32_bf16 v244, v96, v10
    v_dot2c_f32_bf16 v245, v96, v96
    v_dot2c_f32_bf16 v244, v97, v10
    v_dot2c_f32_bf16 v245, v97, v97
    v_dot2c_f32_bf16 v244, v98, v10
    v_dot2c_f32_bf16 v245, v98, v98
    v_dot2c_f32_bf16 v244, v99, v10
    v_dot2c_f32_bf16 v245, v99, v99
    s_waitcnt lgkmcnt(10)
    v_dot2c_f32_bf16 v244, v100, v10
    v_dot2c_f32_bf16 v245, v100, v100
    v_dot2c_f32_bf16 v244, v101, v10
    v_dot2c_f32_bf16 v245, v101, v101
    v_dot2c_f32_bf16 v244, v102, v10
    v_dot2c_f32_bf16 v245, v102, v102
    v_dot2c_f32_bf16 v244, v103, v10
    v_dot2c_f32_bf16 v245, v103, v103
    s_waitcnt lgkmcnt(9)
    v_dot2c_f32_bf16 v244, v104, v10
    v_dot2c_f32_bf16 v245, v104, v104
    v_dot2c_f32_bf16 v244, v105, v10
    v_dot2c_f32_bf16 v245, v105, v105
    v_dot2c_f32_bf16 v244, v106, v10
    v_dot2c_f32_bf16 v245, v106, v106
    v_dot2c_f32_bf16 v244, v107, v10
    v_dot2c_f32_bf16 v245, v107, v107
    s_waitcnt lgkmcnt(8)
    v_dot2c_f32_bf16 v244, v108, v10
    v_dot2c_f32_bf16 v245, v108, v108
    v_dot2c_f32_bf16 v244, v109, v10
    v_dot2c_f32_bf16 v245, v109, v109
    v_dot2c_f32_bf16 v244, v110, v10
    v_dot2c_f32_bf16 v245, v110, v110
    v_dot2c_f32_bf16 v244, v111, v10
    v_dot2c_f32_bf16 v245, v111, v111
    s_waitcnt lgkmcnt(7)
    v_dot2c_f32_bf16 v244, v112, v10
    v_dot2c_f32_bf16 v245, v112, v112
    v_dot2c_f32_bf16 v244, v113, v10
    v_dot2c_f32_bf16 v245, v113, v113
    v_dot2c_f32_bf16 v244, v114, v10
    v_dot2c_f32_bf16 v245, v114, v114
    v_dot2c_f32_bf16 v244, v115, v10
    v_dot2c_f32_bf16 v245, v115, v115
    s_waitcnt lgkmcnt(6)
    v_dot2c_f32_bf16 v244, v116, v10
    v_dot2c_f32_bf16 v245, v116, v116
    v_dot2c_f32_bf16 v244, v117, v10
    v_dot2c_f32_bf16 v245, v117, v117
    v_dot2c_f32_bf16 v244, v118, v10
    v_dot2c_f32_bf16 v245, v118, v118
    v_dot2c_f32_bf16 v244, v119, v10
    v_dot2c_f32_bf16 v245, v119, v119
    s_waitcnt lgkmcnt(5)
    v_dot2c_f32_bf16 v244, v120, v10
    v_dot2c_f32_bf16 v245, v120, v120
    v_dot2c_f32_bf16 v244, v121, v10
    v_dot2c_f32_bf16 v245, v121, v121
    v_dot2c_f32_bf16 v244, v122, v10
    v_dot2c_f32_bf16 v245, v122, v122
    v_dot2c_f32_bf16 v244, v123, v10
    v_dot2c_f32_bf16 v245, v123, v123
    s_waitcnt lgkmcnt(4)
    v_dot2c_f32_bf16 v244, v124, v10
    v_dot2c_f32_bf16 v245, v124, v124
    v_dot2c_f32_bf16 v244, v125, v10
    v_dot2c_f32_bf16 v245, v125, v125
    v_dot2c_f32_bf16 v244, v126, v10
    v_dot2c_f32_bf16 v245, v126, v126
    v_dot2c_f32_bf16 v244, v127, v10
    v_dot2c_f32_bf16 v245, v127, v127
    s_waitcnt lgkmcnt(3)
    v_dot2c_f32_bf16 v244, v128, v10
    v_dot2c_f32_bf16 v245, v128, v128
    v_dot2c_f32_bf16 v244, v129, v10
    v_dot2c_f32_bf16 v245, v129, v129
    v_dot2c_f32_bf16 v244, v130, v10
    v_dot2c_f32_bf16 v245, v130, v130
    v_dot2c_f32_bf16 v244, v131, v10
    v_dot2c_f32_bf16 v245, v131, v131
    s_waitcnt lgkmcnt(2)
    v_dot2c_f32_bf16 v244, v132, v10
    v_dot2c_f32_bf16 v245, v132, v132
    v_dot2c_f32_bf16 v244, v133, v10
    v_dot2c_f32_bf16 v245, v133, v133
    v_dot2c_f32_bf16 v244, v134, v10
    v_dot2c_f32_bf16 v245, v134, v134
    v_dot2c_f32_bf16 v244, v135, v10
    v_dot2c_f32_bf16 v245, v135, v135
    s_waitcnt lgkmcnt(1)
    v_dot2c_f32_bf16 v244, v136, v10
    v_dot2c_f32_bf16 v245, v136, v136
    v_dot2c_f32_bf16 v244, v137, v10
    v_dot2c_f32_bf16 v245, v137, v137
    v_dot2c_f32_bf16 v244, v138, v10
    v_dot2c_f32_bf16 v245, v138, v138
    v_dot2c_f32_bf16 v244, v139, v10
    v_dot2c_f32_bf16 v245, v139, v139
    s_waitcnt lgkmcnt(0)
    v_dot2c_f32_bf16 v244, v140, v10
    v_dot2c_f32_bf16 v245, v140, v140
    v_dot2c_f32_bf16 v244, v141, v10
    v_dot2c_f32_bf16 v245, v141, v141
    v_dot2c_f32_bf16 v244, v142, v10
    v_dot2c_f32_bf16 v245, v142, v142
    v_dot2c_f32_bf16 v244, v143, v10
    v_dot2c_f32_bf16 v245, v143, v143
    buffer_load_dword v0, v253, s[92:95], s49 offen
    buffer_load_dword v0, v252, s[32:35], s84 offen
    buffer_load_ushort v248, v13, s[40:43], s70 offen offset:0
    buffer_load_ushort v249, v13, s[40:43], s70 offen offset:64
    buffer_load_ushort v250, v13, s[40:43], s71 offen offset:0
    buffer_load_ushort v251, v13, s[40:43], s71 offen offset:64
    v_mov_b32 v11, 0
    global_load_dword v253, v11, s[22:23] sc1
    s_waitcnt lgkmcnt(0)
    s_barrier
    s_setprio 3
    ds_read_b64_tr_b16 v[144:145], v208 offset:0
    ds_read_b64_tr_b16 v[146:147], v208 offset:256
    ds_read_b64_tr_b16 v[148:149], v208 offset:512
    ds_read_b64_tr_b16 v[150:151], v208 offset:768
    ds_read_b64_tr_b16 v[152:153], v208 offset:1024
    ds_read_b64_tr_b16 v[154:155], v208 offset:1280
    ds_read_b64_tr_b16 v[156:157], v208 offset:1536
    ds_read_b64_tr_b16 v[158:159], v208 offset:1792
    ds_read_b64_tr_b16 v[160:161], v208 offset:16384
    ds_read_b64_tr_b16 v[162:163], v208 offset:16640
    ds_read_b64_tr_b16 v[164:165], v208 offset:16896
    ds_read_b64_tr_b16 v[166:167], v208 offset:17152
    ds_read_b64_tr_b16 v[168:169], v208 offset:17408
    ds_read_b64_tr_b16 v[170:171], v208 offset:17664
    s_waitcnt lgkmcnt(12)
    v_mfma_f32_32x32x16_bf16 v[176:191], v[16:19], v[144:147], 0
    v_mfma_f32_16x16x32_bf16 v[220:223], v[216:219], v[144:147], 0
    ds_read_b64_tr_b16 v[172:173], v208 offset:17920
    ds_read_b64_tr_b16 v[174:175], v208 offset:18176
    s_waitcnt lgkmcnt(12)
    v_mfma_f32_32x32x16_bf16 v[192:207], v[16:19], v[148:151], 0
    v_mfma_f32_16x16x32_bf16 v[224:227], v[216:219], v[148:151], 0
    ds_read_b64_tr_b16 v[144:145], v209 offset:0
    ds_read_b64_tr_b16 v[146:147], v209 offset:256
    s_waitcnt lgkmcnt(12)
    v_mfma_f32_32x32x16_bf16 v[176:191], v[20:23], v[152:155], v[176:191]
    v_mfma_f32_16x16x32_bf16 v[220:223], v[216:219], v[152:155], v[220:223]
    ds_read_b64_tr_b16 v[148:149], v209 offset:512
    ds_read_b64_tr_b16 v[150:151], v209 offset:768
    s_waitcnt lgkmcnt(12)
    v_mfma_f32_32x32x16_bf16 v[192:207], v[20:23], v[156:159], v[192:207]
    v_mfma_f32_16x16x32_bf16 v[224:227], v[216:219], v[156:159], v[224:227]
    ds_read_b64_tr_b16 v[152:153], v209 offset:1024
    ds_read_b64_tr_b16 v[154:155], v209 offset:1280
    s_waitcnt lgkmcnt(12)
    v_mfma_f32_32x32x16_bf16 v[176:191], v[24:27], v[160:163], v[176:191]
    v_mfma_f32_16x16x32_bf16 v[220:223], v[216:219], v[160:163], v[220:223]
    ds_read_b64_tr_b16 v[156:157], v209 offset:1536
    ds_read_b64_tr_b16 v[158:159], v209 offset:1792
    s_waitcnt lgkmcnt(12)
    v_mfma_f32_32x32x16_bf16 v[192:207], v[24:27], v[164:167], v[192:207]
    v_mfma_f32_16x16x32_bf16 v[224:227], v[216:219], v[164:167], v[224:227]
    ds_read_b64_tr_b16 v[160:161], v209 offset:16384
    ds_read_b64_tr_b16 v[162:163], v209 offset:16640
    s_waitcnt lgkmcnt(12)
    v_mfma_f32_32x32x16_bf16 v[176:191], v[28:31], v[168:171], v[176:191]
    v_mfma_f32_16x16x32_bf16 v[220:223], v[216:219], v[168:171], v[220:223]
    ds_read_b64_tr_b16 v[164:165], v209 offset:16896
    ds_read_b64_tr_b16 v[166:167], v209 offset:17152
    s_waitcnt lgkmcnt(12)
    v_mfma_f32_32x32x16_bf16 v[192:207], v[28:31], v[172:175], v[192:207]
    v_mfma_f32_16x16x32_bf16 v[224:227], v[216:219], v[172:175], v[224:227]
    ds_read_b64_tr_b16 v[168:169], v209 offset:17408
    ds_read_b64_tr_b16 v[170:171], v209 offset:17664
    s_waitcnt lgkmcnt(12)
    v_mfma_f32_32x32x16_bf16 v[176:191], v[32:35], v[144:147], v[176:191]
    ds_read_b64_tr_b16 v[172:173], v209 offset:17920
    ds_read_b64_tr_b16 v[174:175], v209 offset:18176
    s_waitcnt lgkmcnt(12)
    v_mfma_f32_32x32x16_bf16 v[192:207], v[32:35], v[148:151], v[192:207]
    ds_read_b64_tr_b16 v[144:145], v210 offset:0
    ds_read_b64_tr_b16 v[146:147], v210 offset:256
    s_waitcnt lgkmcnt(12)
    v_mfma_f32_32x32x16_bf16 v[176:191], v[36:39], v[152:155], v[176:191]
    ds_read_b64_tr_b16 v[148:149], v210 offset:512
    ds_read_b64_tr_b16 v[150:151], v210 offset:768
    s_waitcnt lgkmcnt(12)
    v_mfma_f32_32x32x16_bf16 v[192:207], v[36:39], v[156:159], v[192:207]
    s_lshl_b32 s61, s26, 9
    s_add_u32 s61, s61, 69632
    v_lshl_add_u32 v11, v1, 2, s61
    ds_write_b32 v11, v244
    ds_write_b32 v11, v245 offset:256
    ds_read_b64_tr_b16 v[152:153], v210 offset:1024
    ds_read_b64_tr_b16 v[154:155], v210 offset:1280
    s_waitcnt lgkmcnt(14)
    v_mfma_f32_32x32x16_bf16 v[176:191], v[40:43], v[160:163], v[176:191]
    ds_read_b64_tr_b16 v[156:157], v210 offset:1536
    ds_read_b64_tr_b16 v[158:159], v210 offset:1792
    s_waitcnt lgkmcnt(14)
    v_mfma_f32_32x32x16_bf16 v[192:207], v[40:43], v[164:167], v[192:207]
    ds_read_b64_tr_b16 v[160:161], v210 offset:16384
    ds_read_b64_tr_b16 v[162:163], v210 offset:16640
    s_waitcnt lgkmcnt(14)
    v_mfma_f32_32x32x16_bf16 v[176:191], v[44:47], v[168:171], v[176:191]
    ds_read_b64_tr_b16 v[164:165], v210 offset:16896
    ds_read_b64_tr_b16 v[166:167], v210 offset:17152
    s_waitcnt lgkmcnt(14)
    v_mfma_f32_32x32x16_bf16 v[192:207], v[44:47], v[172:175], v[192:207]
    ds_read_b64_tr_b16 v[168:169], v210 offset:17408
    ds_read_b64_tr_b16 v[170:171], v210 offset:17664
    s_waitcnt lgkmcnt(14)
    v_mfma_f32_32x32x16_bf16 v[176:191], v[48:51], v[144:147], v[176:191]
    ds_read_b64_tr_b16 v[172:173], v210 offset:17920
    ds_read_b64_tr_b16 v[174:175], v210 offset:18176
    s_waitcnt lgkmcnt(14)
    v_mfma_f32_32x32x16_bf16 v[192:207], v[48:51], v[148:151], v[192:207]
    ds_read_b64_tr_b16 v[144:145], v211 offset:0
    ds_read_b64_tr_b16 v[146:147], v211 offset:256
    s_waitcnt lgkmcnt(12)
    v_mfma_f32_32x32x16_bf16 v[176:191], v[52:55], v[152:155], v[176:191]
    ds_read_b64_tr_b16 v[148:149], v211 offset:512
    ds_read_b64_tr_b16 v[150:151], v211 offset:768
    s_waitcnt lgkmcnt(12)
    v_mfma_f32_32x32x16_bf16 v[192:207], v[52:55], v[156:159], v[192:207]
    ds_read_b64_tr_b16 v[152:153], v211 offset:1024
    ds_read_b64_tr_b16 v[154:155], v211 offset:1280
    s_waitcnt lgkmcnt(12)
    v_mfma_f32_32x32x16_bf16 v[176:191], v[56:59], v[160:163], v[176:191]
    ds_read_b64_tr_b16 v[156:157], v211 offset:1536
    ds_read_b64_tr_b16 v[158:159], v211 offset:1792
    s_waitcnt lgkmcnt(12)
    v_mfma_f32_32x32x16_bf16 v[192:207], v[56:59], v[164:167], v[192:207]
    ds_read_b64_tr_b16 v[160:161], v211 offset:16384
    ds_read_b64_tr_b16 v[162:163], v211 offset:16640
    s_waitcnt lgkmcnt(12)
    v_mfma_f32_32x32x16_bf16 v[176:191], v[60:63], v[168:171], v[176:191]
    ds_read_b64_tr_b16 v[164:165], v211 offset:16896
    ds_read_b64_tr_b16 v[166:167], v211 offset:17152
    s_waitcnt lgkmcnt(12)
    v_mfma_f32_32x32x16_bf16 v[192:207], v[60:63], v[172:175], v[192:207]
    ds_read_b64_tr_b16 v[168:169], v211 offset:17408
    ds_read_b64_tr_b16 v[170:171], v211 offset:17664
    s_waitcnt lgkmcnt(12)
    v_mfma_f32_32x32x16_bf16 v[176:191], v[64:67], v[144:147], v[176:191]
    ds_read_b64_tr_b16 v[172:173], v211 offset:17920
    ds_read_b64_tr_b16 v[174:175], v211 offset:18176
    s_waitcnt lgkmcnt(12)
    v_mfma_f32_32x32x16_bf16 v[192:207], v[64:67], v[148:151], v[192:207]
    s_waitcnt lgkmcnt(10)
    v_mfma_f32_32x32x16_bf16 v[176:191], v[68:71], v[152:155], v[176:191]
    s_waitcnt lgkmcnt(8)
    v_mfma_f32_32x32x16_bf16 v[192:207], v[68:71], v[156:159], v[192:207]
    s_waitcnt lgkmcnt(0)
    s_barrier
    ds_read_b64_tr_b16 v[144:145], v208 offset:32768
    ds_read_b64_tr_b16 v[146:147], v208 offset:33024
    ds_read_b64_tr_b16 v[148:149], v208 offset:33280
    ds_read_b64_tr_b16 v[150:151], v208 offset:33536
    ds_read_b64_tr_b16 v[152:153], v208 offset:33792
    ds_read_b64_tr_b16 v[154:155], v208 offset:34048
    v_mfma_f32_32x32x16_bf16 v[176:191], v[72:75], v[160:163], v[176:191]
    ds_read_b64_tr_b16 v[156:157], v208 offset:34304
    ds_read_b64_tr_b16 v[158:159], v208 offset:34560
    v_mfma_f32_32x32x16_bf16 v[192:207], v[72:75], v[164:167], v[192:207]
    ds_read_b64_tr_b16 v[160:161], v208 offset:49152
    ds_read_b64_tr_b16 v[162:163], v208 offset:49408
    v_mfma_f32_32x32x16_bf16 v[176:191], v[76:79], v[168:171], v[176:191]
    ds_read_b64_tr_b16 v[164:165], v208 offset:49664
    ds_read_b64_tr_b16 v[166:167], v208 offset:49920
    v_mfma_f32_32x32x16_bf16 v[192:207], v[76:79], v[172:175], v[192:207]
    ds_read_b64_tr_b16 v[168:169], v208 offset:50176
    ds_read_b64_tr_b16 v[170:171], v208 offset:50432
    s_waitcnt lgkmcnt(12)
    v_mfma_f32_32x32x16_bf16 v[176:191], v[80:83], v[144:147], v[176:191]
    v_mfma_f32_16x16x32_bf16 v[220:223], v[216:219], v[144:147], v[220:223]
    ds_read_b64_tr_b16 v[172:173], v208 offset:50688
    ds_read_b64_tr_b16 v[174:175], v208 offset:50944
    s_waitcnt lgkmcnt(12)
    v_mfma_f32_32x32x16_bf16 v[192:207], v[80:83], v[148:151], v[192:207]
    v_mfma_f32_16x16x32_bf16 v[224:227], v[216:219], v[148:151], v[224:227]
    ds_read_b64_tr_b16 v[144:145], v209 offset:32768
    ds_read_b64_tr_b16 v[146:147], v209 offset:33024
    s_waitcnt lgkmcnt(12)
    v_mfma_f32_32x32x16_bf16 v[176:191], v[84:87], v[152:155], v[176:191]
    v_mfma_f32_16x16x32_bf16 v[220:223], v[216:219], v[152:155], v[220:223]
    ds_read_b64_tr_b16 v[148:149], v209 offset:33280
    ds_read_b64_tr_b16 v[150:151], v209 offset:33536
    s_waitcnt lgkmcnt(12)
    v_mfma_f32_32x32x16_bf16 v[192:207], v[84:87], v[156:159], v[192:207]
    v_mfma_f32_16x16x32_bf16 v[224:227], v[216:219], v[156:159], v[224:227]
    ds_read_b64_tr_b16 v[152:153], v209 offset:33792
    ds_read_b64_tr_b16 v[154:155], v209 offset:34048
    s_waitcnt lgkmcnt(12)
    v_mfma_f32_32x32x16_bf16 v[176:191], v[88:91], v[160:163], v[176:191]
    v_mfma_f32_16x16x32_bf16 v[220:223], v[216:219], v[160:163], v[220:223]
    ds_read_b64_tr_b16 v[156:157], v209 offset:34304
    ds_read_b64_tr_b16 v[158:159], v209 offset:34560
    s_waitcnt lgkmcnt(12)
    v_mfma_f32_32x32x16_bf16 v[192:207], v[88:91], v[164:167], v[192:207]
    v_mfma_f32_16x16x32_bf16 v[224:227], v[216:219], v[164:167], v[224:227]
    ds_read_b64_tr_b16 v[160:161], v209 offset:49152
    ds_read_b64_tr_b16 v[162:163], v209 offset:49408
    s_waitcnt lgkmcnt(12)
    v_mfma_f32_32x32x16_bf16 v[176:191], v[92:95], v[168:171], v[176:191]
    v_mfma_f32_16x16x32_bf16 v[220:223], v[216:219], v[168:171], v[220:223]
    ds_read_b64_tr_b16 v[164:165], v209 offset:49664
    ds_read_b64_tr_b16 v[166:167], v209 offset:49920
    s_waitcnt lgkmcnt(12)
    v_mfma_f32_32x32x16_bf16 v[192:207], v[92:95], v[172:175], v[192:207]
    v_mfma_f32_16x16x32_bf16 v[224:227], v[216:219], v[172:175], v[224:227]
    ds_read_b64_tr_b16 v[168:169], v209 offset:50176
    ds_read_b64_tr_b16 v[170:171], v209 offset:50432
    s_waitcnt lgkmcnt(12)
    v_mfma_f32_32x32x16_bf16 v[176:191], v[96:99], v[144:147], v[176:191]
    ds_read_b64_tr_b16 v[172:173], v209 offset:50688
    ds_read_b64_tr_b16 v[174:175], v209 offset:50944
    s_waitcnt lgkmcnt(12)
    v_mfma_f32_32x32x16_bf16 v[192:207], v[96:99], v[148:151], v[192:207]
    ds_read_b64_tr_b16 v[144:145], v210 offset:32768
    ds_read_b64_tr_b16 v[146:147], v210 offset:33024
    s_waitcnt lgkmcnt(12)
    v_mfma_f32_32x32x16_bf16 v[176:191], v[100:103], v[152:155], v[176:191]
    ds_read_b64_tr_b16 v[148:149], v210 offset:33280
    ds_read_b64_tr_b16 v[150:151], v210 offset:33536
    s_waitcnt lgkmcnt(12)
    v_mfma_f32_32x32x16_bf16 v[192:207], v[100:103], v[156:159], v[192:207]
    ds_read_b64_tr_b16 v[152:153], v210 offset:33792
    ds_read_b64_tr_b16 v[154:155], v210 offset:34048
    s_waitcnt lgkmcnt(12)
    v_mfma_f32_32x32x16_bf16 v[176:191], v[104:107], v[160:163], v[176:191]
    ds_read_b64_tr_b16 v[156:157], v210 offset:34304
    ds_read_b64_tr_b16 v[158:159], v210 offset:34560
    s_waitcnt lgkmcnt(12)
    v_mfma_f32_32x32x16_bf16 v[192:207], v[104:107], v[164:167], v[192:207]
    ds_read_b64_tr_b16 v[160:161], v210 offset:49152
    ds_read_b64_tr_b16 v[162:163], v210 offset:49408
    s_waitcnt lgkmcnt(12)
    v_mfma_f32_32x32x16_bf16 v[176:191], v[108:111], v[168:171], v[176:191]
    ds_read_b64_tr_b16 v[164:165], v210 offset:49664
    ds_read_b64_tr_b16 v[166:167], v210 offset:49920
    s_waitcnt lgkmcnt(12)
    v_mfma_f32_32x32x16_bf16 v[192:207], v[108:111], v[172:175], v[192:207]
    ds_read_b64_tr_b16 v[168:169], v210 offset:50176
    ds_read_b64_tr_b16 v[170:171], v210 offset:50432
    s_waitcnt lgkmcnt(12)
    v_mfma_f32_32x32x16_bf16 v[176:191], v[112:115], v[144:147], v[176:191]
    ds_read_b64_tr_b16 v[172:173], v210 offset:50688
    ds_read_b64_tr_b16 v[174:175], v210 offset:50944
    s_waitcnt lgkmcnt(12)
    v_mfma_f32_32x32x16_bf16 v[192:207], v[112:115], v[148:151], v[192:207]
    v_cndmask_b32 v11, v220, v221, s[52:53]
    ds_write_b32 v5, v11 offset:0
    ds_read_b64_tr_b16 v[144:145], v211 offset:32768
    ds_read_b64_tr_b16 v[146:147], v211 offset:33024
    s_waitcnt lgkmcnt(13)
    v_mfma_f32_32x32x16_bf16 v[176:191], v[116:119], v[152:155], v[176:191]
    ds_read_b64_tr_b16 v[148:149], v211 offset:33280
    ds_read_b64_tr_b16 v[150:151], v211 offset:33536
    s_waitcnt lgkmcnt(13)
    v_mfma_f32_32x32x16_bf16 v[192:207], v[116:119], v[156:159], v[192:207]
    v_cndmask_b32 v12, v224, v225, s[52:53]
    ds_write_b32 v5, v12 offset:512
    ds_read_b64_tr_b16 v[152:153], v211 offset:33792
    ds_read_b64_tr_b16 v[154:155], v211 offset:34048
    s_waitcnt lgkmcnt(14)
    v_mfma_f32_32x32x16_bf16 v[176:191], v[120:123], v[160:163], v[176:191]
    ds_read_b64_tr_b16 v[156:157], v211 offset:34304
    ds_read_b64_tr_b16 v[158:159], v211 offset:34560
    s_waitcnt lgkmcnt(14)
    v_mfma_f32_32x32x16_bf16 v[192:207], v[120:123], v[164:167], v[192:207]
    ds_read_b64_tr_b16 v[160:161], v211 offset:49152
    ds_read_b64_tr_b16 v[162:163], v211 offset:49408
    s_waitcnt lgkmcnt(14)
    v_mfma_f32_32x32x16_bf16 v[176:191], v[124:127], v[168:171], v[176:191]
    ds_read_b64_tr_b16 v[164:165], v211 offset:49664
    ds_read_b64_tr_b16 v[166:167], v211 offset:49920
    s_waitcnt lgkmcnt(14)
    v_mfma_f32_32x32x16_bf16 v[192:207], v[124:127], v[172:175], v[192:207]
    ds_read_b64_tr_b16 v[168:169], v211 offset:50176
    ds_read_b64_tr_b16 v[170:171], v211 offset:50432
    s_waitcnt lgkmcnt(13)
    v_mfma_f32_32x32x16_bf16 v[176:191], v[128:131], v[144:147], v[176:191]
    ds_read_b64_tr_b16 v[172:173], v211 offset:50688
    ds_read_b64_tr_b16 v[174:175], v211 offset:50944
    s_waitcnt lgkmcnt(13)
    v_mfma_f32_32x32x16_bf16 v[192:207], v[128:131], v[148:151], v[192:207]
    s_waitcnt lgkmcnt(10)
    v_mfma_f32_32x32x16_bf16 v[176:191], v[132:135], v[152:155], v[176:191]
    s_waitcnt lgkmcnt(8)
    v_mfma_f32_32x32x16_bf16 v[192:207], v[132:135], v[156:159], v[192:207]
    s_waitcnt lgkmcnt(0)
    s_barrier
    v_mfma_f32_32x32x16_bf16 v[176:191], v[136:139], v[160:163], v[176:191]
    v_mfma_f32_32x32x16_bf16 v[192:207], v[136:139], v[164:167], v[192:207]
    v_mfma_f32_32x32x16_bf16 v[176:191], v[140:143], v[168:171], v[176:191]
    v_mfma_f32_32x32x16_bf16 v[192:207], v[140:143], v[172:175], v[192:207]
    s_setprio 0
    s_waitcnt vmcnt(0)
    v_readfirstlane_b32 s100, v253
    s_nop 0
    s_cmp_lg_u32 s100, 0
    s_cbranch_scc1 L_k1_ttx1d
    s_mov_b32 s62, 0x40000
    v_mov_b32 v11, 0
L_k1_ttx1:
    global_load_dword v253, v11, s[22:23] sc1
    s_waitcnt vmcnt(0)
    v_readfirstlane_b32 s100, v253
    s_sub_u32 s62, s62, 1
    s_cbranch_scc1 L_k1_ttx1d
    s_cmp_eq_u32 s100, 0
    s_cbranch_scc1 L_k1_ttx1
L_k1_ttx1d:
    ds_read_b128 v[160:163], v6 offset:0
    ds_read_b128 v[164:167], v6 offset:512
    v_mov_b32 v228, 0
    v_mov_b32 v232, 0
    v_mov_b32 v236, 0
    v_mov_b32 v229, 0
    v_mov_b32 v233, 0
    v_mov_b32 v237, 0
    v_mov_b32 v230, 0
    v_mov_b32 v234, 0
    v_mov_b32 v238, 0
    v_mov_b32 v231, 0
    v_mov_b32 v235, 0
    v_mov_b32 v239, 0
    s_xor_b32 s61, s26, 4
    s_lshl_b32 s61, s61, 9
    s_add_u32 s61, s61, 69632
    v_lshl_add_u32 v153, v1, 2, s61
    ds_read_b32 v154, v153
    ds_read_b32 v155, v153 offset:256
    s_waitcnt lgkmcnt(0)
    v_add_f32 v244, v244, v154
    v_add_f32 v245, v245, v155
    v_mov_b32 v154, v244
    v_mov_b32 v155, v245
    s_nop 0
    v_permlane32_swap_b32 v244, v154
    v_permlane32_swap_b32 v245, v155
    v_add_f32 v244, v244, v154
    v_add_f32 v245, v245, v155
    v_mul_f32 v244, 0x3b000000, v244
    v_mul_f32 v245, 0x3b000000, v245
    v_fma_f32 v245, -v244, v244, v245
    v_max_f32 v245, 0, v245
    v_cvt_pk_bf16_f32 v154, v245, -v244
    v_lshlrev_b32 v155, 16, v154
    v_add_f32 v155, 0x3727c5ac, v155
    v_cvt_pk_bf16_f32 v155, v155, v155
    v_lshlrev_b32 v155, 16, v155
    v_sqrt_f32 v155, v155
    s_nop 0
    v_cvt_pk_bf16_f32 v155, v155, v155
    v_and_b32 v241, 0xffff0000, v155
    v_rcp_f32 v240, v241
    v_lshrrev_b32 v155, 16, v154
    v_cmp_gt_u32 vcc, 32, v1
    v_lshl_or_b32 v156, v155, 16, v155
    v_or_b32 v157, v241, v155
    v_cndmask_b32 v228, 0, v156, vcc
    v_cndmask_b32 v229, 0, v157, vcc
    v_mul_f32 v242, 0xc0135761, v240
    v_mul_f32 v243, v240, v240
    v_mul_f32 v243, v243, v240
    v_mul_f32 v243, 0xbdd2d3e8, v243
    s_lshl_b32 s61, s26, 7
    s_add_u32 s61, s61, 73728
    v_and_b32 v152, 31, v1
    v_lshl_add_u32 v153, v152, 2, s61
    ds_write_b32 v153, v240
    v_lshrrev_b32 v247, 5, v1
    v_lshl_add_u32 v247, v247, 4, s61
    v_add_f32 v160, v160, v161
    v_add_f32 v162, v162, v163
    v_add_f32 v144, v160, v162
    v_and_b32 v145, 0xffff0000, v144
    v_sub_f32 v146, v144, v145
    v_and_b32 v147, 0xffff0000, v146
    v_sub_f32 v146, v146, v147
    v_lshrrev_b32 v145, 16, v145
    v_or_b32 v232, v145, v147
    v_lshrrev_b32 v233, 16, v146
    v_add_f32 v164, v164, v165
    v_add_f32 v166, v166, v167
    v_add_f32 v144, v164, v166
    v_and_b32 v145, 0xffff0000, v144
    v_sub_f32 v146, v144, v145
    v_and_b32 v147, 0xffff0000, v146
    v_sub_f32 v146, v146, v147
    v_lshrrev_b32 v145, 16, v145
    v_or_b32 v236, v145, v147
    v_lshrrev_b32 v237, 16, v146
    v_mfma_f32_32x32x16_bf16 v[176:191], v[228:231], v[232:235], v[176:191]
    s_nop 0
    v_mfma_f32_32x32x16_bf16 v[192:207], v[228:231], v[236:239], v[192:207]
    ds_read_b128 v[144:147], v247 offset:0
    ds_read_b128 v[148:151], v247 offset:32
    ds_read_b128 v[152:155], v247 offset:64
    ds_read_b128 v[156:159], v247 offset:96
    s_waitcnt lgkmcnt(0)
    s_nop 4
    v_mul_f32 v176, v176, v144
    v_mul_f32 v177, v177, v145
    v_mul_f32 v178, v178, v146
    v_mul_f32 v179, v179, v147
    v_mul_f32 v180, v180, v148
    v_mul_f32 v181, v181, v149
    v_mul_f32 v182, v182, v150
    v_mul_f32 v183, v183, v151
    v_cvt_pk_bf16_f32 v160, v176, v177
    v_cvt_pk_bf16_f32 v161, v178, v179
    v_cvt_pk_bf16_f32 v162, v180, v181
    v_cvt_pk_bf16_f32 v163, v182, v183
    s_add_u32 s61, s68, 4194304
    buffer_store_dwordx4 v[160:163], v7, s[36:39], s61 offen offset:0 sc1
    v_mul_f32 v184, v184, v152
    v_mul_f32 v185, v185, v153
    v_mul_f32 v186, v186, v154
    v_mul_f32 v187, v187, v155
    v_mul_f32 v188, v188, v156
    v_mul_f32 v189, v189, v157
    v_mul_f32 v190, v190, v158
    v_mul_f32 v191, v191, v159
    v_cvt_pk_bf16_f32 v164, v184, v185
    v_cvt_pk_bf16_f32 v165, v186, v187
    v_cvt_pk_bf16_f32 v166, v188, v189
    v_cvt_pk_bf16_f32 v167, v190, v191
    s_add_u32 s61, s68, 4194304
    buffer_store_dwordx4 v[164:167], v7, s[36:39], s61 offen offset:512 sc1
    v_mul_f32 v192, v192, v144
    v_mul_f32 v193, v193, v145
    v_mul_f32 v194, v194, v146
    v_mul_f32 v195, v195, v147
    v_mul_f32 v196, v196, v148
    v_mul_f32 v197, v197, v149
    v_mul_f32 v198, v198, v150
    v_mul_f32 v199, v199, v151
    v_cvt_pk_bf16_f32 v168, v192, v193
    v_cvt_pk_bf16_f32 v169, v194, v195
    v_cvt_pk_bf16_f32 v170, v196, v197
    v_cvt_pk_bf16_f32 v171, v198, v199
    s_add_u32 s61, s68, 4325376
    buffer_store_dwordx4 v[168:171], v7, s[36:39], s61 offen offset:0 sc1
    v_mul_f32 v200, v200, v152
    v_mul_f32 v201, v201, v153
    v_mul_f32 v202, v202, v154
    v_mul_f32 v203, v203, v155
    v_mul_f32 v204, v204, v156
    v_mul_f32 v205, v205, v157
    v_mul_f32 v206, v206, v158
    v_mul_f32 v207, v207, v159
    v_cvt_pk_bf16_f32 v172, v200, v201
    v_cvt_pk_bf16_f32 v173, v202, v203
    v_cvt_pk_bf16_f32 v174, v204, v205
    v_cvt_pk_bf16_f32 v175, v206, v207
    s_add_u32 s61, s68, 4325376
    buffer_store_dwordx4 v[172:175], v7, s[36:39], s61 offen offset:512 sc1
    s_waitcnt lgkmcnt(0)
    s_barrier
    s_waitcnt vmcnt(0)
    s_add_u32 s61, s48, 20193280
    v_lshlrev_b32 v11, 2, v1
    v_mov_b32 v12, s100
    s_mov_b32 exec_hi, 0
    buffer_store_dword v12, v11, s[36:39], s61 offen sc1
    s_mov_b64 exec, -1
    s_add_u32 m0, s65, 0
    s_mov_b32 s60, s58
    buffer_load_dwordx4 v3, s[32:35], s60 offen lds
    s_add_u32 m0, s65, 1024
    s_addk_i32 s60, 28672
    buffer_load_dwordx4 v3, s[32:35], s60 offen lds
    s_add_u32 m0, s65, 2048
    s_addk_i32 s60, 28672
    buffer_load_dwordx4 v3, s[32:35], s60 offen lds
    s_add_u32 m0, s65, 3072
    s_addk_i32 s60, 28672
    buffer_load_dwordx4 v3, s[32:35], s60 offen lds
    s_add_u32 m0, s65, 4096
    s_addk_i32 s60, 28672
    buffer_load_dwordx4 v3, s[32:35], s60 offen lds
    s_add_u32 m0, s65, 5120
    s_addk_i32 s60, 28672
    buffer_load_dwordx4 v3, s[32:35], s60 offen lds
    s_add_u32 m0, s65, 6144
    s_addk_i32 s60, 28672
    buffer_load_dwordx4 v3, s[32:35], s60 offen lds
    s_add_u32 m0, s65, 7168
    s_addk_i32 s60, 28672
    buffer_load_dwordx4 v3, s[32:35], s60 offen lds
    s_lshl_b32 s63, s27, 12
    s_add_u32 m0, s63, 77824
    s_add_u32 s63, s54, 0
    buffer_load_dwordx4 v8, s[80:83], s63 offen lds
    s_lshl_b32 s63, s27, 12
    s_add_u32 m0, s63, 78848
    s_add_u32 s63, s54, 4096
    buffer_load_dwordx4 v8, s[80:83], s63 offen lds
    s_lshl_b32 s63, s27, 12
    s_add_u32 m0, s63, 79872
    s_add_u32 s63, s54, 8192
    buffer_load_dwordx4 v8, s[80:83], s63 offen lds
    s_lshl_b32 s63, s27, 12
    s_add_u32 m0, s63, 80896
    s_add_u32 s63, s54, 12288
    buffer_load_dwordx4 v8, s[80:83], s63 offen lds
    s_add_u32 m0, s65, 32768
    s_add_u32 s60, s58, 917504
    buffer_load_dwordx4 v3, s[32:35], s60 offen lds
    s_add_u32 m0, s65, 33792
    s_addk_i32 s60, 28672
    buffer_load_dwordx4 v3, s[32:35], s60 offen lds
    s_add_u32 m0, s65, 34816
    s_addk_i32 s60, 28672
    buffer_load_dwordx4 v3, s[32:35], s60 offen lds
    s_add_u32 m0, s65, 35840
    s_addk_i32 s60, 28672
    buffer_load_dwordx4 v3, s[32:35], s60 offen lds
    s_add_u32 m0, s65, 36864
    s_addk_i32 s60, 28672
    buffer_load_dwordx4 v3, s[32:35], s60 offen lds
    s_add_u32 m0, s65, 37888
    s_addk_i32 s60, 28672
    buffer_load_dwordx4 v3, s[32:35], s60 offen lds
    s_add_u32 m0, s65, 38912
    s_addk_i32 s60, 28672
    buffer_load_dwordx4 v3, s[32:35], s60 offen lds
    s_add_u32 m0, s65, 39936
    s_addk_i32 s60, 28672
    buffer_load_dwordx4 v3, s[32:35], s60 offen lds
    s_waitcnt vmcnt(8)
    ds_read_b64_tr_b16 v[144:145], v9 offset:0
    ds_read_b64_tr_b16 v[146:147], v9 offset:2048
    ds_read_b64_tr_b16 v[148:149], v9 offset:64
    ds_read_b64_tr_b16 v[150:151], v9 offset:2112
    ds_read_b64_tr_b16 v[152:153], v9 offset:128
    ds_read_b64_tr_b16 v[154:155], v9 offset:2176
    ds_read_b64_tr_b16 v[156:157], v9 offset:192
    ds_read_b64_tr_b16 v[158:159], v9 offset:2240
    s_waitcnt lgkmcnt(6)
    s_add_u32 s63, s55, 0
    buffer_store_dwordx4 v[144:147], v2, s[36:39], s63 offen sc1
    s_waitcnt lgkmcnt(4)
    s_add_u32 s63, s55, 147456
    buffer_store_dwordx4 v[148:151], v2, s[36:39], s63 offen sc1
    s_waitcnt lgkmcnt(2)
    s_add_u32 s63, s55, 294912
    buffer_store_dwordx4 v[152:155], v2, s[36:39], s63 offen sc1
    s_waitcnt lgkmcnt(0)
    s_add_u32 s63, s55, 442368
    buffer_store_dwordx4 v[156:159], v2, s[36:39], s63 offen sc1
    s_lshl_b32 s63, s27, 12
    s_add_u32 m0, s63, 77824
    s_add_u32 s63, s54, 16384
    buffer_load_dwordx4 v8, s[80:83], s63 offen lds
    s_lshl_b32 s63, s27, 12
    s_add_u32 m0, s63, 78848
    s_add_u32 s63, s54, 20480
    buffer_load_dwordx4 v8, s[80:83], s63 offen lds
    s_lshl_b32 s63, s27, 12
    s_add_u32 m0, s63, 79872
    s_add_u32 s63, s54, 24576
    buffer_load_dwordx4 v8, s[80:83], s63 offen lds
    s_lshl_b32 s63, s27, 12
    s_add_u32 m0, s63, 80896
    s_add_u32 s63, s54, 28672
    buffer_load_dwordx4 v8, s[80:83], s63 offen lds
    s_waitcnt lgkmcnt(0)
    s_barrier
    s_setprio 3
    ds_read_b64_tr_b16 v[144:145], v208 offset:0
    ds_read_b64_tr_b16 v[146:147], v208 offset:256
    ds_read_b64_tr_b16 v[148:149], v208 offset:512
    ds_read_b64_tr_b16 v[150:151], v208 offset:768
    ds_read_b64_tr_b16 v[152:153], v208 offset:1024
    ds_read_b64_tr_b16 v[154:155], v208 offset:1280
    ds_read_b64_tr_b16 v[156:157], v208 offset:1536
    ds_read_b64_tr_b16 v[158:159], v208 offset:1792
    ds_read_b64_tr_b16 v[160:161], v208 offset:16384
    ds_read_b64_tr_b16 v[162:163], v208 offset:16640
    ds_read_b64_tr_b16 v[164:165], v208 offset:16896
    ds_read_b64_tr_b16 v[166:167], v208 offset:17152
    ds_read_b64_tr_b16 v[168:169], v208 offset:17408
    ds_read_b64_tr_b16 v[170:171], v208 offset:17664
    s_waitcnt lgkmcnt(12)
    v_mfma_f32_32x32x16_bf16 v[176:191], v[144:147], v[16:19], 0
    v_mfma_f32_16x16x32_bf16 v[220:223], v[216:219], v[144:147], 0
    ds_read_b64_tr_b16 v[172:173], v208 offset:17920
    ds_read_b64_tr_b16 v[174:175], v208 offset:18176
    s_waitcnt lgkmcnt(12)
    v_mfma_f32_32x32x16_bf16 v[192:207], v[148:151], v[16:19], 0
    v_mfma_f32_16x16x32_bf16 v[224:227], v[216:219], v[148:151], 0
    ds_read_b64_tr_b16 v[144:145], v209 offset:0
    ds_read_b64_tr_b16 v[146:147], v209 offset:256
    s_waitcnt lgkmcnt(12)
    v_mfma_f32_32x32x16_bf16 v[176:191], v[152:155], v[20:23], v[176:191]
    v_mfma_f32_16x16x32_bf16 v[220:223], v[216:219], v[152:155], v[220:223]
    ds_read_b64_tr_b16 v[148:149], v209 offset:512
    ds_read_b64_tr_b16 v[150:151], v209 offset:768
    s_waitcnt lgkmcnt(12)
    v_mfma_f32_32x32x16_bf16 v[192:207], v[156:159], v[20:23], v[192:207]
    v_mfma_f32_16x16x32_bf16 v[224:227], v[216:219], v[156:159], v[224:227]
    ds_read_b64_tr_b16 v[152:153], v209 offset:1024
    ds_read_b64_tr_b16 v[154:155], v209 offset:1280
    s_waitcnt lgkmcnt(12)
    v_mfma_f32_32x32x16_bf16 v[176:191], v[160:163], v[24:27], v[176:191]
    v_mfma_f32_16x16x32_bf16 v[220:223], v[216:219], v[160:163], v[220:223]
    ds_read_b64_tr_b16 v[156:157], v209 offset:1536
    ds_read_b64_tr_b16 v[158:159], v209 offset:1792
    s_waitcnt lgkmcnt(12)
    v_mfma_f32_32x32x16_bf16 v[192:207], v[164:167], v[24:27], v[192:207]
    v_mfma_f32_16x16x32_bf16 v[224:227], v[216:219], v[164:167], v[224:227]
    ds_read_b64_tr_b16 v[160:161], v209 offset:16384
    ds_read_b64_tr_b16 v[162:163], v209 offset:16640
    s_waitcnt lgkmcnt(12)
    v_mfma_f32_32x32x16_bf16 v[176:191], v[168:171], v[28:31], v[176:191]
    v_mfma_f32_16x16x32_bf16 v[220:223], v[216:219], v[168:171], v[220:223]
    ds_read_b64_tr_b16 v[164:165], v209 offset:16896
    ds_read_b64_tr_b16 v[166:167], v209 offset:17152
    s_waitcnt lgkmcnt(12)
    v_mfma_f32_32x32x16_bf16 v[192:207], v[172:175], v[28:31], v[192:207]
    v_mfma_f32_16x16x32_bf16 v[224:227], v[216:219], v[172:175], v[224:227]
    ds_read_b64_tr_b16 v[168:169], v209 offset:17408
    ds_read_b64_tr_b16 v[170:171], v209 offset:17664
    s_waitcnt lgkmcnt(12)
    v_mfma_f32_32x32x16_bf16 v[176:191], v[144:147], v[32:35], v[176:191]
    ds_read_b64_tr_b16 v[172:173], v209 offset:17920
    ds_read_b64_tr_b16 v[174:175], v209 offset:18176
    s_waitcnt lgkmcnt(12)
    v_mfma_f32_32x32x16_bf16 v[192:207], v[148:151], v[32:35], v[192:207]
    ds_read_b64_tr_b16 v[144:145], v210 offset:0
    ds_read_b64_tr_b16 v[146:147], v210 offset:256
    s_waitcnt lgkmcnt(12)
    v_mfma_f32_32x32x16_bf16 v[176:191], v[152:155], v[36:39], v[176:191]
    ds_read_b64_tr_b16 v[148:149], v210 offset:512
    ds_read_b64_tr_b16 v[150:151], v210 offset:768
    s_waitcnt lgkmcnt(12)
    v_mfma_f32_32x32x16_bf16 v[192:207], v[156:159], v[36:39], v[192:207]
    ds_read_b64_tr_b16 v[152:153], v210 offset:1024
    ds_read_b64_tr_b16 v[154:155], v210 offset:1280
    s_waitcnt lgkmcnt(12)
    v_mfma_f32_32x32x16_bf16 v[176:191], v[160:163], v[40:43], v[176:191]
    ds_read_b64_tr_b16 v[156:157], v210 offset:1536
    ds_read_b64_tr_b16 v[158:159], v210 offset:1792
    s_waitcnt lgkmcnt(12)
    v_mfma_f32_32x32x16_bf16 v[192:207], v[164:167], v[40:43], v[192:207]
    ds_read_b64_tr_b16 v[160:161], v210 offset:16384
    ds_read_b64_tr_b16 v[162:163], v210 offset:16640
    s_waitcnt lgkmcnt(12)
    v_mfma_f32_32x32x16_bf16 v[176:191], v[168:171], v[44:47], v[176:191]
    ds_read_b64_tr_b16 v[164:165], v210 offset:16896
    ds_read_b64_tr_b16 v[166:167], v210 offset:17152
    s_waitcnt lgkmcnt(12)
    v_mfma_f32_32x32x16_bf16 v[192:207], v[172:175], v[44:47], v[192:207]
    ds_read_b64_tr_b16 v[168:169], v210 offset:17408
    ds_read_b64_tr_b16 v[170:171], v210 offset:17664
    s_waitcnt lgkmcnt(12)
    v_mfma_f32_32x32x16_bf16 v[176:191], v[144:147], v[48:51], v[176:191]
    ds_read_b64_tr_b16 v[172:173], v210 offset:17920
    ds_read_b64_tr_b16 v[174:175], v210 offset:18176
    s_waitcnt lgkmcnt(12)
    v_mfma_f32_32x32x16_bf16 v[192:207], v[148:151], v[48:51], v[192:207]
    ds_read_b64_tr_b16 v[144:145], v211 offset:0
    ds_read_b64_tr_b16 v[146:147], v211 offset:256
    s_waitcnt lgkmcnt(12)
    v_mfma_f32_32x32x16_bf16 v[176:191], v[152:155], v[52:55], v[176:191]
    ds_read_b64_tr_b16 v[148:149], v211 offset:512
    ds_read_b64_tr_b16 v[150:151], v211 offset:768
    s_waitcnt lgkmcnt(12)
    v_mfma_f32_32x32x16_bf16 v[192:207], v[156:159], v[52:55], v[192:207]
    ds_read_b64_tr_b16 v[152:153], v211 offset:1024
    ds_read_b64_tr_b16 v[154:155], v211 offset:1280
    s_waitcnt lgkmcnt(12)
    v_mfma_f32_32x32x16_bf16 v[176:191], v[160:163], v[56:59], v[176:191]
    ds_read_b64_tr_b16 v[156:157], v211 offset:1536
    ds_read_b64_tr_b16 v[158:159], v211 offset:1792
    s_waitcnt lgkmcnt(12)
    v_mfma_f32_32x32x16_bf16 v[192:207], v[164:167], v[56:59], v[192:207]
    ds_read_b64_tr_b16 v[160:161], v211 offset:16384
    ds_read_b64_tr_b16 v[162:163], v211 offset:16640
    s_waitcnt lgkmcnt(12)
    v_mfma_f32_32x32x16_bf16 v[176:191], v[168:171], v[60:63], v[176:191]
    ds_read_b64_tr_b16 v[164:165], v211 offset:16896
    ds_read_b64_tr_b16 v[166:167], v211 offset:17152
    s_waitcnt lgkmcnt(12)
    v_mfma_f32_32x32x16_bf16 v[192:207], v[172:175], v[60:63], v[192:207]
    ds_read_b64_tr_b16 v[168:169], v211 offset:17408
    ds_read_b64_tr_b16 v[170:171], v211 offset:17664
    s_waitcnt lgkmcnt(12)
    v_mfma_f32_32x32x16_bf16 v[176:191], v[144:147], v[64:67], v[176:191]
    ds_read_b64_tr_b16 v[172:173], v211 offset:17920
    ds_read_b64_tr_b16 v[174:175], v211 offset:18176
    s_waitcnt lgkmcnt(12)
    v_mfma_f32_32x32x16_bf16 v[192:207], v[148:151], v[64:67], v[192:207]
    s_waitcnt lgkmcnt(10)
    v_mfma_f32_32x32x16_bf16 v[176:191], v[152:155], v[68:71], v[176:191]
    s_waitcnt lgkmcnt(8)
    v_mfma_f32_32x32x16_bf16 v[192:207], v[156:159], v[68:71], v[192:207]
    s_waitcnt vmcnt(8)
    s_waitcnt lgkmcnt(0)
    s_barrier
    ds_read_b64_tr_b16 v[144:145], v208 offset:32768
    ds_read_b64_tr_b16 v[146:147], v208 offset:33024
    ds_read_b64_tr_b16 v[148:149], v208 offset:33280
    ds_read_b64_tr_b16 v[150:151], v208 offset:33536
    ds_read_b64_tr_b16 v[152:153], v208 offset:33792
    ds_read_b64_tr_b16 v[154:155], v208 offset:34048
    v_mfma_f32_32x32x16_bf16 v[176:191], v[160:163], v[72:75], v[176:191]
    ds_read_b64_tr_b16 v[156:157], v208 offset:34304
    ds_read_b64_tr_b16 v[158:159], v208 offset:34560
    v_mfma_f32_32x32x16_bf16 v[192:207], v[164:167], v[72:75], v[192:207]
    ds_read_b64_tr_b16 v[160:161], v208 offset:49152
    ds_read_b64_tr_b16 v[162:163], v208 offset:49408
    v_mfma_f32_32x32x16_bf16 v[176:191], v[168:171], v[76:79], v[176:191]
    ds_read_b64_tr_b16 v[164:165], v208 offset:49664
    ds_read_b64_tr_b16 v[166:167], v208 offset:49920
    v_mfma_f32_32x32x16_bf16 v[192:207], v[172:175], v[76:79], v[192:207]
    ds_read_b64_tr_b16 v[168:169], v208 offset:50176
    ds_read_b64_tr_b16 v[170:171], v208 offset:50432
    s_waitcnt lgkmcnt(12)
    v_mfma_f32_32x32x16_bf16 v[176:191], v[144:147], v[80:83], v[176:191]
    v_mfma_f32_16x16x32_bf16 v[220:223], v[216:219], v[144:147], v[220:223]
    ds_read_b64_tr_b16 v[172:173], v208 offset:50688
    ds_read_b64_tr_b16 v[174:175], v208 offset:50944
    s_waitcnt lgkmcnt(12)
    v_mfma_f32_32x32x16_bf16 v[192:207], v[148:151], v[80:83], v[192:207]
    v_mfma_f32_16x16x32_bf16 v[224:227], v[216:219], v[148:151], v[224:227]
    ds_read_b64_tr_b16 v[144:145], v209 offset:32768
    ds_read_b64_tr_b16 v[146:147], v209 offset:33024
    s_waitcnt lgkmcnt(12)
    v_mfma_f32_32x32x16_bf16 v[176:191], v[152:155], v[84:87], v[176:191]
    v_mfma_f32_16x16x32_bf16 v[220:223], v[216:219], v[152:155], v[220:223]
    ds_read_b64_tr_b16 v[148:149], v209 offset:33280
    ds_read_b64_tr_b16 v[150:151], v209 offset:33536
    s_waitcnt lgkmcnt(12)
    v_mfma_f32_32x32x16_bf16 v[192:207], v[156:159], v[84:87], v[192:207]
    v_mfma_f32_16x16x32_bf16 v[224:227], v[216:219], v[156:159], v[224:227]
    ds_read_b64_tr_b16 v[152:153], v209 offset:33792
    ds_read_b64_tr_b16 v[154:155], v209 offset:34048
    s_waitcnt lgkmcnt(12)
    v_mfma_f32_32x32x16_bf16 v[176:191], v[160:163], v[88:91], v[176:191]
    v_mfma_f32_16x16x32_bf16 v[220:223], v[216:219], v[160:163], v[220:223]
    ds_read_b64_tr_b16 v[156:157], v209 offset:34304
    ds_read_b64_tr_b16 v[158:159], v209 offset:34560
    s_waitcnt lgkmcnt(12)
    v_mfma_f32_32x32x16_bf16 v[192:207], v[164:167], v[88:91], v[192:207]
    v_mfma_f32_16x16x32_bf16 v[224:227], v[216:219], v[164:167], v[224:227]
    ds_read_b64_tr_b16 v[160:161], v209 offset:49152
    ds_read_b64_tr_b16 v[162:163], v209 offset:49408
    s_waitcnt lgkmcnt(12)
    v_mfma_f32_32x32x16_bf16 v[176:191], v[168:171], v[92:95], v[176:191]
    v_mfma_f32_16x16x32_bf16 v[220:223], v[216:219], v[168:171], v[220:223]
    ds_read_b64_tr_b16 v[164:165], v209 offset:49664
    ds_read_b64_tr_b16 v[166:167], v209 offset:49920
    s_waitcnt lgkmcnt(12)
    v_mfma_f32_32x32x16_bf16 v[192:207], v[172:175], v[92:95], v[192:207]
    v_mfma_f32_16x16x32_bf16 v[224:227], v[216:219], v[172:175], v[224:227]
    ds_read_b64_tr_b16 v[168:169], v209 offset:50176
    ds_read_b64_tr_b16 v[170:171], v209 offset:50432
    s_waitcnt lgkmcnt(12)
    v_mfma_f32_32x32x16_bf16 v[176:191], v[144:147], v[96:99], v[176:191]
    ds_read_b64_tr_b16 v[172:173], v209 offset:50688
    ds_read_b64_tr_b16 v[174:175], v209 offset:50944
    s_waitcnt lgkmcnt(12)
    v_mfma_f32_32x32x16_bf16 v[192:207], v[148:151], v[96:99], v[192:207]
    ds_read_b64_tr_b16 v[144:145], v210 offset:32768
    ds_read_b64_tr_b16 v[146:147], v210 offset:33024
    s_waitcnt lgkmcnt(12)
    v_mfma_f32_32x32x16_bf16 v[176:191], v[152:155], v[100:103], v[176:191]
    ds_read_b64_tr_b16 v[148:149], v210 offset:33280
    ds_read_b64_tr_b16 v[150:151], v210 offset:33536
    s_waitcnt lgkmcnt(12)
    v_mfma_f32_32x32x16_bf16 v[192:207], v[156:159], v[100:103], v[192:207]
    ds_read_b64_tr_b16 v[152:153], v210 offset:33792
    ds_read_b64_tr_b16 v[154:155], v210 offset:34048
    s_waitcnt lgkmcnt(12)
    v_mfma_f32_32x32x16_bf16 v[176:191], v[160:163], v[104:107], v[176:191]
    ds_read_b64_tr_b16 v[156:157], v210 offset:34304
    ds_read_b64_tr_b16 v[158:159], v210 offset:34560
    s_waitcnt lgkmcnt(12)
    v_mfma_f32_32x32x16_bf16 v[192:207], v[164:167], v[104:107], v[192:207]
    ds_read_b64_tr_b16 v[160:161], v210 offset:49152
    ds_read_b64_tr_b16 v[162:163], v210 offset:49408
    s_waitcnt lgkmcnt(12)
    v_mfma_f32_32x32x16_bf16 v[176:191], v[168:171], v[108:111], v[176:191]
    ds_read_b64_tr_b16 v[164:165], v210 offset:49664
    ds_read_b64_tr_b16 v[166:167], v210 offset:49920
    s_waitcnt lgkmcnt(12)
    v_mfma_f32_32x32x16_bf16 v[192:207], v[172:175], v[108:111], v[192:207]
    ds_read_b64_tr_b16 v[168:169], v210 offset:50176
    ds_read_b64_tr_b16 v[170:171], v210 offset:50432
    s_waitcnt lgkmcnt(12)
    v_mfma_f32_32x32x16_bf16 v[176:191], v[144:147], v[112:115], v[176:191]
    ds_read_b64_tr_b16 v[172:173], v210 offset:50688
    ds_read_b64_tr_b16 v[174:175], v210 offset:50944
    s_waitcnt lgkmcnt(12)
    v_mfma_f32_32x32x16_bf16 v[192:207], v[148:151], v[112:115], v[192:207]
    v_cndmask_b32 v11, v220, v221, s[52:53]
    ds_write_b32 v5, v11 offset:2048
    ds_read_b64_tr_b16 v[144:145], v211 offset:32768
    ds_read_b64_tr_b16 v[146:147], v211 offset:33024
    s_waitcnt lgkmcnt(13)
    v_mfma_f32_32x32x16_bf16 v[176:191], v[152:155], v[116:119], v[176:191]
    ds_read_b64_tr_b16 v[148:149], v211 offset:33280
    ds_read_b64_tr_b16 v[150:151], v211 offset:33536
    s_waitcnt lgkmcnt(13)
    v_mfma_f32_32x32x16_bf16 v[192:207], v[156:159], v[116:119], v[192:207]
    v_cndmask_b32 v12, v224, v225, s[52:53]
    ds_write_b32 v5, v12 offset:2560
    ds_read_b64_tr_b16 v[152:153], v211 offset:33792
    ds_read_b64_tr_b16 v[154:155], v211 offset:34048
    s_waitcnt lgkmcnt(14)
    v_mfma_f32_32x32x16_bf16 v[176:191], v[160:163], v[120:123], v[176:191]
    ds_read_b64_tr_b16 v[156:157], v211 offset:34304
    ds_read_b64_tr_b16 v[158:159], v211 offset:34560
    s_waitcnt lgkmcnt(14)
    v_mfma_f32_32x32x16_bf16 v[192:207], v[164:167], v[120:123], v[192:207]
    ds_read_b64_tr_b16 v[160:161], v211 offset:49152
    ds_read_b64_tr_b16 v[162:163], v211 offset:49408
    s_waitcnt lgkmcnt(14)
    v_mfma_f32_32x32x16_bf16 v[176:191], v[168:171], v[124:127], v[176:191]
    ds_read_b64_tr_b16 v[164:165], v211 offset:49664
    ds_read_b64_tr_b16 v[166:167], v211 offset:49920
    s_waitcnt lgkmcnt(14)
    v_mfma_f32_32x32x16_bf16 v[192:207], v[172:175], v[124:127], v[192:207]
    ds_read_b64_tr_b16 v[168:169], v211 offset:50176
    ds_read_b64_tr_b16 v[170:171], v211 offset:50432
    s_waitcnt lgkmcnt(13)
    v_mfma_f32_32x32x16_bf16 v[176:191], v[144:147], v[128:131], v[176:191]
    ds_read_b64_tr_b16 v[172:173], v211 offset:50688
    ds_read_b64_tr_b16 v[174:175], v211 offset:50944
    s_waitcnt lgkmcnt(13)
    v_mfma_f32_32x32x16_bf16 v[192:207], v[148:151], v[128:131], v[192:207]
    s_waitcnt lgkmcnt(10)
    v_mfma_f32_32x32x16_bf16 v[176:191], v[152:155], v[132:135], v[176:191]
    s_waitcnt lgkmcnt(8)
    v_mfma_f32_32x32x16_bf16 v[192:207], v[156:159], v[132:135], v[192:207]
    s_waitcnt lgkmcnt(0)
    s_barrier
    v_mfma_f32_32x32x16_bf16 v[176:191], v[160:163], v[136:139], v[176:191]
    v_mfma_f32_32x32x16_bf16 v[192:207], v[164:167], v[136:139], v[192:207]
    v_mfma_f32_32x32x16_bf16 v[176:191], v[168:171], v[140:143], v[176:191]
    v_mfma_f32_32x32x16_bf16 v[192:207], v[172:175], v[140:143], v[192:207]
    s_setprio 0
    s_setprio 3
    s_waitcnt vmcnt(0)
    ds_read_b64_tr_b16 v[144:145], v9 offset:0
    ds_read_b64_tr_b16 v[146:147], v9 offset:2048
    ds_read_b64_tr_b16 v[148:149], v9 offset:64
    ds_read_b64_tr_b16 v[150:151], v9 offset:2112
    ds_read_b64_tr_b16 v[152:153], v9 offset:128
    ds_read_b64_tr_b16 v[154:155], v9 offset:2176
    ds_read_b64_tr_b16 v[156:157], v9 offset:192
    ds_read_b64_tr_b16 v[158:159], v9 offset:2240
    s_waitcnt lgkmcnt(6)
    s_add_u32 s63, s55, 1024
    buffer_store_dwordx4 v[144:147], v2, s[36:39], s63 offen sc1
    s_waitcnt lgkmcnt(4)
    s_add_u32 s63, s55, 148480
    buffer_store_dwordx4 v[148:151], v2, s[36:39], s63 offen sc1
    s_waitcnt lgkmcnt(2)
    s_add_u32 s63, s55, 295936
    buffer_store_dwordx4 v[152:155], v2, s[36:39], s63 offen sc1
    s_waitcnt lgkmcnt(0)
    s_add_u32 s63, s55, 443392
    buffer_store_dwordx4 v[156:159], v2, s[36:39], s63 offen sc1
    ds_read_b128 v[160:163], v6 offset:2048
    ds_read_b128 v[164:167], v6 offset:2560
    s_waitcnt lgkmcnt(0)
    v_add_f32 v160, v160, v161
    v_add_f32 v162, v162, v163
    v_add_f32 v144, v160, v162
    v_and_b32 v145, 0xffff0000, v144
    v_sub_f32 v146, v144, v145
    v_and_b32 v147, 0xffff0000, v146
    v_sub_f32 v146, v146, v147
    v_lshrrev_b32 v145, 16, v145
    v_or_b32 v232, v145, v147
    v_lshrrev_b32 v146, 16, v146
    v_lshl_or_b32 v233, v248, 16, v146
    v_add_f32 v164, v164, v165
    v_add_f32 v166, v166, v167
    v_add_f32 v144, v164, v166
    v_and_b32 v145, 0xffff0000, v144
    v_sub_f32 v146, v144, v145
    v_and_b32 v147, 0xffff0000, v146
    v_sub_f32 v146, v146, v147
    v_lshrrev_b32 v145, 16, v145
    v_or_b32 v236, v145, v147
    v_lshrrev_b32 v146, 16, v146
    v_lshl_or_b32 v237, v249, 16, v146
    v_mfma_f32_32x32x16_bf16 v[176:191], v[232:235], v[228:231], v[176:191]
    s_nop 0
    v_mfma_f32_32x32x16_bf16 v[192:207], v[236:239], v[228:231], v[192:207]
    s_nop 9
    v_mul_f32 v144, v176, v176
    v_mul_f32 v145, v177, v177
    v_mul_f32 v146, v178, v178
    v_mul_f32 v147, v179, v179
    v_mul_f32 v148, v180, v180
    v_mul_f32 v149, v181, v181
    v_mul_f32 v150, v182, v182
    v_mul_f32 v151, v183, v183
    v_fma_f32 v144, v144, v243, v242
    v_fma_f32 v145, v145, v243, v242
    v_fma_f32 v146, v146, v243, v242
    v_fma_f32 v147, v147, v243, v242
    v_fma_f32 v148, v148, v243, v242
    v_fma_f32 v149, v149, v243, v242
    v_fma_f32 v150, v150, v243, v242
    v_fma_f32 v151, v151, v243, v242
    v_mul_f32 v144, v144, v176
    v_mul_f32 v145, v145, v177
    v_mul_f32 v146, v146, v178
    v_mul_f32 v147, v147, v179
    v_mul_f32 v148, v148, v180
    v_mul_f32 v149, v149, v181
    v_mul_f32 v150, v150, v182
    v_mul_f32 v151, v151, v183
    v_exp_f32 v144, v144
    v_exp_f32 v145, v145
    v_exp_f32 v146, v146
    v_exp_f32 v147, v147
    v_exp_f32 v148, v148
    v_exp_f32 v149, v149
    v_exp_f32 v150, v150
    v_exp_f32 v151, v151
    v_fma_f32 v144, v144, v241, v241
    v_fma_f32 v145, v145, v241, v241
    v_fma_f32 v146, v146, v241, v241
    v_fma_f32 v147, v147, v241, v241
    v_fma_f32 v148, v148, v241, v241
    v_fma_f32 v149, v149, v241, v241
    v_fma_f32 v150, v150, v241, v241
    v_fma_f32 v151, v151, v241, v241
    v_rcp_f32 v144, v144
    v_rcp_f32 v145, v145
    v_rcp_f32 v146, v146
    v_rcp_f32 v147, v147
    v_rcp_f32 v148, v148
    v_rcp_f32 v149, v149
    v_rcp_f32 v150, v150
    v_rcp_f32 v151, v151
    v_mul_f32 v144, v144, v176
    v_mul_f32 v145, v145, v177
    v_mul_f32 v146, v146, v178
    v_mul_f32 v147, v147, v179
    v_mul_f32 v148, v148, v180
    v_mul_f32 v149, v149, v181
    v_mul_f32 v150, v150, v182
    v_mul_f32 v151, v151, v183
    v_cvt_pk_bf16_f32 v160, v144, v145
    v_cvt_pk_bf16_f32 v161, v146, v147
    v_cvt_pk_bf16_f32 v162, v148, v149
    v_cvt_pk_bf16_f32 v163, v150, v151
    buffer_store_dwordx4 v[160:163], v2, s[36:39], s66 offen offset:0 sc1
    v_mul_f32 v144, v184, v184
    v_mul_f32 v145, v185, v185
    v_mul_f32 v146, v186, v186
    v_mul_f32 v147, v187, v187
    v_mul_f32 v148, v188, v188
    v_mul_f32 v149, v189, v189
    v_mul_f32 v150, v190, v190
    v_mul_f32 v151, v191, v191
    v_fma_f32 v144, v144, v243, v242
    v_fma_f32 v145, v145, v243, v242
    v_fma_f32 v146, v146, v243, v242
    v_fma_f32 v147, v147, v243, v242
    v_fma_f32 v148, v148, v243, v242
    v_fma_f32 v149, v149, v243, v242
    v_fma_f32 v150, v150, v243, v242
    v_fma_f32 v151, v151, v243, v242
    v_mul_f32 v144, v144, v184
    v_mul_f32 v145, v145, v185
    v_mul_f32 v146, v146, v186
    v_mul_f32 v147, v147, v187
    v_mul_f32 v148, v148, v188
    v_mul_f32 v149, v149, v189
    v_mul_f32 v150, v150, v190
    v_mul_f32 v151, v151, v191
    v_exp_f32 v144, v144
    v_exp_f32 v145, v145
    v_exp_f32 v146, v146
    v_exp_f32 v147, v147
    v_exp_f32 v148, v148
    v_exp_f32 v149, v149
    v_exp_f32 v150, v150
    v_exp_f32 v151, v151
    v_fma_f32 v144, v144, v241, v241
    v_fma_f32 v145, v145, v241, v241
    v_fma_f32 v146, v146, v241, v241
    v_fma_f32 v147, v147, v241, v241
    v_fma_f32 v148, v148, v241, v241
    v_fma_f32 v149, v149, v241, v241
    v_fma_f32 v150, v150, v241, v241
    v_fma_f32 v151, v151, v241, v241
    v_rcp_f32 v144, v144
    v_rcp_f32 v145, v145
    v_rcp_f32 v146, v146
    v_rcp_f32 v147, v147
    v_rcp_f32 v148, v148
    v_rcp_f32 v149, v149
    v_rcp_f32 v150, v150
    v_rcp_f32 v151, v151
    v_mul_f32 v144, v144, v184
    v_mul_f32 v145, v145, v185
    v_mul_f32 v146, v146, v186
    v_mul_f32 v147, v147, v187
    v_mul_f32 v148, v148, v188
    v_mul_f32 v149, v149, v189
    v_mul_f32 v150, v150, v190
    v_mul_f32 v151, v151, v191
    v_cvt_pk_bf16_f32 v164, v144, v145
    v_cvt_pk_bf16_f32 v165, v146, v147
    v_cvt_pk_bf16_f32 v166, v148, v149
    v_cvt_pk_bf16_f32 v167, v150, v151
    buffer_store_dwordx4 v[164:167], v2, s[36:39], s66 offen offset:1024 sc1
    v_mul_f32 v144, v192, v192
    v_mul_f32 v145, v193, v193
    v_mul_f32 v146, v194, v194
    v_mul_f32 v147, v195, v195
    v_mul_f32 v148, v196, v196
    v_mul_f32 v149, v197, v197
    v_mul_f32 v150, v198, v198
    v_mul_f32 v151, v199, v199
    v_fma_f32 v144, v144, v243, v242
    v_fma_f32 v145, v145, v243, v242
    v_fma_f32 v146, v146, v243, v242
    v_fma_f32 v147, v147, v243, v242
    v_fma_f32 v148, v148, v243, v242
    v_fma_f32 v149, v149, v243, v242
    v_fma_f32 v150, v150, v243, v242
    v_fma_f32 v151, v151, v243, v242
    v_mul_f32 v144, v144, v192
    v_mul_f32 v145, v145, v193
    v_mul_f32 v146, v146, v194
    v_mul_f32 v147, v147, v195
    v_mul_f32 v148, v148, v196
    v_mul_f32 v149, v149, v197
    v_mul_f32 v150, v150, v198
    v_mul_f32 v151, v151, v199
    v_exp_f32 v144, v144
    v_exp_f32 v145, v145
    v_exp_f32 v146, v146
    v_exp_f32 v147, v147
    v_exp_f32 v148, v148
    v_exp_f32 v149, v149
    v_mov_b32 v11, 96256
L_k1_qwx120:
    ds_read_b32 v12, v11 offset:20
    s_waitcnt lgkmcnt(0)
    v_readfirstlane_b32 s62, v12
    s_nop 0
    s_cmp_eq_u32 s62, 0
    s_cbranch_scc1 L_k1_qwx120
    buffer_load_dwordx4 v[16:19], v2, s[36:39], s88 offen offset:0 sc1
    buffer_load_dwordx4 v[20:23], v2, s[36:39], s88 offen offset:1024 sc1
    v_exp_f32 v150, v150
    v_exp_f32 v151, v151
    v_fma_f32 v144, v144, v241, v241
    v_fma_f32 v145, v145, v241, v241
    v_fma_f32 v146, v146, v241, v241
    v_fma_f32 v147, v147, v241, v241
    v_fma_f32 v148, v148, v241, v241
    v_fma_f32 v149, v149, v241, v241
    v_fma_f32 v150, v150, v241, v241
    v_fma_f32 v151, v151, v241, v241
    v_rcp_f32 v144, v144
    v_rcp_f32 v145, v145
    v_rcp_f32 v146, v146
    v_rcp_f32 v147, v147
    v_rcp_f32 v148, v148
    v_rcp_f32 v149, v149
    v_rcp_f32 v150, v150
    v_rcp_f32 v151, v151
    v_mul_f32 v144, v144, v192
    v_mul_f32 v145, v145, v193
    v_mul_f32 v146, v146, v194
    v_mul_f32 v147, v147, v195
    v_mul_f32 v148, v148, v196
    v_mul_f32 v149, v149, v197
    v_mul_f32 v150, v150, v198
    v_mul_f32 v151, v151, v199
    v_cvt_pk_bf16_f32 v168, v144, v145
    v_cvt_pk_bf16_f32 v169, v146, v147
    v_cvt_pk_bf16_f32 v170, v148, v149
    v_cvt_pk_bf16_f32 v171, v150, v151
    buffer_store_dwordx4 v[168:171], v2, s[36:39], s66 offen offset:2048 sc1
    v_mul_f32 v144, v200, v200
    v_mul_f32 v145, v201, v201
    v_mul_f32 v146, v202, v202
    v_mul_f32 v147, v203, v203
    v_mul_f32 v148, v204, v204
    v_mul_f32 v149, v205, v205
    v_mul_f32 v150, v206, v206
    v_mul_f32 v151, v207, v207
    v_fma_f32 v144, v144, v243, v242
    v_fma_f32 v145, v145, v243, v242
    v_fma_f32 v146, v146, v243, v242
    v_fma_f32 v147, v147, v243, v242
    v_fma_f32 v148, v148, v243, v242
    v_fma_f32 v149, v149, v243, v242
    v_fma_f32 v150, v150, v243, v242
    v_fma_f32 v151, v151, v243, v242
    v_mul_f32 v144, v144, v200
    v_mul_f32 v145, v145, v201
    v_mul_f32 v146, v146, v202
    v_mul_f32 v147, v147, v203
    v_mul_f32 v148, v148, v204
    v_mul_f32 v149, v149, v205
    v_mul_f32 v150, v150, v206
    v_mul_f32 v151, v151, v207
    v_exp_f32 v144, v144
    v_exp_f32 v145, v145
    v_exp_f32 v146, v146
    v_exp_f32 v147, v147
    v_exp_f32 v148, v148
    v_exp_f32 v149, v149
    v_exp_f32 v150, v150
    v_exp_f32 v151, v151
    v_fma_f32 v144, v144, v241, v241
    v_fma_f32 v145, v145, v241, v241
    v_fma_f32 v146, v146, v241, v241
    v_fma_f32 v147, v147, v241, v241
    v_fma_f32 v148, v148, v241, v241
    v_fma_f32 v149, v149, v241, v241
    v_fma_f32 v150, v150, v241, v241
    v_fma_f32 v151, v151, v241, v241
    v_rcp_f32 v144, v144
    v_rcp_f32 v145, v145
    v_rcp_f32 v146, v146
    v_rcp_f32 v147, v147
    v_rcp_f32 v148, v148
    v_rcp_f32 v149, v149
    v_rcp_f32 v150, v150
    v_rcp_f32 v151, v151
    v_mul_f32 v144, v144, v200
    v_mul_f32 v145, v145, v201
    v_mul_f32 v146, v146, v202
    v_mul_f32 v147, v147, v203
    v_mul_f32 v148, v148, v204
    v_mul_f32 v149, v149, v205
    v_mul_f32 v150, v150, v206
    v_mul_f32 v151, v151, v207
    v_cvt_pk_bf16_f32 v172, v144, v145
    v_cvt_pk_bf16_f32 v173, v146, v147
    v_cvt_pk_bf16_f32 v174, v148, v149
    v_cvt_pk_bf16_f32 v175, v150, v151
    buffer_store_dwordx4 v[172:175], v2, s[36:39], s66 offen offset:3072 sc1
    s_mov_b32 s96, s85
    s_mov_b32 s97, 0
    s_add_u32 s94, s72, 128
    s_add_u32 s95, s59, 0
    s_branch L_p2
L_k1_y:
    s_nop 4
    s_add_u32 s56, s63, 1024
    s_mov_b32 s57, s63
    s_lshl_b32 s61, s46, 7
    s_add_u32 s61, s61, 2048
    s_add_u32 s58, s61, s62
    s_mov_b32 s70, s61
    s_lshl_b32 s71, s46, 6
    s_add_u32 s71, s71, 3072
    s_add_u32 s59, s71, s62
    s_add_u32 s84, s84, s61
    s_mul_i32 s60, s74, 147456
    s_add_u32 s60, s60, 6324224
    s_lshr_b32 s61, s70, 6
    s_lshl_b32 s61, s61, 11
    s_add_u32 s66, s60, s61
    s_lshr_b32 s61, s71, 6
    s_lshl_b32 s61, s61, 11
    s_add_u32 s67, s60, s61
    v_and_b32 v178, 0x33, v1
    v_and_b32 v180, 4, v1
    v_lshl_add_u32 v178, v180, 1, v178
    v_and_b32 v180, 8, v1
    v_lshrrev_b32 v180, 1, v180
    v_add_u32 v178, v178, v180
    v_lshlrev_b32 v7, 4, v178
    s_cmp_eq_u32 s44, 0
    s_cbranch_scc0 L_k1_by
    s_xor_b32 m0, s90, 1024
    s_xor_b32 s60, s86, 4096
    buffer_load_dwordx4 v185, s[28:31], s60 offen lds
    s_xor_b32 m0, s91, 1024
    s_xor_b32 s60, s87, 4096
    buffer_load_dwordx4 v185, s[28:31], s60 offen lds
    s_xor_b32 m0, s90, 2048
    s_xor_b32 s60, s86, 8192
    buffer_load_dwordx4 v186, s[28:31], s60 offen lds
    s_xor_b32 m0, s91, 2048
    s_xor_b32 s60, s87, 8192
    buffer_load_dwordx4 v186, s[28:31], s60 offen lds
    s_xor_b32 m0, s90, 3072
    s_xor_b32 s60, s86, 12288
    buffer_load_dwordx4 v187, s[28:31], s60 offen lds
    s_xor_b32 m0, s91, 3072
    s_xor_b32 s60, s87, 12288
    buffer_load_dwordx4 v187, s[28:31], s60 offen lds
    s_xor_b32 m0, s90, 4096
    s_xor_b32 s60, s86, 16384
    buffer_load_dwordx4 v184, s[28:31], s60 offen lds
    s_xor_b32 m0, s91, 4096
    s_xor_b32 s60, s87, 16384
    buffer_load_dwordx4 v184, s[28:31], s60 offen lds
    s_xor_b32 m0, s90, 5120
    s_xor_b32 s60, s86, 20480
    buffer_load_dwordx4 v185, s[28:31], s60 offen lds
    s_xor_b32 m0, s91, 5120
    s_xor_b32 s60, s87, 20480
    buffer_load_dwordx4 v185, s[28:31], s60 offen lds
    s_xor_b32 m0, s90, 6144
    s_xor_b32 s60, s86, 24576
    buffer_load_dwordx4 v186, s[28:31], s60 offen lds
    s_xor_b32 m0, s91, 6144
    s_xor_b32 s60, s87, 24576
    buffer_load_dwordx4 v186, s[28:31], s60 offen lds
    s_xor_b32 m0, s90, 7168
    s_xor_b32 s60, s86, 28672
    buffer_load_dwordx4 v187, s[28:31], s60 offen lds
    s_xor_b32 m0, s91, 7168
    s_xor_b32 s60, s87, 28672
    buffer_load_dwordx4 v187, s[28:31], s60 offen lds
    s_waitcnt vmcnt(0)
    s_waitcnt lgkmcnt(0)
    s_barrier
    s_add_u32 m0, s65, 0
    s_mov_b32 s60, s56
    buffer_load_dwordx4 v4, s[92:95], s60 offen lds
    s_add_u32 m0, s65, 1024
    s_addk_i32 s60, 24576
    buffer_load_dwordx4 v4, s[92:95], s60 offen lds
    s_add_u32 m0, s65, 2048
    s_addk_i32 s60, 24576
    buffer_load_dwordx4 v4, s[92:95], s60 offen lds
    s_add_u32 m0, s65, 3072
    s_addk_i32 s60, 24576
    buffer_load_dwordx4 v4, s[92:95], s60 offen lds
    s_add_u32 m0, s65, 4096
    s_addk_i32 s60, 24576
    buffer_load_dwordx4 v4, s[92:95], s60 offen lds
    s_add_u32 m0, s65, 5120
    s_addk_i32 s60, 24576
    buffer_load_dwordx4 v4, s[92:95], s60 offen lds
    s_add_u32 m0, s65, 6144
    s_addk_i32 s60, 24576
    buffer_load_dwordx4 v4, s[92:95], s60 offen lds
    s_add_u32 m0, s65, 7168
    s_addk_i32 s60, 24576
    buffer_load_dwordx4 v4, s[92:95], s60 offen lds
    ds_read_b128 v[16:19], v228 offset:0
    ds_read_b128 v[20:23], v229 offset:0
    ds_read_b128 v[24:27], v228 offset:32768
    ds_read_b128 v[28:31], v229 offset:32768
    ds_read_b128 v[32:35], v230 offset:0
    ds_read_b128 v[36:39], v231 offset:0
    ds_read_b128 v[40:43], v230 offset:32768
    ds_read_b128 v[44:47], v231 offset:32768
    ds_read_b128 v[48:51], v232 offset:0
    ds_read_b128 v[52:55], v233 offset:0
    ds_read_b128 v[56:59], v232 offset:32768
    ds_read_b128 v[60:63], v233 offset:32768
    ds_read_b128 v[64:67], v234 offset:0
    ds_read_b128 v[68:71], v235 offset:0
    ds_read_b128 v[72:75], v234 offset:32768
    ds_read_b128 v[76:79], v235 offset:32768
    v_add_u32 v228, 65536, v228
    v_add_u32 v229, 65536, v229
    v_add_u32 v230, 65536, v230
    v_add_u32 v231, 65536, v231
    v_add_u32 v232, 65536, v232
    v_add_u32 v233, 65536, v233
    v_add_u32 v234, 65536, v234
    v_add_u32 v235, 65536, v235
    buffer_load_dword v0, v253, s[92:95], s49 offen
    s_waitcnt lgkmcnt(15)
    v_dot2c_f32_bf16 v244, v16, v10
    v_dot2c_f32_bf16 v245, v16, v16
    v_dot2c_f32_bf16 v244, v17, v10
    v_dot2c_f32_bf16 v245, v17, v17
    v_dot2c_f32_bf16 v244, v18, v10
    v_dot2c_f32_bf16 v245, v18, v18
    v_dot2c_f32_bf16 v244, v19, v10
    v_dot2c_f32_bf16 v245, v19, v19
    s_waitcnt lgkmcnt(14)
    v_dot2c_f32_bf16 v244, v20, v10
    v_dot2c_f32_bf16 v245, v20, v20
    v_dot2c_f32_bf16 v244, v21, v10
    v_dot2c_f32_bf16 v245, v21, v21
    v_dot2c_f32_bf16 v244, v22, v10
    v_dot2c_f32_bf16 v245, v22, v22
    v_dot2c_f32_bf16 v244, v23, v10
    v_dot2c_f32_bf16 v245, v23, v23
    s_waitcnt lgkmcnt(13)
    v_dot2c_f32_bf16 v244, v24, v10
    v_dot2c_f32_bf16 v245, v24, v24
    v_dot2c_f32_bf16 v244, v25, v10
    v_dot2c_f32_bf16 v245, v25, v25
    v_dot2c_f32_bf16 v244, v26, v10
    v_dot2c_f32_bf16 v245, v26, v26
    v_dot2c_f32_bf16 v244, v27, v10
    v_dot2c_f32_bf16 v245, v27, v27
    s_waitcnt lgkmcnt(12)
    v_dot2c_f32_bf16 v244, v28, v10
    v_dot2c_f32_bf16 v245, v28, v28
    v_dot2c_f32_bf16 v244, v29, v10
    v_dot2c_f32_bf16 v245, v29, v29
    v_dot2c_f32_bf16 v244, v30, v10
    v_dot2c_f32_bf16 v245, v30, v30
    v_dot2c_f32_bf16 v244, v31, v10
    v_dot2c_f32_bf16 v245, v31, v31
    s_waitcnt lgkmcnt(11)
    v_dot2c_f32_bf16 v244, v32, v10
    v_dot2c_f32_bf16 v245, v32, v32
    v_dot2c_f32_bf16 v244, v33, v10
    v_dot2c_f32_bf16 v245, v33, v33
    v_dot2c_f32_bf16 v244, v34, v10
    v_dot2c_f32_bf16 v245, v34, v34
    v_dot2c_f32_bf16 v244, v35, v10
    v_dot2c_f32_bf16 v245, v35, v35
    s_waitcnt lgkmcnt(10)
    v_dot2c_f32_bf16 v244, v36, v10
    v_dot2c_f32_bf16 v245, v36, v36
    v_dot2c_f32_bf16 v244, v37, v10
    v_dot2c_f32_bf16 v245, v37, v37
    v_dot2c_f32_bf16 v244, v38, v10
    v_dot2c_f32_bf16 v245, v38, v38
    v_dot2c_f32_bf16 v244, v39, v10
    v_dot2c_f32_bf16 v245, v39, v39
    s_waitcnt lgkmcnt(9)
    v_dot2c_f32_bf16 v244, v40, v10
    v_dot2c_f32_bf16 v245, v40, v40
    v_dot2c_f32_bf16 v244, v41, v10
    v_dot2c_f32_bf16 v245, v41, v41
    v_dot2c_f32_bf16 v244, v42, v10
    v_dot2c_f32_bf16 v245, v42, v42
    v_dot2c_f32_bf16 v244, v43, v10
    v_dot2c_f32_bf16 v245, v43, v43
    s_waitcnt lgkmcnt(8)
    v_dot2c_f32_bf16 v244, v44, v10
    v_dot2c_f32_bf16 v245, v44, v44
    v_dot2c_f32_bf16 v244, v45, v10
    v_dot2c_f32_bf16 v245, v45, v45
    v_dot2c_f32_bf16 v244, v46, v10
    v_dot2c_f32_bf16 v245, v46, v46
    v_dot2c_f32_bf16 v244, v47, v10
    v_dot2c_f32_bf16 v245, v47, v47
    s_waitcnt lgkmcnt(7)
    v_dot2c_f32_bf16 v244, v48, v10
    v_dot2c_f32_bf16 v245, v48, v48
    v_dot2c_f32_bf16 v244, v49, v10
    v_dot2c_f32_bf16 v245, v49, v49
    v_dot2c_f32_bf16 v244, v50, v10
    v_dot2c_f32_bf16 v245, v50, v50
    v_dot2c_f32_bf16 v244, v51, v10
    v_dot2c_f32_bf16 v245, v51, v51
    s_waitcnt lgkmcnt(6)
    v_dot2c_f32_bf16 v244, v52, v10
    v_dot2c_f32_bf16 v245, v52, v52
    v_dot2c_f32_bf16 v244, v53, v10
    v_dot2c_f32_bf16 v245, v53, v53
    v_dot2c_f32_bf16 v244, v54, v10
    v_dot2c_f32_bf16 v245, v54, v54
    v_dot2c_f32_bf16 v244, v55, v10
    v_dot2c_f32_bf16 v245, v55, v55
    s_waitcnt lgkmcnt(5)
    v_dot2c_f32_bf16 v244, v56, v10
    v_dot2c_f32_bf16 v245, v56, v56
    v_dot2c_f32_bf16 v244, v57, v10
    v_dot2c_f32_bf16 v245, v57, v57
    v_dot2c_f32_bf16 v244, v58, v10
    v_dot2c_f32_bf16 v245, v58, v58
    v_dot2c_f32_bf16 v244, v59, v10
    v_dot2c_f32_bf16 v245, v59, v59
    s_waitcnt lgkmcnt(4)
    v_dot2c_f32_bf16 v244, v60, v10
    v_dot2c_f32_bf16 v245, v60, v60
    v_dot2c_f32_bf16 v244, v61, v10
    v_dot2c_f32_bf16 v245, v61, v61
    v_dot2c_f32_bf16 v244, v62, v10
    v_dot2c_f32_bf16 v245, v62, v62
    v_dot2c_f32_bf16 v244, v63, v10
    v_dot2c_f32_bf16 v245, v63, v63
    s_waitcnt lgkmcnt(3)
    v_dot2c_f32_bf16 v244, v64, v10
    v_dot2c_f32_bf16 v245, v64, v64
    v_dot2c_f32_bf16 v244, v65, v10
    v_dot2c_f32_bf16 v245, v65, v65
    v_dot2c_f32_bf16 v244, v66, v10
    v_dot2c_f32_bf16 v245, v66, v66
    v_dot2c_f32_bf16 v244, v67, v10
    v_dot2c_f32_bf16 v245, v67, v67
    s_waitcnt lgkmcnt(2)
    v_dot2c_f32_bf16 v244, v68, v10
    v_dot2c_f32_bf16 v245, v68, v68
    v_dot2c_f32_bf16 v244, v69, v10
    v_dot2c_f32_bf16 v245, v69, v69
    v_dot2c_f32_bf16 v244, v70, v10
    v_dot2c_f32_bf16 v245, v70, v70
    v_dot2c_f32_bf16 v244, v71, v10
    v_dot2c_f32_bf16 v245, v71, v71
    s_waitcnt lgkmcnt(1)
    v_dot2c_f32_bf16 v244, v72, v10
    v_dot2c_f32_bf16 v245, v72, v72
    v_dot2c_f32_bf16 v244, v73, v10
    v_dot2c_f32_bf16 v245, v73, v73
    v_dot2c_f32_bf16 v244, v74, v10
    v_dot2c_f32_bf16 v245, v74, v74
    v_dot2c_f32_bf16 v244, v75, v10
    v_dot2c_f32_bf16 v245, v75, v75
    s_waitcnt lgkmcnt(0)
    v_dot2c_f32_bf16 v244, v76, v10
    v_dot2c_f32_bf16 v245, v76, v76
    v_dot2c_f32_bf16 v244, v77, v10
    v_dot2c_f32_bf16 v245, v77, v77
    v_dot2c_f32_bf16 v244, v78, v10
    v_dot2c_f32_bf16 v245, v78, v78
    v_dot2c_f32_bf16 v244, v79, v10
    v_dot2c_f32_bf16 v245, v79, v79
    v_bfe_u32 v11, v1, 2, 2
    v_mul_u32_u24 v11, 3072, v11
    v_and_b32 v12, 3, v1
    v_lshl_add_u32 v11, v12, 7, v11
    s_lshr_b32 s61, s2, 3
    s_lshl_b32 s61, s61, 2
    s_add_u32 s61, s61, s27
    s_mul_i32 s61, s61, 12288
    s_and_b32 s62, s2, 4
    s_lshl_b32 s62, s62, 7
    s_add_u32 s61, s61, s62
    buffer_load_dword v0, v11, s[92:95], s61 offen
    buffer_load_ushort v248, v13, s[40:43], s70 offen offset:0
    buffer_load_ushort v249, v13, s[40:43], s70 offen offset:64
    buffer_load_ushort v250, v13, s[40:43], s71 offen offset:0
    buffer_load_ushort v251, v13, s[40:43], s71 offen offset:64
    s_waitcnt vmcnt(6)
    s_waitcnt lgkmcnt(0)
    s_barrier
    s_setprio 0
    s_add_u32 m0, s65, 32768
    s_add_u32 s60, s56, 786432
    buffer_load_dwordx4 v4, s[92:95], s60 offen lds
    s_add_u32 m0, s65, 33792
    s_addk_i32 s60, 24576
    buffer_load_dwordx4 v4, s[92:95], s60 offen lds
    s_add_u32 m0, s65, 34816
    s_addk_i32 s60, 24576
    buffer_load_dwordx4 v4, s[92:95], s60 offen lds
    s_add_u32 m0, s65, 35840
    s_addk_i32 s60, 24576
    buffer_load_dwordx4 v4, s[92:95], s60 offen lds
    s_add_u32 m0, s65, 36864
    s_addk_i32 s60, 24576
    buffer_load_dwordx4 v4, s[92:95], s60 offen lds
    s_add_u32 m0, s65, 37888
    s_addk_i32 s60, 24576
    buffer_load_dwordx4 v4, s[92:95], s60 offen lds
    s_add_u32 m0, s65, 38912
    s_addk_i32 s60, 24576
    buffer_load_dwordx4 v4, s[92:95], s60 offen lds
    s_add_u32 m0, s65, 39936
    s_addk_i32 s60, 24576
    buffer_load_dwordx4 v4, s[92:95], s60 offen lds
    v_mov_b32 v11, 0
    global_load_dword v253, v11, s[22:23] sc1
    ds_read_b128 v[80:83], v228 offset:0
    ds_read_b128 v[84:87], v229 offset:0
    ds_read_b128 v[88:91], v228 offset:32768
    ds_read_b128 v[92:95], v229 offset:32768
    ds_read_b128 v[96:99], v230 offset:0
    ds_read_b128 v[100:103], v231 offset:0
    ds_read_b128 v[104:107], v230 offset:32768
    ds_read_b128 v[108:111], v231 offset:32768
    ds_read_b128 v[112:115], v232 offset:0
    ds_read_b128 v[116:119], v233 offset:0
    ds_read_b128 v[120:123], v232 offset:32768
    ds_read_b128 v[124:127], v233 offset:32768
    ds_read_b128 v[128:131], v234 offset:0
    ds_read_b128 v[132:135], v235 offset:0
    ds_read_b128 v[136:139], v234 offset:32768
    ds_read_b128 v[140:143], v235 offset:32768
    s_lshl_b32 s61, s26, 9
    s_add_u32 s61, s61, 69632
    v_lshl_add_u32 v11, v1, 2, s61
    ds_write_b32 v11, v244
    ds_write_b32 v11, v245 offset:256
    v_mov_b32 v11, 96256
    v_mov_b32 v12, 0
    ds_write_b32 v11, v12 offset:0
    ds_write_b32 v11, v12 offset:4
    ds_write_b32 v11, v12 offset:8
    ds_write_b32 v11, v12 offset:12
    ds_write_b32 v11, v12 offset:20
    ds_write_b32 v11, v12 offset:24
    ds_write_b32 v11, v12 offset:28
    v_mov_b32 v12, -1
    ds_write_b32 v11, v12 offset:16
    s_waitcnt vmcnt(1)
    s_waitcnt lgkmcnt(0)
    s_barrier
    s_add_u32 m0, s65, 98304
    s_mov_b32 s60, s57
    buffer_load_dwordx4 v4, s[92:95], s60 offen lds
    s_add_u32 m0, s65, 99328
    s_addk_i32 s60, 24576
    buffer_load_dwordx4 v4, s[92:95], s60 offen lds
    s_add_u32 m0, s65, 100352
    s_addk_i32 s60, 24576
    buffer_load_dwordx4 v4, s[92:95], s60 offen lds
    s_add_u32 m0, s65, 101376
    s_addk_i32 s60, 24576
    buffer_load_dwordx4 v4, s[92:95], s60 offen lds
    s_add_u32 m0, s65, 102400
    s_addk_i32 s60, 24576
    buffer_load_dwordx4 v4, s[92:95], s60 offen lds
    s_add_u32 m0, s65, 103424
    s_addk_i32 s60, 24576
    buffer_load_dwordx4 v4, s[92:95], s60 offen lds
    s_add_u32 m0, s65, 104448
    s_addk_i32 s60, 24576
    buffer_load_dwordx4 v4, s[92:95], s60 offen lds
    s_add_u32 m0, s65, 105472
    s_addk_i32 s60, 24576
    buffer_load_dwordx4 v4, s[92:95], s60 offen lds
    s_add_u32 m0, s65, 131072
    s_add_u32 s60, s57, 786432
    buffer_load_dwordx4 v4, s[92:95], s60 offen lds
    s_add_u32 m0, s65, 132096
    s_addk_i32 s60, 24576
    buffer_load_dwordx4 v4, s[92:95], s60 offen lds
    s_add_u32 m0, s65, 133120
    s_addk_i32 s60, 24576
    buffer_load_dwordx4 v4, s[92:95], s60 offen lds
    s_add_u32 m0, s65, 134144
    s_addk_i32 s60, 24576
    buffer_load_dwordx4 v4, s[92:95], s60 offen lds
    s_add_u32 m0, s65, 135168
    s_addk_i32 s60, 24576
    buffer_load_dwordx4 v4, s[92:95], s60 offen lds
    s_add_u32 m0, s65, 136192
    s_addk_i32 s60, 24576
    buffer_load_dwordx4 v4, s[92:95], s60 offen lds
    s_add_u32 m0, s65, 137216
    s_addk_i32 s60, 24576
    buffer_load_dwordx4 v4, s[92:95], s60 offen lds
    s_add_u32 m0, s65, 138240
    s_addk_i32 s60, 24576
    buffer_load_dwordx4 v4, s[92:95], s60 offen lds
    v_and_b32 v11, 31, v1
    v_mul_u32_u24 v11, 3584, v11
    s_lshl_b32 s61, s51, 2
    s_add_u32 s61, s61, s27
    s_mul_i32 s61, s61, 114688
    s_add_u32 s61, s61, s70
    buffer_load_dword v0, v11, s[32:35], s61 offen offset:0
    v_and_b32 v11, 31, v1
    v_mul_u32_u24 v11, 3584, v11
    s_lshl_b32 s61, s51, 2
    s_add_u32 s61, s61, s27
    s_mul_i32 s61, s61, 114688
    s_add_u32 s61, s61, s71
    buffer_load_dword v0, v11, s[32:35], s61 offen offset:0
    v_mov_b32 v228, 0
    v_mov_b32 v232, 0
    v_mov_b32 v236, 0
    v_mov_b32 v229, 0
    v_mov_b32 v233, 0
    v_mov_b32 v237, 0
    v_mov_b32 v230, 0
    v_mov_b32 v234, 0
    v_mov_b32 v238, 0
    v_mov_b32 v231, 0
    v_mov_b32 v235, 0
    v_mov_b32 v239, 0
    s_xor_b32 s61, s26, 4
    s_lshl_b32 s61, s61, 9
    s_add_u32 s61, s61, 69632
    v_lshl_add_u32 v153, v1, 2, s61
    ds_read_b32 v154, v153
    ds_read_b32 v155, v153 offset:256
    s_waitcnt lgkmcnt(0)
    v_add_f32 v244, v244, v154
    v_add_f32 v245, v245, v155
    v_mov_b32 v154, v244
    v_mov_b32 v155, v245
    s_nop 0
    v_permlane32_swap_b32 v244, v154
    v_permlane32_swap_b32 v245, v155
    v_add_f32 v244, v244, v154
    v_add_f32 v245, v245, v155
    v_mul_f32 v244, 0x3b000000, v244
    v_mul_f32 v245, 0x3b000000, v245
    v_fma_f32 v245, -v244, v244, v245
    v_max_f32 v245, 0, v245
    v_cvt_pk_bf16_f32 v154, v245, -v244
    v_lshlrev_b32 v155, 16, v154
    v_add_f32 v155, 0x3727c5ac, v155
    v_cvt_pk_bf16_f32 v155, v155, v155
    v_lshlrev_b32 v155, 16, v155
    v_sqrt_f32 v155, v155
    s_nop 0
    v_cvt_pk_bf16_f32 v155, v155, v155
    v_and_b32 v241, 0xffff0000, v155
    v_rcp_f32 v240, v241
    v_lshrrev_b32 v155, 16, v154
    v_cmp_gt_u32 vcc, 32, v1
    v_lshl_or_b32 v156, v155, 16, v155
    v_or_b32 v157, v241, v155
    v_cndmask_b32 v228, 0, v156, vcc
    v_cndmask_b32 v229, 0, v157, vcc
    v_mul_f32 v242, 0xc0135761, v240
    v_mul_f32 v243, v240, v240
    v_mul_f32 v243, v243, v240
    v_mul_f32 v243, 0xbdd2d3e8, v243
    v_mul_f32 v246, 0x3eb8aa3b, v240
    s_waitcnt vmcnt(18)
    v_readfirstlane_b32 s100, v253
    s_nop 0
    s_cmp_lg_u32 s100, 0
    s_cbranch_scc1 L_k1_tty0d
    s_mov_b32 s62, 0x40000
    v_mov_b32 v11, 0
L_k1_tty0:
    global_load_dword v253, v11, s[22:23] sc1
    s_waitcnt vmcnt(0)
    v_readfirstlane_b32 s100, v253
    s_sub_u32 s62, s62, 1
    s_cbranch_scc1 L_k1_tty0d
    s_cmp_eq_u32 s100, 0
    s_cbranch_scc1 L_k1_tty0
L_k1_tty0d:
    s_waitcnt vmcnt(10)
    s_waitcnt lgkmcnt(0)
    s_barrier
    s_setprio 3
    ds_read_b64_tr_b16 v[144:145], v212 offset:0
    ds_read_b64_tr_b16 v[146:147], v212 offset:256
    ds_read_b64_tr_b16 v[148:149], v212 offset:512
    ds_read_b64_tr_b16 v[150:151], v212 offset:768
    ds_read_b64_tr_b16 v[152:153], v212 offset:1024
    ds_read_b64_tr_b16 v[154:155], v212 offset:1280
    ds_read_b64_tr_b16 v[156:157], v212 offset:1536
    ds_read_b64_tr_b16 v[158:159], v212 offset:1792
    ds_read_b64_tr_b16 v[160:161], v212 offset:16384
    ds_read_b64_tr_b16 v[162:163], v212 offset:16640
    ds_read_b64_tr_b16 v[164:165], v212 offset:16896
    ds_read_b64_tr_b16 v[166:167], v212 offset:17152
    ds_read_b64_tr_b16 v[168:169], v212 offset:17408
    ds_read_b64_tr_b16 v[170:171], v212 offset:17664
    s_waitcnt lgkmcnt(12)
    v_mfma_f32_32x32x16_bf16 v[176:191], v[144:147], v[16:19], 0
    v_mfma_f32_16x16x32_bf16 v[220:223], v[216:219], v[144:147], 0
    ds_read_b64_tr_b16 v[172:173], v212 offset:17920
    ds_read_b64_tr_b16 v[174:175], v212 offset:18176
    s_waitcnt lgkmcnt(12)
    v_mfma_f32_32x32x16_bf16 v[192:207], v[148:151], v[16:19], 0
    v_mfma_f32_16x16x32_bf16 v[224:227], v[216:219], v[148:151], 0
    ds_read_b64_tr_b16 v[144:145], v213 offset:0
    ds_read_b64_tr_b16 v[146:147], v213 offset:256
    s_waitcnt lgkmcnt(12)
    v_mfma_f32_32x32x16_bf16 v[176:191], v[152:155], v[20:23], v[176:191]
    v_mfma_f32_16x16x32_bf16 v[220:223], v[216:219], v[152:155], v[220:223]
    ds_read_b64_tr_b16 v[148:149], v213 offset:512
    ds_read_b64_tr_b16 v[150:151], v213 offset:768
    s_waitcnt lgkmcnt(12)
    v_mfma_f32_32x32x16_bf16 v[192:207], v[156:159], v[20:23], v[192:207]
    v_mfma_f32_16x16x32_bf16 v[224:227], v[216:219], v[156:159], v[224:227]
    ds_read_b64_tr_b16 v[152:153], v213 offset:1024
    ds_read_b64_tr_b16 v[154:155], v213 offset:1280
    s_waitcnt lgkmcnt(12)
    v_mfma_f32_32x32x16_bf16 v[176:191], v[160:163], v[24:27], v[176:191]
    v_mfma_f32_16x16x32_bf16 v[220:223], v[216:219], v[160:163], v[220:223]
    ds_read_b64_tr_b16 v[156:157], v213 offset:1536
    ds_read_b64_tr_b16 v[158:159], v213 offset:1792
    s_waitcnt lgkmcnt(12)
    v_mfma_f32_32x32x16_bf16 v[192:207], v[164:167], v[24:27], v[192:207]
    v_mfma_f32_16x16x32_bf16 v[224:227], v[216:219], v[164:167], v[224:227]
    ds_read_b64_tr_b16 v[160:161], v213 offset:16384
    ds_read_b64_tr_b16 v[162:163], v213 offset:16640
    s_waitcnt lgkmcnt(12)
    v_mfma_f32_32x32x16_bf16 v[176:191], v[168:171], v[28:31], v[176:191]
    v_mfma_f32_16x16x32_bf16 v[220:223], v[216:219], v[168:171], v[220:223]
    ds_read_b64_tr_b16 v[164:165], v213 offset:16896
    ds_read_b64_tr_b16 v[166:167], v213 offset:17152
    s_waitcnt lgkmcnt(12)
    v_mfma_f32_32x32x16_bf16 v[192:207], v[172:175], v[28:31], v[192:207]
    v_mfma_f32_16x16x32_bf16 v[224:227], v[216:219], v[172:175], v[224:227]
    ds_read_b64_tr_b16 v[168:169], v213 offset:17408
    ds_read_b64_tr_b16 v[170:171], v213 offset:17664
    s_waitcnt lgkmcnt(12)
    v_mfma_f32_32x32x16_bf16 v[176:191], v[144:147], v[32:35], v[176:191]
    ds_read_b64_tr_b16 v[172:173], v213 offset:17920
    ds_read_b64_tr_b16 v[174:175], v213 offset:18176
    s_waitcnt lgkmcnt(12)
    v_mfma_f32_32x32x16_bf16 v[192:207], v[148:151], v[32:35], v[192:207]
    ds_read_b64_tr_b16 v[144:145], v214 offset:0
    ds_read_b64_tr_b16 v[146:147], v214 offset:256
    s_waitcnt lgkmcnt(12)
    v_mfma_f32_32x32x16_bf16 v[176:191], v[152:155], v[36:39], v[176:191]
    ds_read_b64_tr_b16 v[148:149], v214 offset:512
    ds_read_b64_tr_b16 v[150:151], v214 offset:768
    s_waitcnt lgkmcnt(12)
    v_mfma_f32_32x32x16_bf16 v[192:207], v[156:159], v[36:39], v[192:207]
    ds_read_b64_tr_b16 v[152:153], v214 offset:1024
    ds_read_b64_tr_b16 v[154:155], v214 offset:1280
    s_waitcnt lgkmcnt(12)
    v_mfma_f32_32x32x16_bf16 v[176:191], v[160:163], v[40:43], v[176:191]
    ds_read_b64_tr_b16 v[156:157], v214 offset:1536
    ds_read_b64_tr_b16 v[158:159], v214 offset:1792
    s_waitcnt lgkmcnt(12)
    v_mfma_f32_32x32x16_bf16 v[192:207], v[164:167], v[40:43], v[192:207]
    ds_read_b64_tr_b16 v[160:161], v214 offset:16384
    ds_read_b64_tr_b16 v[162:163], v214 offset:16640
    s_waitcnt lgkmcnt(12)
    v_mfma_f32_32x32x16_bf16 v[176:191], v[168:171], v[44:47], v[176:191]
    ds_read_b64_tr_b16 v[164:165], v214 offset:16896
    ds_read_b64_tr_b16 v[166:167], v214 offset:17152
    s_waitcnt lgkmcnt(12)
    v_mfma_f32_32x32x16_bf16 v[192:207], v[172:175], v[44:47], v[192:207]
    ds_read_b64_tr_b16 v[168:169], v214 offset:17408
    ds_read_b64_tr_b16 v[170:171], v214 offset:17664
    s_waitcnt lgkmcnt(12)
    v_mfma_f32_32x32x16_bf16 v[176:191], v[144:147], v[48:51], v[176:191]
    ds_read_b64_tr_b16 v[172:173], v214 offset:17920
    ds_read_b64_tr_b16 v[174:175], v214 offset:18176
    s_waitcnt lgkmcnt(12)
    v_mfma_f32_32x32x16_bf16 v[192:207], v[148:151], v[48:51], v[192:207]
    ds_read_b64_tr_b16 v[144:145], v215 offset:0
    ds_read_b64_tr_b16 v[146:147], v215 offset:256
    s_waitcnt lgkmcnt(12)
    v_mfma_f32_32x32x16_bf16 v[176:191], v[152:155], v[52:55], v[176:191]
    ds_read_b64_tr_b16 v[148:149], v215 offset:512
    ds_read_b64_tr_b16 v[150:151], v215 offset:768
    s_waitcnt lgkmcnt(12)
    v_mfma_f32_32x32x16_bf16 v[192:207], v[156:159], v[52:55], v[192:207]
    ds_read_b64_tr_b16 v[152:153], v215 offset:1024
    ds_read_b64_tr_b16 v[154:155], v215 offset:1280
    s_waitcnt lgkmcnt(12)
    v_mfma_f32_32x32x16_bf16 v[176:191], v[160:163], v[56:59], v[176:191]
    ds_read_b64_tr_b16 v[156:157], v215 offset:1536
    ds_read_b64_tr_b16 v[158:159], v215 offset:1792
    s_waitcnt lgkmcnt(12)
    v_mfma_f32_32x32x16_bf16 v[192:207], v[164:167], v[56:59], v[192:207]
    ds_read_b64_tr_b16 v[160:161], v215 offset:16384
    ds_read_b64_tr_b16 v[162:163], v215 offset:16640
    s_waitcnt lgkmcnt(12)
    v_mfma_f32_32x32x16_bf16 v[176:191], v[168:171], v[60:63], v[176:191]
    ds_read_b64_tr_b16 v[164:165], v215 offset:16896
    ds_read_b64_tr_b16 v[166:167], v215 offset:17152
    s_waitcnt lgkmcnt(12)
    v_mfma_f32_32x32x16_bf16 v[192:207], v[172:175], v[60:63], v[192:207]
    ds_read_b64_tr_b16 v[168:169], v215 offset:17408
    ds_read_b64_tr_b16 v[170:171], v215 offset:17664
    s_waitcnt lgkmcnt(12)
    v_mfma_f32_32x32x16_bf16 v[176:191], v[144:147], v[64:67], v[176:191]
    ds_read_b64_tr_b16 v[172:173], v215 offset:17920
    ds_read_b64_tr_b16 v[174:175], v215 offset:18176
    s_waitcnt lgkmcnt(12)
    v_mfma_f32_32x32x16_bf16 v[192:207], v[148:151], v[64:67], v[192:207]
    s_waitcnt lgkmcnt(10)
    v_mfma_f32_32x32x16_bf16 v[176:191], v[152:155], v[68:71], v[176:191]
    s_waitcnt lgkmcnt(8)
    v_mfma_f32_32x32x16_bf16 v[192:207], v[156:159], v[68:71], v[192:207]
    s_waitcnt vmcnt(2)
    s_waitcnt lgkmcnt(0)
    s_barrier
    ds_read_b64_tr_b16 v[144:145], v212 offset:32768
    ds_read_b64_tr_b16 v[146:147], v212 offset:33024
    ds_read_b64_tr_b16 v[148:149], v212 offset:33280
    ds_read_b64_tr_b16 v[150:151], v212 offset:33536
    ds_read_b64_tr_b16 v[152:153], v212 offset:33792
    ds_read_b64_tr_b16 v[154:155], v212 offset:34048
    v_mfma_f32_32x32x16_bf16 v[176:191], v[160:163], v[72:75], v[176:191]
    ds_read_b64_tr_b16 v[156:157], v212 offset:34304
    ds_read_b64_tr_b16 v[158:159], v212 offset:34560
    v_mfma_f32_32x32x16_bf16 v[192:207], v[164:167], v[72:75], v[192:207]
    ds_read_b64_tr_b16 v[160:161], v212 offset:49152
    ds_read_b64_tr_b16 v[162:163], v212 offset:49408
    v_mfma_f32_32x32x16_bf16 v[176:191], v[168:171], v[76:79], v[176:191]
    ds_read_b64_tr_b16 v[164:165], v212 offset:49664
    ds_read_b64_tr_b16 v[166:167], v212 offset:49920
    v_mfma_f32_32x32x16_bf16 v[192:207], v[172:175], v[76:79], v[192:207]
    ds_read_b64_tr_b16 v[168:169], v212 offset:50176
    ds_read_b64_tr_b16 v[170:171], v212 offset:50432
    s_waitcnt lgkmcnt(12)
    v_mfma_f32_32x32x16_bf16 v[176:191], v[144:147], v[80:83], v[176:191]
    v_mfma_f32_16x16x32_bf16 v[220:223], v[216:219], v[144:147], v[220:223]
    ds_read_b64_tr_b16 v[172:173], v212 offset:50688
    ds_read_b64_tr_b16 v[174:175], v212 offset:50944
    s_waitcnt lgkmcnt(12)
    v_mfma_f32_32x32x16_bf16 v[192:207], v[148:151], v[80:83], v[192:207]
    v_mfma_f32_16x16x32_bf16 v[224:227], v[216:219], v[148:151], v[224:227]
    ds_read_b64_tr_b16 v[144:145], v213 offset:32768
    ds_read_b64_tr_b16 v[146:147], v213 offset:33024
    s_waitcnt lgkmcnt(12)
    v_mfma_f32_32x32x16_bf16 v[176:191], v[152:155], v[84:87], v[176:191]
    v_mfma_f32_16x16x32_bf16 v[220:223], v[216:219], v[152:155], v[220:223]
    ds_read_b64_tr_b16 v[148:149], v213 offset:33280
    ds_read_b64_tr_b16 v[150:151], v213 offset:33536
    s_waitcnt lgkmcnt(12)
    v_mfma_f32_32x32x16_bf16 v[192:207], v[156:159], v[84:87], v[192:207]
    v_mfma_f32_16x16x32_bf16 v[224:227], v[216:219], v[156:159], v[224:227]
    ds_read_b64_tr_b16 v[152:153], v213 offset:33792
    ds_read_b64_tr_b16 v[154:155], v213 offset:34048
    s_waitcnt lgkmcnt(12)
    v_mfma_f32_32x32x16_bf16 v[176:191], v[160:163], v[88:91], v[176:191]
    v_mfma_f32_16x16x32_bf16 v[220:223], v[216:219], v[160:163], v[220:223]
    ds_read_b64_tr_b16 v[156:157], v213 offset:34304
    ds_read_b64_tr_b16 v[158:159], v213 offset:34560
    s_waitcnt lgkmcnt(12)
    v_mfma_f32_32x32x16_bf16 v[192:207], v[164:167], v[88:91], v[192:207]
    v_mfma_f32_16x16x32_bf16 v[224:227], v[216:219], v[164:167], v[224:227]
    ds_read_b64_tr_b16 v[160:161], v213 offset:49152
    ds_read_b64_tr_b16 v[162:163], v213 offset:49408
    s_waitcnt lgkmcnt(12)
    v_mfma_f32_32x32x16_bf16 v[176:191], v[168:171], v[92:95], v[176:191]
    v_mfma_f32_16x16x32_bf16 v[220:223], v[216:219], v[168:171], v[220:223]
    ds_read_b64_tr_b16 v[164:165], v213 offset:49664
    ds_read_b64_tr_b16 v[166:167], v213 offset:49920
    s_waitcnt lgkmcnt(12)
    v_mfma_f32_32x32x16_bf16 v[192:207], v[172:175], v[92:95], v[192:207]
    v_mfma_f32_16x16x32_bf16 v[224:227], v[216:219], v[172:175], v[224:227]
    ds_read_b64_tr_b16 v[168:169], v213 offset:50176
    ds_read_b64_tr_b16 v[170:171], v213 offset:50432
    s_waitcnt lgkmcnt(12)
    v_mfma_f32_32x32x16_bf16 v[176:191], v[144:147], v[96:99], v[176:191]
    ds_read_b64_tr_b16 v[172:173], v213 offset:50688
    ds_read_b64_tr_b16 v[174:175], v213 offset:50944
    s_waitcnt lgkmcnt(12)
    v_mfma_f32_32x32x16_bf16 v[192:207], v[148:151], v[96:99], v[192:207]
    ds_read_b64_tr_b16 v[144:145], v214 offset:32768
    ds_read_b64_tr_b16 v[146:147], v214 offset:33024
    s_waitcnt lgkmcnt(12)
    v_mfma_f32_32x32x16_bf16 v[176:191], v[152:155], v[100:103], v[176:191]
    ds_read_b64_tr_b16 v[148:149], v214 offset:33280
    ds_read_b64_tr_b16 v[150:151], v214 offset:33536
    s_waitcnt lgkmcnt(12)
    v_mfma_f32_32x32x16_bf16 v[192:207], v[156:159], v[100:103], v[192:207]
    ds_read_b64_tr_b16 v[152:153], v214 offset:33792
    ds_read_b64_tr_b16 v[154:155], v214 offset:34048
    s_waitcnt lgkmcnt(12)
    v_mfma_f32_32x32x16_bf16 v[176:191], v[160:163], v[104:107], v[176:191]
    ds_read_b64_tr_b16 v[156:157], v214 offset:34304
    ds_read_b64_tr_b16 v[158:159], v214 offset:34560
    s_waitcnt lgkmcnt(12)
    v_mfma_f32_32x32x16_bf16 v[192:207], v[164:167], v[104:107], v[192:207]
    ds_read_b64_tr_b16 v[160:161], v214 offset:49152
    ds_read_b64_tr_b16 v[162:163], v214 offset:49408
    s_waitcnt lgkmcnt(12)
    v_mfma_f32_32x32x16_bf16 v[176:191], v[168:171], v[108:111], v[176:191]
    ds_read_b64_tr_b16 v[164:165], v214 offset:49664
    ds_read_b64_tr_b16 v[166:167], v214 offset:49920
    s_waitcnt lgkmcnt(12)
    v_mfma_f32_32x32x16_bf16 v[192:207], v[172:175], v[108:111], v[192:207]
    ds_read_b64_tr_b16 v[168:169], v214 offset:50176
    ds_read_b64_tr_b16 v[170:171], v214 offset:50432
    s_waitcnt lgkmcnt(12)
    v_mfma_f32_32x32x16_bf16 v[176:191], v[144:147], v[112:115], v[176:191]
    ds_read_b64_tr_b16 v[172:173], v214 offset:50688
    ds_read_b64_tr_b16 v[174:175], v214 offset:50944
    s_waitcnt lgkmcnt(12)
    v_mfma_f32_32x32x16_bf16 v[192:207], v[148:151], v[112:115], v[192:207]
    v_cndmask_b32 v11, v220, v221, s[52:53]
    ds_write_b32 v5, v11 offset:1024
    ds_read_b64_tr_b16 v[144:145], v215 offset:32768
    ds_read_b64_tr_b16 v[146:147], v215 offset:33024
    s_waitcnt lgkmcnt(13)
    v_mfma_f32_32x32x16_bf16 v[176:191], v[152:155], v[116:119], v[176:191]
    ds_read_b64_tr_b16 v[148:149], v215 offset:33280
    ds_read_b64_tr_b16 v[150:151], v215 offset:33536
    s_waitcnt lgkmcnt(13)
    v_mfma_f32_32x32x16_bf16 v[192:207], v[156:159], v[116:119], v[192:207]
    v_cndmask_b32 v12, v224, v225, s[52:53]
    ds_write_b32 v5, v12 offset:1536
    ds_read_b64_tr_b16 v[152:153], v215 offset:33792
    ds_read_b64_tr_b16 v[154:155], v215 offset:34048
    s_waitcnt lgkmcnt(14)
    v_mfma_f32_32x32x16_bf16 v[176:191], v[160:163], v[120:123], v[176:191]
    ds_read_b64_tr_b16 v[156:157], v215 offset:34304
    ds_read_b64_tr_b16 v[158:159], v215 offset:34560
    s_waitcnt lgkmcnt(14)
    v_mfma_f32_32x32x16_bf16 v[192:207], v[164:167], v[120:123], v[192:207]
    ds_read_b64_tr_b16 v[160:161], v215 offset:49152
    ds_read_b64_tr_b16 v[162:163], v215 offset:49408
    s_waitcnt lgkmcnt(14)
    v_mfma_f32_32x32x16_bf16 v[176:191], v[168:171], v[124:127], v[176:191]
    ds_read_b64_tr_b16 v[164:165], v215 offset:49664
    ds_read_b64_tr_b16 v[166:167], v215 offset:49920
    s_waitcnt lgkmcnt(14)
    v_mfma_f32_32x32x16_bf16 v[192:207], v[172:175], v[124:127], v[192:207]
    ds_read_b64_tr_b16 v[168:169], v215 offset:50176
    ds_read_b64_tr_b16 v[170:171], v215 offset:50432
    s_waitcnt lgkmcnt(13)
    v_mfma_f32_32x32x16_bf16 v[176:191], v[144:147], v[128:131], v[176:191]
    ds_read_b64_tr_b16 v[172:173], v215 offset:50688
    ds_read_b64_tr_b16 v[174:175], v215 offset:50944
    s_waitcnt lgkmcnt(13)
    v_mfma_f32_32x32x16_bf16 v[192:207], v[148:151], v[128:131], v[192:207]
    s_waitcnt lgkmcnt(10)
    v_mfma_f32_32x32x16_bf16 v[176:191], v[152:155], v[132:135], v[176:191]
    s_waitcnt lgkmcnt(8)
    v_mfma_f32_32x32x16_bf16 v[192:207], v[156:159], v[132:135], v[192:207]
    s_waitcnt lgkmcnt(0)
    s_barrier
    v_mfma_f32_32x32x16_bf16 v[176:191], v[160:163], v[136:139], v[176:191]
    v_mfma_f32_32x32x16_bf16 v[192:207], v[164:167], v[136:139], v[192:207]
    v_mfma_f32_32x32x16_bf16 v[176:191], v[168:171], v[140:143], v[176:191]
    v_mfma_f32_32x32x16_bf16 v[192:207], v[172:175], v[140:143], v[192:207]
    s_setprio 0
    s_add_u32 m0, s65, 98304
    s_mov_b32 s60, s59
    buffer_load_dwordx4 v8, s[32:35], s60 offen lds
    ds_read_b128 v[160:163], v6 offset:1024
    ds_read_b128 v[164:167], v6 offset:1536
    s_waitcnt lgkmcnt(0)
    v_add_f32 v160, v160, v161
    v_add_f32 v162, v162, v163
    v_add_f32 v144, v160, v162
    v_and_b32 v145, 0xffff0000, v144
    v_sub_f32 v146, v144, v145
    v_and_b32 v147, 0xffff0000, v146
    v_sub_f32 v146, v146, v147
    v_lshrrev_b32 v145, 16, v145
    v_or_b32 v232, v145, v147
    v_lshrrev_b32 v233, 16, v146
    v_add_f32 v164, v164, v165
    v_add_f32 v166, v166, v167
    v_add_f32 v144, v164, v166
    v_and_b32 v145, 0xffff0000, v144
    v_sub_f32 v146, v144, v145
    v_and_b32 v147, 0xffff0000, v146
    v_sub_f32 v146, v146, v147
    v_lshrrev_b32 v145, 16, v145
    v_or_b32 v236, v145, v147
    v_lshrrev_b32 v237, 16, v146
    s_add_u32 m0, s65, 99328
    s_addk_i32 s60, 28672
    buffer_load_dwordx4 v8, s[32:35], s60 offen lds
    v_mfma_f32_32x32x16_bf16 v[176:191], v[232:235], v[228:231], v[176:191]
    s_add_u32 m0, s65, 100352
    s_addk_i32 s60, 28672
    buffer_load_dwordx4 v8, s[32:35], s60 offen lds
    v_mfma_f32_32x32x16_bf16 v[192:207], v[236:239], v[228:231], v[192:207]
    s_nop 7
    v_mul_f32 v176, v176, v246
    v_mul_f32 v177, v177, v246
    v_mul_f32 v178, v178, v246
    s_add_u32 m0, s65, 101376
    s_addk_i32 s60, 28672
    buffer_load_dwordx4 v8, s[32:35], s60 offen lds
    v_mul_f32 v179, v179, v246
    v_mul_f32 v180, v180, v246
    v_mul_f32 v181, v181, v246
    v_mul_f32 v182, v182, v246
    v_mul_f32 v183, v183, v246
    v_cvt_pk_bf16_f32 v160, v176, v177
    v_cvt_pk_bf16_f32 v161, v178, v179
    v_cvt_pk_bf16_f32 v162, v180, v181
    v_cvt_pk_bf16_f32 v163, v182, v183
    s_add_u32 s61, s68, 0
    buffer_store_dwordx4 v[160:163], v2, s[36:39], s61 offen sc1
    s_add_u32 m0, s65, 102400
    s_addk_i32 s60, 28672
    buffer_load_dwordx4 v8, s[32:35], s60 offen lds
    v_mul_f32 v184, v184, v246
    v_mul_f32 v185, v185, v246
    v_mul_f32 v186, v186, v246
    v_mul_f32 v187, v187, v246
    v_mul_f32 v188, v188, v246
    v_mul_f32 v189, v189, v246
    v_mul_f32 v190, v190, v246
    v_mul_f32 v191, v191, v246
    v_cvt_pk_bf16_f32 v164, v184, v185
    v_cvt_pk_bf16_f32 v165, v186, v187
    v_cvt_pk_bf16_f32 v166, v188, v189
    s_add_u32 m0, s65, 103424
    s_addk_i32 s60, 28672
    buffer_load_dwordx4 v8, s[32:35], s60 offen lds
    v_cvt_pk_bf16_f32 v167, v190, v191
    s_add_u32 s61, s68, 65536
    buffer_store_dwordx4 v[164:167], v2, s[36:39], s61 offen sc1
    v_mul_f32 v192, v192, v246
    v_mul_f32 v193, v193, v246
    v_mul_f32 v194, v194, v246
    v_mul_f32 v195, v195, v246
    s_add_u32 m0, s65, 104448
    s_addk_i32 s60, 28672
    buffer_load_dwordx4 v8, s[32:35], s60 offen lds
    v_mul_f32 v196, v196, v246
    v_mul_f32 v197, v197, v246
    v_mul_f32 v198, v198, v246
    v_mul_f32 v199, v199, v246
    v_cvt_pk_bf16_f32 v168, v192, v193
    v_cvt_pk_bf16_f32 v169, v194, v195
    v_cvt_pk_bf16_f32 v170, v196, v197
    v_cvt_pk_bf16_f32 v171, v198, v199
    s_add_u32 s61, s68, 131072
    buffer_store_dwordx4 v[168:171], v2, s[36:39], s61 offen sc1
    s_add_u32 m0, s65, 105472
    s_addk_i32 s60, 28672
    buffer_load_dwordx4 v8, s[32:35], s60 offen lds
    v_mul_f32 v200, v200, v246
    v_mul_f32 v201, v201, v246
    v_mul_f32 v202, v202, v246
    v_mul_f32 v203, v203, v246
    v_mul_f32 v204, v204, v246
    v_mul_f32 v205, v205, v246
    v_mul_f32 v206, v206, v246
    v_mul_f32 v207, v207, v246
    v_cvt_pk_bf16_f32 v172, v200, v201
    v_cvt_pk_bf16_f32 v173, v202, v203
    v_cvt_pk_bf16_f32 v174, v204, v205
    v_cvt_pk_bf16_f32 v175, v206, v207
    s_add_u32 s61, s68, 196608
    buffer_store_dwordx4 v[172:175], v2, s[36:39], s61 offen sc1
    s_waitcnt lgkmcnt(0)
    s_barrier
    s_waitcnt vmcnt(0)
    s_add_u32 s61, s73, 20316160
    v_lshlrev_b32 v11, 2, v1
    v_mov_b32 v12, s100
    s_mov_b32 exec_hi, 0
    buffer_store_dword v12, v11, s[36:39], s61 offen sc1
    s_mov_b64 exec, -1
    s_waitcnt lgkmcnt(0)
    s_barrier
    s_setprio 3
    ds_read_b64_tr_b16 v[144:145], v212 offset:0
    ds_read_b64_tr_b16 v[146:147], v212 offset:256
    ds_read_b64_tr_b16 v[148:149], v212 offset:512
    ds_read_b64_tr_b16 v[150:151], v212 offset:768
    ds_read_b64_tr_b16 v[152:153], v212 offset:1024
    ds_read_b64_tr_b16 v[154:155], v212 offset:1280
    ds_read_b64_tr_b16 v[156:157], v212 offset:1536
    ds_read_b64_tr_b16 v[158:159], v212 offset:1792
    ds_read_b64_tr_b16 v[160:161], v212 offset:16384
    ds_read_b64_tr_b16 v[162:163], v212 offset:16640
    ds_read_b64_tr_b16 v[164:165], v212 offset:16896
    ds_read_b64_tr_b16 v[166:167], v212 offset:17152
    ds_read_b64_tr_b16 v[168:169], v212 offset:17408
    ds_read_b64_tr_b16 v[170:171], v212 offset:17664
    s_waitcnt lgkmcnt(12)
    v_mfma_f32_32x32x16_bf16 v[176:191], v[144:147], v[16:19], 0
    v_mfma_f32_16x16x32_bf16 v[220:223], v[216:219], v[144:147], 0
    ds_read_b64_tr_b16 v[172:173], v212 offset:17920
    ds_read_b64_tr_b16 v[174:175], v212 offset:18176
    s_waitcnt lgkmcnt(12)
    v_mfma_f32_32x32x16_bf16 v[176:191], v[148:151], v[80:83], v[176:191]
    v_mfma_f32_16x16x32_bf16 v[220:223], v[216:219], v[148:151], v[220:223]
    ds_read_b64_tr_b16 v[144:145], v213 offset:0
    ds_read_b64_tr_b16 v[146:147], v213 offset:256
    s_waitcnt lgkmcnt(12)
    v_mfma_f32_32x32x16_bf16 v[176:191], v[152:155], v[20:23], v[176:191]
    v_mfma_f32_16x16x32_bf16 v[220:223], v[216:219], v[152:155], v[220:223]
    ds_read_b64_tr_b16 v[148:149], v213 offset:512
    ds_read_b64_tr_b16 v[150:151], v213 offset:768
    s_waitcnt lgkmcnt(12)
    v_mfma_f32_32x32x16_bf16 v[176:191], v[156:159], v[84:87], v[176:191]
    v_mfma_f32_16x16x32_bf16 v[220:223], v[216:219], v[156:159], v[220:223]
    ds_read_b64_tr_b16 v[152:153], v213 offset:1024
    ds_read_b64_tr_b16 v[154:155], v213 offset:1280
    s_waitcnt lgkmcnt(12)
    v_mfma_f32_32x32x16_bf16 v[176:191], v[160:163], v[24:27], v[176:191]
    v_mfma_f32_16x16x32_bf16 v[220:223], v[216:219], v[160:163], v[220:223]
    ds_read_b64_tr_b16 v[156:157], v213 offset:1536
    ds_read_b64_tr_b16 v[158:159], v213 offset:1792
    s_waitcnt lgkmcnt(12)
    v_mfma_f32_32x32x16_bf16 v[176:191], v[164:167], v[88:91], v[176:191]
    v_mfma_f32_16x16x32_bf16 v[220:223], v[216:219], v[164:167], v[220:223]
    ds_read_b64_tr_b16 v[160:161], v213 offset:16384
    ds_read_b64_tr_b16 v[162:163], v213 offset:16640
    s_waitcnt lgkmcnt(12)
    v_mfma_f32_32x32x16_bf16 v[176:191], v[168:171], v[28:31], v[176:191]
    v_mfma_f32_16x16x32_bf16 v[220:223], v[216:219], v[168:171], v[220:223]
    ds_read_b64_tr_b16 v[164:165], v213 offset:16896
    ds_read_b64_tr_b16 v[166:167], v213 offset:17152
    s_waitcnt lgkmcnt(12)
    v_mfma_f32_32x32x16_bf16 v[176:191], v[172:175], v[92:95], v[176:191]
    v_mfma_f32_16x16x32_bf16 v[220:223], v[216:219], v[172:175], v[220:223]
    ds_read_b64_tr_b16 v[168:169], v213 offset:17408
    ds_read_b64_tr_b16 v[170:171], v213 offset:17664
    s_waitcnt lgkmcnt(12)
    v_mfma_f32_32x32x16_bf16 v[176:191], v[144:147], v[32:35], v[176:191]
    ds_read_b64_tr_b16 v[172:173], v213 offset:17920
    ds_read_b64_tr_b16 v[174:175], v213 offset:18176
    s_waitcnt lgkmcnt(12)
    v_mfma_f32_32x32x16_bf16 v[176:191], v[148:151], v[96:99], v[176:191]
    ds_read_b64_tr_b16 v[144:145], v214 offset:0
    ds_read_b64_tr_b16 v[146:147], v214 offset:256
    s_waitcnt lgkmcnt(12)
    v_mfma_f32_32x32x16_bf16 v[176:191], v[152:155], v[36:39], v[176:191]
    ds_read_b64_tr_b16 v[148:149], v214 offset:512
    ds_read_b64_tr_b16 v[150:151], v214 offset:768
    s_waitcnt lgkmcnt(12)
    v_mfma_f32_32x32x16_bf16 v[176:191], v[156:159], v[100:103], v[176:191]
    ds_read_b64_tr_b16 v[152:153], v214 offset:1024
    ds_read_b64_tr_b16 v[154:155], v214 offset:1280
    s_waitcnt lgkmcnt(12)
    v_mfma_f32_32x32x16_bf16 v[176:191], v[160:163], v[40:43], v[176:191]
    ds_read_b64_tr_b16 v[156:157], v214 offset:1536
    ds_read_b64_tr_b16 v[158:159], v214 offset:1792
    s_waitcnt lgkmcnt(12)
    v_mfma_f32_32x32x16_bf16 v[176:191], v[164:167], v[104:107], v[176:191]
    ds_read_b64_tr_b16 v[160:161], v214 offset:16384
    ds_read_b64_tr_b16 v[162:163], v214 offset:16640
    s_waitcnt lgkmcnt(12)
    v_mfma_f32_32x32x16_bf16 v[176:191], v[168:171], v[44:47], v[176:191]
    ds_read_b64_tr_b16 v[164:165], v214 offset:16896
    ds_read_b64_tr_b16 v[166:167], v214 offset:17152
    s_waitcnt lgkmcnt(12)
    v_mfma_f32_32x32x16_bf16 v[176:191], v[172:175], v[108:111], v[176:191]
    ds_read_b64_tr_b16 v[168:169], v214 offset:17408
    ds_read_b64_tr_b16 v[170:171], v214 offset:17664
    s_waitcnt lgkmcnt(12)
    v_mfma_f32_32x32x16_bf16 v[176:191], v[144:147], v[48:51], v[176:191]
    ds_read_b64_tr_b16 v[172:173], v214 offset:17920
    ds_read_b64_tr_b16 v[174:175], v214 offset:18176
    s_waitcnt lgkmcnt(12)
    v_mfma_f32_32x32x16_bf16 v[176:191], v[148:151], v[112:115], v[176:191]
    v_cndmask_b32 v11, v220, v221, s[52:53]
    ds_write_b32 v5, v11 offset:3072
    ds_read_b64_tr_b16 v[144:145], v215 offset:0
    ds_read_b64_tr_b16 v[146:147], v215 offset:256
    s_waitcnt lgkmcnt(13)
    v_mfma_f32_32x32x16_bf16 v[176:191], v[152:155], v[52:55], v[176:191]
    ds_read_b64_tr_b16 v[148:149], v215 offset:512
    ds_read_b64_tr_b16 v[150:151], v215 offset:768
    s_waitcnt lgkmcnt(13)
    v_mfma_f32_32x32x16_bf16 v[176:191], v[156:159], v[116:119], v[176:191]
    ds_read_b64_tr_b16 v[152:153], v215 offset:1024
    ds_read_b64_tr_b16 v[154:155], v215 offset:1280
    s_waitcnt lgkmcnt(13)
    v_mfma_f32_32x32x16_bf16 v[176:191], v[160:163], v[56:59], v[176:191]
    ds_read_b64_tr_b16 v[156:157], v215 offset:1536
    ds_read_b64_tr_b16 v[158:159], v215 offset:1792
    s_waitcnt lgkmcnt(13)
    v_mfma_f32_32x32x16_bf16 v[176:191], v[164:167], v[120:123], v[176:191]
    ds_read_b64_tr_b16 v[160:161], v215 offset:16384
    ds_read_b64_tr_b16 v[162:163], v215 offset:16640
    s_waitcnt lgkmcnt(13)
    v_mfma_f32_32x32x16_bf16 v[176:191], v[168:171], v[60:63], v[176:191]
    ds_read_b64_tr_b16 v[164:165], v215 offset:16896
    ds_read_b64_tr_b16 v[166:167], v215 offset:17152
    s_waitcnt lgkmcnt(13)
    v_mfma_f32_32x32x16_bf16 v[176:191], v[172:175], v[124:127], v[176:191]
    ds_read_b64_tr_b16 v[168:169], v215 offset:17408
    ds_read_b64_tr_b16 v[170:171], v215 offset:17664
    s_waitcnt lgkmcnt(12)
    v_mfma_f32_32x32x16_bf16 v[176:191], v[144:147], v[64:67], v[176:191]
    ds_read_b64_tr_b16 v[172:173], v215 offset:17920
    ds_read_b64_tr_b16 v[174:175], v215 offset:18176
    s_waitcnt lgkmcnt(12)
    v_mfma_f32_32x32x16_bf16 v[176:191], v[148:151], v[128:131], v[176:191]
    s_waitcnt lgkmcnt(10)
    v_mfma_f32_32x32x16_bf16 v[176:191], v[152:155], v[68:71], v[176:191]
    s_waitcnt lgkmcnt(8)
    v_mfma_f32_32x32x16_bf16 v[176:191], v[156:159], v[132:135], v[176:191]
    s_waitcnt lgkmcnt(0)
    s_barrier
    v_mfma_f32_32x32x16_bf16 v[176:191], v[160:163], v[72:75], v[176:191]
    v_mfma_f32_32x32x16_bf16 v[176:191], v[164:167], v[136:139], v[176:191]
    v_mfma_f32_32x32x16_bf16 v[176:191], v[168:171], v[76:79], v[176:191]
    v_mfma_f32_32x32x16_bf16 v[176:191], v[172:175], v[140:143], v[176:191]
    s_setprio 0
    s_setprio 3
    ds_read_b128 v[160:163], v6 offset:3072
    s_waitcnt lgkmcnt(0)
    v_add_f32 v160, v160, v161
    v_add_f32 v162, v162, v163
    v_add_f32 v144, v160, v162
    v_and_b32 v145, 0xffff0000, v144
    v_sub_f32 v146, v144, v145
    v_and_b32 v147, 0xffff0000, v146
    v_sub_f32 v146, v146, v147
    v_lshrrev_b32 v145, 16, v145
    v_or_b32 v232, v145, v147
    v_lshrrev_b32 v146, 16, v146
    v_lshl_or_b32 v233, v250, 16, v146
    s_nop 1
    v_mfma_f32_32x32x16_bf16 v[176:191], v[232:235], v[228:231], v[176:191]
    s_nop 11
    v_mul_f32 v144, v176, v176
    v_mul_f32 v145, v177, v177
    v_mul_f32 v146, v178, v178
    v_mul_f32 v147, v179, v179
    v_mul_f32 v148, v180, v180
    v_mul_f32 v149, v181, v181
    v_mul_f32 v150, v182, v182
    v_mul_f32 v151, v183, v183
    v_fma_f32 v144, v144, v243, v242
    v_fma_f32 v145, v145, v243, v242
    v_fma_f32 v146, v146, v243, v242
    v_fma_f32 v147, v147, v243, v242
    v_fma_f32 v148, v148, v243, v242
    v_fma_f32 v149, v149, v243, v242
    v_fma_f32 v150, v150, v243, v242
    v_fma_f32 v151, v151, v243, v242
    v_mul_f32 v144, v144, v176
    v_mul_f32 v145, v145, v177
    v_mul_f32 v146, v146, v178
    v_mul_f32 v147, v147, v179
    v_mul_f32 v148, v148, v180
    v_mul_f32 v149, v149, v181
    v_mul_f32 v150, v150, v182
    v_mul_f32 v151, v151, v183
    v_exp_f32 v144, v144
    v_exp_f32 v145, v145
    v_exp_f32 v146, v146
    v_and_b32 v14, 7, v1
    v_lshlrev_b32 v14, 7, v14
    s_cmp_eq_u32 s27, 0
    s_cselect_b32 s62, s89, 268435456
    buffer_load_dword v254, v14, s[36:39], s62 offen offset:0 sc1
    v_exp_f32 v147, v147
    v_exp_f32 v148, v148
    v_exp_f32 v149, v149
    v_exp_f32 v150, v150
    v_exp_f32 v151, v151
    v_fma_f32 v144, v144, v241, v241
    v_fma_f32 v145, v145, v241, v241
    v_fma_f32 v146, v146, v241, v241
    v_fma_f32 v147, v147, v241, v241
    v_fma_f32 v148, v148, v241, v241
    v_fma_f32 v149, v149, v241, v241
    v_fma_f32 v150, v150, v241, v241
    v_fma_f32 v151, v151, v241, v241
    v_rcp_f32 v144, v144
    v_rcp_f32 v145, v145
    v_rcp_f32 v146, v146
    v_rcp_f32 v147, v147
    v_rcp_f32 v148, v148
    v_rcp_f32 v149, v149
    v_rcp_f32 v150, v150
    v_rcp_f32 v151, v151
    v_mul_f32 v144, v144, v176
    v_mul_f32 v145, v145, v177
    v_mul_f32 v146, v146, v178
    v_mul_f32 v147, v147, v179
    v_mul_f32 v148, v148, v180
    v_mul_f32 v149, v149, v181
    v_mul_f32 v150, v150, v182
    v_mul_f32 v151, v151, v183
    v_cvt_pk_bf16_f32 v160, v144, v145
    v_cvt_pk_bf16_f32 v161, v146, v147
    v_cvt_pk_bf16_f32 v162, v148, v149
    v_cvt_pk_bf16_f32 v163, v150, v151
    buffer_store_dwordx4 v[160:163], v2, s[36:39], s67 offen offset:0 sc1
    v_mul_f32 v144, v184, v184
    v_mul_f32 v145, v185, v185
    v_mul_f32 v146, v186, v186
    v_mul_f32 v147, v187, v187
    v_mul_f32 v148, v188, v188
    v_mul_f32 v149, v189, v189
    v_mul_f32 v150, v190, v190
    v_mul_f32 v151, v191, v191
    v_fma_f32 v144, v144, v243, v242
    v_fma_f32 v145, v145, v243, v242
    v_fma_f32 v146, v146, v243, v242
    v_fma_f32 v147, v147, v243, v242
    v_fma_f32 v148, v148, v243, v242
    v_fma_f32 v149, v149, v243, v242
    v_fma_f32 v150, v150, v243, v242
    v_fma_f32 v151, v151, v243, v242
    v_mul_f32 v144, v144, v184
    v_mul_f32 v145, v145, v185
    v_mul_f32 v146, v146, v186
    s_cmp_lg_u32 s27, 0
    s_cbranch_scc1 L_k1_fqy0x
    s_mov_b32 s62, 0x40000
    s_waitcnt vmcnt(1)
L_k1_fqy0:
    v_xor_b32 v254, s100, v254
    v_cmp_ne_u32 vcc, 0, v254
    s_sub_u32 s62, s62, 1
    s_cbranch_scc1 L_k1_fqy0d
    s_nop 3
    s_cbranch_vccz L_k1_fqy0d
    s_sleep 4
    buffer_load_dword v254, v14, s[36:39], s89 offen offset:0 sc1
    s_waitcnt vmcnt(0)
    s_branch L_k1_fqy0
L_k1_fqy0d:
    v_mov_b32 v254, 96256
    v_mov_b32 v255, 1
    ds_write_b32 v254, v255 offset:20
L_k1_fqy0x:
    v_mov_b32 v11, 96256
L_k1_qwy020:
    ds_read_b32 v12, v11 offset:20
    s_waitcnt lgkmcnt(0)
    v_readfirstlane_b32 s62, v12
    s_nop 0
    s_cmp_eq_u32 s62, 0
    s_cbranch_scc1 L_k1_qwy020
    buffer_load_dwordx4 v[16:19], v2, s[36:39], s88 offen offset:0 sc1
    buffer_load_dwordx4 v[20:23], v2, s[36:39], s88 offen offset:1024 sc1
    v_mul_f32 v147, v147, v187
    v_mul_f32 v148, v148, v188
    v_mul_f32 v149, v149, v189
    v_mul_f32 v150, v150, v190
    v_mul_f32 v151, v151, v191
    v_exp_f32 v144, v144
    v_exp_f32 v145, v145
    v_exp_f32 v146, v146
    v_exp_f32 v147, v147
    v_exp_f32 v148, v148
    v_exp_f32 v149, v149
    v_exp_f32 v150, v150
    v_exp_f32 v151, v151
    v_fma_f32 v144, v144, v241, v241
    v_fma_f32 v145, v145, v241, v241
    v_fma_f32 v146, v146, v241, v241
    v_fma_f32 v147, v147, v241, v241
    v_fma_f32 v148, v148, v241, v241
    v_fma_f32 v149, v149, v241, v241
    v_fma_f32 v150, v150, v241, v241
    v_fma_f32 v151, v151, v241, v241
    v_rcp_f32 v144, v144
    v_rcp_f32 v145, v145
    v_rcp_f32 v146, v146
    v_rcp_f32 v147, v147
    v_rcp_f32 v148, v148
    v_rcp_f32 v149, v149
    v_rcp_f32 v150, v150
    v_rcp_f32 v151, v151
    v_mul_f32 v144, v144, v184
    v_mul_f32 v145, v145, v185
    v_mul_f32 v146, v146, v186
    v_mul_f32 v147, v147, v187
    v_mul_f32 v148, v148, v188
    v_mul_f32 v149, v149, v189
    v_mul_f32 v150, v150, v190
    v_mul_f32 v151, v151, v191
    v_cvt_pk_bf16_f32 v164, v144, v145
    v_cvt_pk_bf16_f32 v165, v146, v147
    v_cvt_pk_bf16_f32 v166, v148, v149
    v_cvt_pk_bf16_f32 v167, v150, v151
    buffer_store_dwordx4 v[164:167], v2, s[36:39], s67 offen offset:1024 sc1
    s_mov_b32 s96, s85
    s_mov_b32 s97, 0
    s_add_u32 s94, s72, 128
    s_mov_b32 s95, 268435456
    s_branch L_p2
L_k1_by:
    s_nop 4
    s_setprio 1
    s_xor_b32 m0, s90, 1024
    s_xor_b32 s60, s86, 4096
    buffer_load_dwordx4 v185, s[28:31], s60 offen lds
    s_xor_b32 m0, s91, 1024
    s_xor_b32 s60, s87, 4096
    buffer_load_dwordx4 v185, s[28:31], s60 offen lds
    s_xor_b32 m0, s90, 2048
    s_xor_b32 s60, s86, 8192
    buffer_load_dwordx4 v186, s[28:31], s60 offen lds
    s_xor_b32 m0, s91, 2048
    s_xor_b32 s60, s87, 8192
    buffer_load_dwordx4 v186, s[28:31], s60 offen lds
    s_xor_b32 m0, s90, 3072
    s_xor_b32 s60, s86, 12288
    buffer_load_dwordx4 v187, s[28:31], s60 offen lds
    s_xor_b32 m0, s91, 3072
    s_xor_b32 s60, s87, 12288
    buffer_load_dwordx4 v187, s[28:31], s60 offen lds
    s_xor_b32 m0, s90, 4096
    s_xor_b32 s60, s86, 16384
    buffer_load_dwordx4 v184, s[28:31], s60 offen lds
    s_xor_b32 m0, s91, 4096
    s_xor_b32 s60, s87, 16384
    buffer_load_dwordx4 v184, s[28:31], s60 offen lds
    s_xor_b32 m0, s90, 5120
    s_xor_b32 s60, s86, 20480
    buffer_load_dwordx4 v185, s[28:31], s60 offen lds
    s_xor_b32 m0, s91, 5120
    s_xor_b32 s60, s87, 20480
    buffer_load_dwordx4 v185, s[28:31], s60 offen lds
    s_xor_b32 m0, s90, 6144
    s_xor_b32 s60, s86, 24576
    buffer_load_dwordx4 v186, s[28:31], s60 offen lds
    s_xor_b32 m0, s91, 6144
    s_xor_b32 s60, s87, 24576
    buffer_load_dwordx4 v186, s[28:31], s60 offen lds
    s_xor_b32 m0, s90, 7168
    s_xor_b32 s60, s86, 28672
    buffer_load_dwordx4 v187, s[28:31], s60 offen lds
    s_xor_b32 m0, s91, 7168
    s_xor_b32 s60, s87, 28672
    buffer_load_dwordx4 v187, s[28:31], s60 offen lds
    s_waitcnt lgkmcnt(0)
    s_barrier
    ds_read_b128 v[16:19], v228 offset:0
    ds_read_b128 v[20:23], v229 offset:0
    ds_read_b128 v[24:27], v228 offset:32768
    ds_read_b128 v[28:31], v229 offset:32768
    ds_read_b128 v[32:35], v230 offset:0
    ds_read_b128 v[36:39], v231 offset:0
    ds_read_b128 v[40:43], v230 offset:32768
    ds_read_b128 v[44:47], v231 offset:32768
    ds_read_b128 v[48:51], v232 offset:0
    ds_read_b128 v[52:55], v233 offset:0
    ds_read_b128 v[56:59], v232 offset:32768
    ds_read_b128 v[60:63], v233 offset:32768
    ds_read_b128 v[64:67], v234 offset:0
    ds_read_b128 v[68:71], v235 offset:0
    ds_read_b128 v[72:75], v234 offset:32768
    ds_read_b128 v[76:79], v235 offset:32768
    v_add_u32 v228, 65536, v228
    v_add_u32 v229, 65536, v229
    v_add_u32 v230, 65536, v230
    v_add_u32 v231, 65536, v231
    v_add_u32 v232, 65536, v232
    v_add_u32 v233, 65536, v233
    v_add_u32 v234, 65536, v234
    v_add_u32 v235, 65536, v235
    s_waitcnt vmcnt(0)
    ds_read_b128 v[80:83], v228 offset:0
    ds_read_b128 v[84:87], v229 offset:0
    ds_read_b128 v[88:91], v228 offset:32768
    ds_read_b128 v[92:95], v229 offset:32768
    ds_read_b128 v[96:99], v230 offset:0
    ds_read_b128 v[100:103], v231 offset:0
    ds_read_b128 v[104:107], v230 offset:32768
    ds_read_b128 v[108:111], v231 offset:32768
    ds_read_b128 v[112:115], v232 offset:0
    ds_read_b128 v[116:119], v233 offset:0
    ds_read_b128 v[120:123], v232 offset:32768
    ds_read_b128 v[124:127], v233 offset:32768
    ds_read_b128 v[128:131], v234 offset:0
    ds_read_b128 v[132:135], v235 offset:0
    ds_read_b128 v[136:139], v234 offset:32768
    ds_read_b128 v[140:143], v235 offset:32768
    s_waitcnt lgkmcnt(15)
    v_dot2c_f32_bf16 v244, v80, v10
    v_dot2c_f32_bf16 v245, v80, v80
    v_dot2c_f32_bf16 v244, v81, v10
    v_dot2c_f32_bf16 v245, v81, v81
    v_dot2c_f32_bf16 v244, v82, v10
    v_dot2c_f32_bf16 v245, v82, v82
    v_dot2c_f32_bf16 v244, v83, v10
    v_dot2c_f32_bf16 v245, v83, v83
    s_waitcnt lgkmcnt(14)
    v_dot2c_f32_bf16 v244, v84, v10
    v_dot2c_f32_bf16 v245, v84, v84
    v_dot2c_f32_bf16 v244, v85, v10
    v_dot2c_f32_bf16 v245, v85, v85
    v_dot2c_f32_bf16 v244, v86, v10
    v_dot2c_f32_bf16 v245, v86, v86
    v_dot2c_f32_bf16 v244, v87, v10
    v_dot2c_f32_bf16 v245, v87, v87
    s_waitcnt lgkmcnt(13)
    v_dot2c_f32_bf16 v244, v88, v10
    v_dot2c_f32_bf16 v245, v88, v88
    v_dot2c_f32_bf16 v244, v89, v10
    v_dot2c_f32_bf16 v245, v89, v89
    v_dot2c_f32_bf16 v244, v90, v10
    v_dot2c_f32_bf16 v245, v90, v90
    v_dot2c_f32_bf16 v244, v91, v10
    v_dot2c_f32_bf16 v245, v91, v91
    s_waitcnt lgkmcnt(12)
    v_dot2c_f32_bf16 v244, v92, v10
    v_dot2c_f32_bf16 v245, v92, v92
    v_dot2c_f32_bf16 v244, v93, v10
    v_dot2c_f32_bf16 v245, v93, v93
    v_dot2c_f32_bf16 v244, v94, v10
    v_dot2c_f32_bf16 v245, v94, v94
    v_dot2c_f32_bf16 v244, v95, v10
    v_dot2c_f32_bf16 v245, v95, v95
    s_waitcnt lgkmcnt(11)
    v_dot2c_f32_bf16 v244, v96, v10
    v_dot2c_f32_bf16 v245, v96, v96
    v_dot2c_f32_bf16 v244, v97, v10
    v_dot2c_f32_bf16 v245, v97, v97
    v_dot2c_f32_bf16 v244, v98, v10
    v_dot2c_f32_bf16 v245, v98, v98
    v_dot2c_f32_bf16 v244, v99, v10
    v_dot2c_f32_bf16 v245, v99, v99
    s_waitcnt lgkmcnt(10)
    v_dot2c_f32_bf16 v244, v100, v10
    v_dot2c_f32_bf16 v245, v100, v100
    v_dot2c_f32_bf16 v244, v101, v10
    v_dot2c_f32_bf16 v245, v101, v101
    v_dot2c_f32_bf16 v244, v102, v10
    v_dot2c_f32_bf16 v245, v102, v102
    v_dot2c_f32_bf16 v244, v103, v10
    v_dot2c_f32_bf16 v245, v103, v103
    s_waitcnt lgkmcnt(9)
    v_dot2c_f32_bf16 v244, v104, v10
    v_dot2c_f32_bf16 v245, v104, v104
    v_dot2c_f32_bf16 v244, v105, v10
    v_dot2c_f32_bf16 v245, v105, v105
    v_dot2c_f32_bf16 v244, v106, v10
    v_dot2c_f32_bf16 v245, v106, v106
    v_dot2c_f32_bf16 v244, v107, v10
    v_dot2c_f32_bf16 v245, v107, v107
    s_waitcnt lgkmcnt(8)
    v_dot2c_f32_bf16 v244, v108, v10
    v_dot2c_f32_bf16 v245, v108, v108
    v_dot2c_f32_bf16 v244, v109, v10
    v_dot2c_f32_bf16 v245, v109, v109
    v_dot2c_f32_bf16 v244, v110, v10
    v_dot2c_f32_bf16 v245, v110, v110
    v_dot2c_f32_bf16 v244, v111, v10
    v_dot2c_f32_bf16 v245, v111, v111
    s_waitcnt lgkmcnt(7)
    v_dot2c_f32_bf16 v244, v112, v10
    v_dot2c_f32_bf16 v245, v112, v112
    v_dot2c_f32_bf16 v244, v113, v10
    v_dot2c_f32_bf16 v245, v113, v113
    v_dot2c_f32_bf16 v244, v114, v10
    v_dot2c_f32_bf16 v245, v114, v114
    v_dot2c_f32_bf16 v244, v115, v10
    v_dot2c_f32_bf16 v245, v115, v115
    s_waitcnt lgkmcnt(6)
    v_dot2c_f32_bf16 v244, v116, v10
    v_dot2c_f32_bf16 v245, v116, v116
    v_dot2c_f32_bf16 v244, v117, v10
    v_dot2c_f32_bf16 v245, v117, v117
    v_dot2c_f32_bf16 v244, v118, v10
    v_dot2c_f32_bf16 v245, v118, v118
    v_dot2c_f32_bf16 v244, v119, v10
    v_dot2c_f32_bf16 v245, v119, v119
    s_waitcnt lgkmcnt(5)
    v_dot2c_f32_bf16 v244, v120, v10
    v_dot2c_f32_bf16 v245, v120, v120
    v_dot2c_f32_bf16 v244, v121, v10
    v_dot2c_f32_bf16 v245, v121, v121
    v_dot2c_f32_bf16 v244, v122, v10
    v_dot2c_f32_bf16 v245, v122, v122
    v_dot2c_f32_bf16 v244, v123, v10
    v_dot2c_f32_bf16 v245, v123, v123
    s_waitcnt lgkmcnt(4)
    v_dot2c_f32_bf16 v244, v124, v10
    v_dot2c_f32_bf16 v245, v124, v124
    v_dot2c_f32_bf16 v244, v125, v10
    v_dot2c_f32_bf16 v245, v125, v125
    v_dot2c_f32_bf16 v244, v126, v10
    v_dot2c_f32_bf16 v245, v126, v126
    v_dot2c_f32_bf16 v244, v127, v10
    v_dot2c_f32_bf16 v245, v127, v127
    s_waitcnt lgkmcnt(3)
    v_dot2c_f32_bf16 v244, v128, v10
    v_dot2c_f32_bf16 v245, v128, v128
    v_dot2c_f32_bf16 v244, v129, v10
    v_dot2c_f32_bf16 v245, v129, v129
    v_dot2c_f32_bf16 v244, v130, v10
    v_dot2c_f32_bf16 v245, v130, v130
    v_dot2c_f32_bf16 v244, v131, v10
    v_dot2c_f32_bf16 v245, v131, v131
    s_waitcnt lgkmcnt(2)
    v_dot2c_f32_bf16 v244, v132, v10
    v_dot2c_f32_bf16 v245, v132, v132
    v_dot2c_f32_bf16 v244, v133, v10
    v_dot2c_f32_bf16 v245, v133, v133
    v_dot2c_f32_bf16 v244, v134, v10
    v_dot2c_f32_bf16 v245, v134, v134
    v_dot2c_f32_bf16 v244, v135, v10
    v_dot2c_f32_bf16 v245, v135, v135
    s_waitcnt lgkmcnt(1)
    v_dot2c_f32_bf16 v244, v136, v10
    v_dot2c_f32_bf16 v245, v136, v136
    v_dot2c_f32_bf16 v244, v137, v10
    v_dot2c_f32_bf16 v245, v137, v137
    v_dot2c_f32_bf16 v244, v138, v10
    v_dot2c_f32_bf16 v245, v138, v138
    v_dot2c_f32_bf16 v244, v139, v10
    v_dot2c_f32_bf16 v245, v139, v139
    s_waitcnt lgkmcnt(0)
    v_dot2c_f32_bf16 v244, v140, v10
    v_dot2c_f32_bf16 v245, v140, v140
    v_dot2c_f32_bf16 v244, v141, v10
    v_dot2c_f32_bf16 v245, v141, v141
    v_dot2c_f32_bf16 v244, v142, v10
    v_dot2c_f32_bf16 v245, v142, v142
    v_dot2c_f32_bf16 v244, v143, v10
    v_dot2c_f32_bf16 v245, v143, v143
    buffer_load_dword v0, v253, s[92:95], s49 offen
    buffer_load_ushort v248, v13, s[40:43], s70 offen offset:0
    buffer_load_ushort v249, v13, s[40:43], s70 offen offset:64
    buffer_load_ushort v250, v13, s[40:43], s71 offen offset:0
    buffer_load_ushort v251, v13, s[40:43], s71 offen offset:64
    v_mov_b32 v11, 0
    global_load_dword v253, v11, s[22:23] sc1
    s_waitcnt lgkmcnt(0)
    s_barrier
    s_setprio 3
    ds_read_b64_tr_b16 v[144:145], v208 offset:0
    ds_read_b64_tr_b16 v[146:147], v208 offset:256
    ds_read_b64_tr_b16 v[148:149], v208 offset:512
    ds_read_b64_tr_b16 v[150:151], v208 offset:768
    ds_read_b64_tr_b16 v[152:153], v208 offset:1024
    ds_read_b64_tr_b16 v[154:155], v208 offset:1280
    ds_read_b64_tr_b16 v[156:157], v208 offset:1536
    ds_read_b64_tr_b16 v[158:159], v208 offset:1792
    ds_read_b64_tr_b16 v[160:161], v208 offset:16384
    ds_read_b64_tr_b16 v[162:163], v208 offset:16640
    ds_read_b64_tr_b16 v[164:165], v208 offset:16896
    ds_read_b64_tr_b16 v[166:167], v208 offset:17152
    ds_read_b64_tr_b16 v[168:169], v208 offset:17408
    ds_read_b64_tr_b16 v[170:171], v208 offset:17664
    s_waitcnt lgkmcnt(12)
    v_mfma_f32_32x32x16_bf16 v[176:191], v[144:147], v[16:19], 0
    v_mfma_f32_16x16x32_bf16 v[220:223], v[216:219], v[144:147], 0
    ds_read_b64_tr_b16 v[172:173], v208 offset:17920
    ds_read_b64_tr_b16 v[174:175], v208 offset:18176
    s_waitcnt lgkmcnt(12)
    v_mfma_f32_32x32x16_bf16 v[192:207], v[148:151], v[16:19], 0
    v_mfma_f32_16x16x32_bf16 v[224:227], v[216:219], v[148:151], 0
    ds_read_b64_tr_b16 v[144:145], v209 offset:0
    ds_read_b64_tr_b16 v[146:147], v209 offset:256
    s_waitcnt lgkmcnt(12)
    v_mfma_f32_32x32x16_bf16 v[176:191], v[152:155], v[20:23], v[176:191]
    v_mfma_f32_16x16x32_bf16 v[220:223], v[216:219], v[152:155], v[220:223]
    ds_read_b64_tr_b16 v[148:149], v209 offset:512
    ds_read_b64_tr_b16 v[150:151], v209 offset:768
    s_waitcnt lgkmcnt(12)
    v_mfma_f32_32x32x16_bf16 v[192:207], v[156:159], v[20:23], v[192:207]
    v_mfma_f32_16x16x32_bf16 v[224:227], v[216:219], v[156:159], v[224:227]
    ds_read_b64_tr_b16 v[152:153], v209 offset:1024
    ds_read_b64_tr_b16 v[154:155], v209 offset:1280
    s_waitcnt lgkmcnt(12)
    v_mfma_f32_32x32x16_bf16 v[176:191], v[160:163], v[24:27], v[176:191]
    v_mfma_f32_16x16x32_bf16 v[220:223], v[216:219], v[160:163], v[220:223]
    ds_read_b64_tr_b16 v[156:157], v209 offset:1536
    ds_read_b64_tr_b16 v[158:159], v209 offset:1792
    s_waitcnt lgkmcnt(12)
    v_mfma_f32_32x32x16_bf16 v[192:207], v[164:167], v[24:27], v[192:207]
    v_mfma_f32_16x16x32_bf16 v[224:227], v[216:219], v[164:167], v[224:227]
    ds_read_b64_tr_b16 v[160:161], v209 offset:16384
    ds_read_b64_tr_b16 v[162:163], v209 offset:16640
    s_waitcnt lgkmcnt(12)
    v_mfma_f32_32x32x16_bf16 v[176:191], v[168:171], v[28:31], v[176:191]
    v_mfma_f32_16x16x32_bf16 v[220:223], v[216:219], v[168:171], v[220:223]
    ds_read_b64_tr_b16 v[164:165], v209 offset:16896
    ds_read_b64_tr_b16 v[166:167], v209 offset:17152
    s_waitcnt lgkmcnt(12)
    v_mfma_f32_32x32x16_bf16 v[192:207], v[172:175], v[28:31], v[192:207]
    v_mfma_f32_16x16x32_bf16 v[224:227], v[216:219], v[172:175], v[224:227]
    ds_read_b64_tr_b16 v[168:169], v209 offset:17408
    ds_read_b64_tr_b16 v[170:171], v209 offset:17664
    s_waitcnt lgkmcnt(12)
    v_mfma_f32_32x32x16_bf16 v[176:191], v[144:147], v[32:35], v[176:191]
    ds_read_b64_tr_b16 v[172:173], v209 offset:17920
    ds_read_b64_tr_b16 v[174:175], v209 offset:18176
    s_waitcnt lgkmcnt(12)
    v_mfma_f32_32x32x16_bf16 v[192:207], v[148:151], v[32:35], v[192:207]
    ds_read_b64_tr_b16 v[144:145], v210 offset:0
    ds_read_b64_tr_b16 v[146:147], v210 offset:256
    s_waitcnt lgkmcnt(12)
    v_mfma_f32_32x32x16_bf16 v[176:191], v[152:155], v[36:39], v[176:191]
    ds_read_b64_tr_b16 v[148:149], v210 offset:512
    ds_read_b64_tr_b16 v[150:151], v210 offset:768
    s_waitcnt lgkmcnt(12)
    v_mfma_f32_32x32x16_bf16 v[192:207], v[156:159], v[36:39], v[192:207]
    s_lshl_b32 s61, s26, 9
    s_add_u32 s61, s61, 69632
    v_lshl_add_u32 v11, v1, 2, s61
    ds_write_b32 v11, v244
    ds_write_b32 v11, v245 offset:256
    ds_read_b64_tr_b16 v[152:153], v210 offset:1024
    ds_read_b64_tr_b16 v[154:155], v210 offset:1280
    s_waitcnt lgkmcnt(14)
    v_mfma_f32_32x32x16_bf16 v[176:191], v[160:163], v[40:43], v[176:191]
    ds_read_b64_tr_b16 v[156:157], v210 offset:1536
    ds_read_b64_tr_b16 v[158:159], v210 offset:1792
    s_waitcnt lgkmcnt(14)
    v_mfma_f32_32x32x16_bf16 v[192:207], v[164:167], v[40:43], v[192:207]
    ds_read_b64_tr_b16 v[160:161], v210 offset:16384
    ds_read_b64_tr_b16 v[162:163], v210 offset:16640
    s_waitcnt lgkmcnt(14)
    v_mfma_f32_32x32x16_bf16 v[176:191], v[168:171], v[44:47], v[176:191]
    ds_read_b64_tr_b16 v[164:165], v210 offset:16896
    ds_read_b64_tr_b16 v[166:167], v210 offset:17152
    s_waitcnt lgkmcnt(14)
    v_mfma_f32_32x32x16_bf16 v[192:207], v[172:175], v[44:47], v[192:207]
    ds_read_b64_tr_b16 v[168:169], v210 offset:17408
    ds_read_b64_tr_b16 v[170:171], v210 offset:17664
    s_waitcnt lgkmcnt(14)
    v_mfma_f32_32x32x16_bf16 v[176:191], v[144:147], v[48:51], v[176:191]
    ds_read_b64_tr_b16 v[172:173], v210 offset:17920
    ds_read_b64_tr_b16 v[174:175], v210 offset:18176
    s_waitcnt lgkmcnt(14)
    v_mfma_f32_32x32x16_bf16 v[192:207], v[148:151], v[48:51], v[192:207]
    ds_read_b64_tr_b16 v[144:145], v211 offset:0
    ds_read_b64_tr_b16 v[146:147], v211 offset:256
    s_waitcnt lgkmcnt(12)
    v_mfma_f32_32x32x16_bf16 v[176:191], v[152:155], v[52:55], v[176:191]
    ds_read_b64_tr_b16 v[148:149], v211 offset:512
    ds_read_b64_tr_b16 v[150:151], v211 offset:768
    s_waitcnt lgkmcnt(12)
    v_mfma_f32_32x32x16_bf16 v[192:207], v[156:159], v[52:55], v[192:207]
    ds_read_b64_tr_b16 v[152:153], v211 offset:1024
    ds_read_b64_tr_b16 v[154:155], v211 offset:1280
    s_waitcnt lgkmcnt(12)
    v_mfma_f32_32x32x16_bf16 v[176:191], v[160:163], v[56:59], v[176:191]
    ds_read_b64_tr_b16 v[156:157], v211 offset:1536
    ds_read_b64_tr_b16 v[158:159], v211 offset:1792
    s_waitcnt lgkmcnt(12)
    v_mfma_f32_32x32x16_bf16 v[192:207], v[164:167], v[56:59], v[192:207]
    ds_read_b64_tr_b16 v[160:161], v211 offset:16384
    ds_read_b64_tr_b16 v[162:163], v211 offset:16640
    s_waitcnt lgkmcnt(12)
    v_mfma_f32_32x32x16_bf16 v[176:191], v[168:171], v[60:63], v[176:191]
    ds_read_b64_tr_b16 v[164:165], v211 offset:16896
    ds_read_b64_tr_b16 v[166:167], v211 offset:17152
    s_waitcnt lgkmcnt(12)
    v_mfma_f32_32x32x16_bf16 v[192:207], v[172:175], v[60:63], v[192:207]
    ds_read_b64_tr_b16 v[168:169], v211 offset:17408
    ds_read_b64_tr_b16 v[170:171], v211 offset:17664
    s_waitcnt lgkmcnt(12)
    v_mfma_f32_32x32x16_bf16 v[176:191], v[144:147], v[64:67], v[176:191]
    ds_read_b64_tr_b16 v[172:173], v211 offset:17920
    ds_read_b64_tr_b16 v[174:175], v211 offset:18176
    s_waitcnt lgkmcnt(12)
    v_mfma_f32_32x32x16_bf16 v[192:207], v[148:151], v[64:67], v[192:207]
    s_waitcnt lgkmcnt(10)
    v_mfma_f32_32x32x16_bf16 v[176:191], v[152:155], v[68:71], v[176:191]
    s_waitcnt lgkmcnt(8)
    v_mfma_f32_32x32x16_bf16 v[192:207], v[156:159], v[68:71], v[192:207]
    s_waitcnt lgkmcnt(0)
    s_barrier
    ds_read_b64_tr_b16 v[144:145], v208 offset:32768
    ds_read_b64_tr_b16 v[146:147], v208 offset:33024
    ds_read_b64_tr_b16 v[148:149], v208 offset:33280
    ds_read_b64_tr_b16 v[150:151], v208 offset:33536
    ds_read_b64_tr_b16 v[152:153], v208 offset:33792
    ds_read_b64_tr_b16 v[154:155], v208 offset:34048
    v_mfma_f32_32x32x16_bf16 v[176:191], v[160:163], v[72:75], v[176:191]
    ds_read_b64_tr_b16 v[156:157], v208 offset:34304
    ds_read_b64_tr_b16 v[158:159], v208 offset:34560
    v_mfma_f32_32x32x16_bf16 v[192:207], v[164:167], v[72:75], v[192:207]
    ds_read_b64_tr_b16 v[160:161], v208 offset:49152
    ds_read_b64_tr_b16 v[162:163], v208 offset:49408
    v_mfma_f32_32x32x16_bf16 v[176:191], v[168:171], v[76:79], v[176:191]
    ds_read_b64_tr_b16 v[164:165], v208 offset:49664
    ds_read_b64_tr_b16 v[166:167], v208 offset:49920
    v_mfma_f32_32x32x16_bf16 v[192:207], v[172:175], v[76:79], v[192:207]
    ds_read_b64_tr_b16 v[168:169], v208 offset:50176
    ds_read_b64_tr_b16 v[170:171], v208 offset:50432
    s_waitcnt lgkmcnt(12)
    v_mfma_f32_32x32x16_bf16 v[176:191], v[144:147], v[80:83], v[176:191]
    v_mfma_f32_16x16x32_bf16 v[220:223], v[216:219], v[144:147], v[220:223]
    ds_read_b64_tr_b16 v[172:173], v208 offset:50688
    ds_read_b64_tr_b16 v[174:175], v208 offset:50944
    s_waitcnt lgkmcnt(12)
    v_mfma_f32_32x32x16_bf16 v[192:207], v[148:151], v[80:83], v[192:207]
    v_mfma_f32_16x16x32_bf16 v[224:227], v[216:219], v[148:151], v[224:227]
    ds_read_b64_tr_b16 v[144:145], v209 offset:32768
    ds_read_b64_tr_b16 v[146:147], v209 offset:33024
    s_waitcnt lgkmcnt(12)
    v_mfma_f32_32x32x16_bf16 v[176:191], v[152:155], v[84:87], v[176:191]
    v_mfma_f32_16x16x32_bf16 v[220:223], v[216:219], v[152:155], v[220:223]
    ds_read_b64_tr_b16 v[148:149], v209 offset:33280
    ds_read_b64_tr_b16 v[150:151], v209 offset:33536
    s_waitcnt lgkmcnt(12)
    v_mfma_f32_32x32x16_bf16 v[192:207], v[156:159], v[84:87], v[192:207]
    v_mfma_f32_16x16x32_bf16 v[224:227], v[216:219], v[156:159], v[224:227]
    ds_read_b64_tr_b16 v[152:153], v209 offset:33792
    ds_read_b64_tr_b16 v[154:155], v209 offset:34048
    s_waitcnt lgkmcnt(12)
    v_mfma_f32_32x32x16_bf16 v[176:191], v[160:163], v[88:91], v[176:191]
    v_mfma_f32_16x16x32_bf16 v[220:223], v[216:219], v[160:163], v[220:223]
    ds_read_b64_tr_b16 v[156:157], v209 offset:34304
    ds_read_b64_tr_b16 v[158:159], v209 offset:34560
    s_waitcnt lgkmcnt(12)
    v_mfma_f32_32x32x16_bf16 v[192:207], v[164:167], v[88:91], v[192:207]
    v_mfma_f32_16x16x32_bf16 v[224:227], v[216:219], v[164:167], v[224:227]
    ds_read_b64_tr_b16 v[160:161], v209 offset:49152
    ds_read_b64_tr_b16 v[162:163], v209 offset:49408
    s_waitcnt lgkmcnt(12)
    v_mfma_f32_32x32x16_bf16 v[176:191], v[168:171], v[92:95], v[176:191]
    v_mfma_f32_16x16x32_bf16 v[220:223], v[216:219], v[168:171], v[220:223]
    ds_read_b64_tr_b16 v[164:165], v209 offset:49664
    ds_read_b64_tr_b16 v[166:167], v209 offset:49920
    s_waitcnt lgkmcnt(12)
    v_mfma_f32_32x32x16_bf16 v[192:207], v[172:175], v[92:95], v[192:207]
    v_mfma_f32_16x16x32_bf16 v[224:227], v[216:219], v[172:175], v[224:227]
    ds_read_b64_tr_b16 v[168:169], v209 offset:50176
    ds_read_b64_tr_b16 v[170:171], v209 offset:50432
    s_waitcnt lgkmcnt(12)
    v_mfma_f32_32x32x16_bf16 v[176:191], v[144:147], v[96:99], v[176:191]
    ds_read_b64_tr_b16 v[172:173], v209 offset:50688
    ds_read_b64_tr_b16 v[174:175], v209 offset:50944
    s_waitcnt lgkmcnt(12)
    v_mfma_f32_32x32x16_bf16 v[192:207], v[148:151], v[96:99], v[192:207]
    ds_read_b64_tr_b16 v[144:145], v210 offset:32768
    ds_read_b64_tr_b16 v[146:147], v210 offset:33024
    s_waitcnt lgkmcnt(12)
    v_mfma_f32_32x32x16_bf16 v[176:191], v[152:155], v[100:103], v[176:191]
    ds_read_b64_tr_b16 v[148:149], v210 offset:33280
    ds_read_b64_tr_b16 v[150:151], v210 offset:33536
    s_waitcnt lgkmcnt(12)
    v_mfma_f32_32x32x16_bf16 v[192:207], v[156:159], v[100:103], v[192:207]
    ds_read_b64_tr_b16 v[152:153], v210 offset:33792
    ds_read_b64_tr_b16 v[154:155], v210 offset:34048
    s_waitcnt lgkmcnt(12)
    v_mfma_f32_32x32x16_bf16 v[176:191], v[160:163], v[104:107], v[176:191]
    ds_read_b64_tr_b16 v[156:157], v210 offset:34304
    ds_read_b64_tr_b16 v[158:159], v210 offset:34560
    s_waitcnt lgkmcnt(12)
    v_mfma_f32_32x32x16_bf16 v[192:207], v[164:167], v[104:107], v[192:207]
    ds_read_b64_tr_b16 v[160:161], v210 offset:49152
    ds_read_b64_tr_b16 v[162:163], v210 offset:49408
    s_waitcnt lgkmcnt(12)
    v_mfma_f32_32x32x16_bf16 v[176:191], v[168:171], v[108:111], v[176:191]
    ds_read_b64_tr_b16 v[164:165], v210 offset:49664
    ds_read_b64_tr_b16 v[166:167], v210 offset:49920
    s_waitcnt lgkmcnt(12)
    v_mfma_f32_32x32x16_bf16 v[192:207], v[172:175], v[108:111], v[192:207]
    ds_read_b64_tr_b16 v[168:169], v210 offset:50176
    ds_read_b64_tr_b16 v[170:171], v210 offset:50432
    s_waitcnt lgkmcnt(12)
    v_mfma_f32_32x32x16_bf16 v[176:191], v[144:147], v[112:115], v[176:191]
    ds_read_b64_tr_b16 v[172:173], v210 offset:50688
    ds_read_b64_tr_b16 v[174:175], v210 offset:50944
    s_waitcnt lgkmcnt(12)
    v_mfma_f32_32x32x16_bf16 v[192:207], v[148:151], v[112:115], v[192:207]
    v_cndmask_b32 v11, v220, v221, s[52:53]
    ds_write_b32 v5, v11 offset:0
    ds_read_b64_tr_b16 v[144:145], v211 offset:32768
    ds_read_b64_tr_b16 v[146:147], v211 offset:33024
    s_waitcnt lgkmcnt(13)
    v_mfma_f32_32x32x16_bf16 v[176:191], v[152:155], v[116:119], v[176:191]
    ds_read_b64_tr_b16 v[148:149], v211 offset:33280
    ds_read_b64_tr_b16 v[150:151], v211 offset:33536
    s_waitcnt lgkmcnt(13)
    v_mfma_f32_32x32x16_bf16 v[192:207], v[156:159], v[116:119], v[192:207]
    v_cndmask_b32 v12, v224, v225, s[52:53]
    ds_write_b32 v5, v12 offset:512
    ds_read_b64_tr_b16 v[152:153], v211 offset:33792
    ds_read_b64_tr_b16 v[154:155], v211 offset:34048
    s_waitcnt lgkmcnt(14)
    v_mfma_f32_32x32x16_bf16 v[176:191], v[160:163], v[120:123], v[176:191]
    ds_read_b64_tr_b16 v[156:157], v211 offset:34304
    ds_read_b64_tr_b16 v[158:159], v211 offset:34560
    s_waitcnt lgkmcnt(14)
    v_mfma_f32_32x32x16_bf16 v[192:207], v[164:167], v[120:123], v[192:207]
    ds_read_b64_tr_b16 v[160:161], v211 offset:49152
    ds_read_b64_tr_b16 v[162:163], v211 offset:49408
    s_waitcnt lgkmcnt(14)
    v_mfma_f32_32x32x16_bf16 v[176:191], v[168:171], v[124:127], v[176:191]
    ds_read_b64_tr_b16 v[164:165], v211 offset:49664
    ds_read_b64_tr_b16 v[166:167], v211 offset:49920
    s_waitcnt lgkmcnt(14)
    v_mfma_f32_32x32x16_bf16 v[192:207], v[172:175], v[124:127], v[192:207]
    ds_read_b64_tr_b16 v[168:169], v211 offset:50176
    ds_read_b64_tr_b16 v[170:171], v211 offset:50432
    s_waitcnt lgkmcnt(13)
    v_mfma_f32_32x32x16_bf16 v[176:191], v[144:147], v[128:131], v[176:191]
    ds_read_b64_tr_b16 v[172:173], v211 offset:50688
    ds_read_b64_tr_b16 v[174:175], v211 offset:50944
    s_waitcnt lgkmcnt(13)
    v_mfma_f32_32x32x16_bf16 v[192:207], v[148:151], v[128:131], v[192:207]
    s_waitcnt lgkmcnt(10)
    v_mfma_f32_32x32x16_bf16 v[176:191], v[152:155], v[132:135], v[176:191]
    s_waitcnt lgkmcnt(8)
    v_mfma_f32_32x32x16_bf16 v[192:207], v[156:159], v[132:135], v[192:207]
    s_waitcnt lgkmcnt(0)
    s_barrier
    v_mfma_f32_32x32x16_bf16 v[176:191], v[160:163], v[136:139], v[176:191]
    v_mfma_f32_32x32x16_bf16 v[192:207], v[164:167], v[136:139], v[192:207]
    v_mfma_f32_32x32x16_bf16 v[176:191], v[168:171], v[140:143], v[176:191]
    v_mfma_f32_32x32x16_bf16 v[192:207], v[172:175], v[140:143], v[192:207]
    s_setprio 0
    s_waitcnt vmcnt(0)
    v_readfirstlane_b32 s100, v253
    s_nop 0
    s_cmp_lg_u32 s100, 0
    s_cbranch_scc1 L_k1_tty1d
    s_mov_b32 s62, 0x40000
    v_mov_b32 v11, 0
L_k1_tty1:
    global_load_dword v253, v11, s[22:23] sc1
    s_waitcnt vmcnt(0)
    v_readfirstlane_b32 s100, v253
    s_sub_u32 s62, s62, 1
    s_cbranch_scc1 L_k1_tty1d
    s_cmp_eq_u32 s100, 0
    s_cbranch_scc1 L_k1_tty1
L_k1_tty1d:
    ds_read_b128 v[160:163], v6 offset:0
    ds_read_b128 v[164:167], v6 offset:512
    v_mov_b32 v228, 0
    v_mov_b32 v232, 0
    v_mov_b32 v236, 0
    v_mov_b32 v229, 0
    v_mov_b32 v233, 0
    v_mov_b32 v237, 0
    v_mov_b32 v230, 0
    v_mov_b32 v234, 0
    v_mov_b32 v238, 0
    v_mov_b32 v231, 0
    v_mov_b32 v235, 0
    v_mov_b32 v239, 0
    s_xor_b32 s61, s26, 4
    s_lshl_b32 s61, s61, 9
    s_add_u32 s61, s61, 69632
    v_lshl_add_u32 v153, v1, 2, s61
    ds_read_b32 v154, v153
    ds_read_b32 v155, v153 offset:256
    s_waitcnt lgkmcnt(0)
    v_add_f32 v244, v244, v154
    v_add_f32 v245, v245, v155
    v_mov_b32 v154, v244
    v_mov_b32 v155, v245
    s_nop 0
    v_permlane32_swap_b32 v244, v154
    v_permlane32_swap_b32 v245, v155
    v_add_f32 v244, v244, v154
    v_add_f32 v245, v245, v155
    v_mul_f32 v244, 0x3b000000, v244
    v_mul_f32 v245, 0x3b000000, v245
    v_fma_f32 v245, -v244, v244, v245
    v_max_f32 v245, 0, v245
    v_cvt_pk_bf16_f32 v154, v245, -v244
    v_lshlrev_b32 v155, 16, v154
    v_add_f32 v155, 0x3727c5ac, v155
    v_cvt_pk_bf16_f32 v155, v155, v155
    v_lshlrev_b32 v155, 16, v155
    v_sqrt_f32 v155, v155
    s_nop 0
    v_cvt_pk_bf16_f32 v155, v155, v155
    v_and_b32 v241, 0xffff0000, v155
    v_rcp_f32 v240, v241
    v_lshrrev_b32 v155, 16, v154
    v_cmp_gt_u32 vcc, 32, v1
    v_lshl_or_b32 v156, v155, 16, v155
    v_or_b32 v157, v241, v155
    v_cndmask_b32 v228, 0, v156, vcc
    v_cndmask_b32 v229, 0, v157, vcc
    v_mul_f32 v242, 0xc0135761, v240
    v_mul_f32 v243, v240, v240
    v_mul_f32 v243, v243, v240
    v_mul_f32 v243, 0xbdd2d3e8, v243
    v_add_f32 v160, v160, v161
    v_add_f32 v162, v162, v163
    v_add_f32 v144, v160, v162
    v_and_b32 v145, 0xffff0000, v144
    v_sub_f32 v146, v144, v145
    v_and_b32 v147, 0xffff0000, v146
    v_sub_f32 v146, v146, v147
    v_lshrrev_b32 v145, 16, v145
    v_or_b32 v232, v145, v147
    v_lshrrev_b32 v233, 16, v146
    v_add_f32 v164, v164, v165
    v_add_f32 v166, v166, v167
    v_add_f32 v144, v164, v166
    v_and_b32 v145, 0xffff0000, v144
    v_sub_f32 v146, v144, v145
    v_and_b32 v147, 0xffff0000, v146
    v_sub_f32 v146, v146, v147
    v_lshrrev_b32 v145, 16, v145
    v_or_b32 v236, v145, v147
    v_lshrrev_b32 v237, 16, v146
    v_mfma_f32_32x32x16_bf16 v[176:191], v[232:235], v[228:231], v[176:191]
    s_nop 0
    v_mfma_f32_32x32x16_bf16 v[192:207], v[236:239], v[228:231], v[192:207]
    s_nop 9
    v_mul_f32 v176, v176, v240
    v_mul_f32 v177, v177, v240
    v_mul_f32 v178, v178, v240
    v_mul_f32 v179, v179, v240
    v_mul_f32 v180, v180, v240
    v_mul_f32 v181, v181, v240
    v_mul_f32 v182, v182, v240
    v_mul_f32 v183, v183, v240
    v_cvt_pk_bf16_f32 v160, v176, v177
    v_cvt_pk_bf16_f32 v161, v178, v179
    v_cvt_pk_bf16_f32 v162, v180, v181
    v_cvt_pk_bf16_f32 v163, v182, v183
    s_add_u32 s61, s68, 2097152
    buffer_store_dwordx4 v[160:163], v7, s[36:39], s61 offen sc1
    v_mul_f32 v184, v184, v240
    v_mul_f32 v185, v185, v240
    v_mul_f32 v186, v186, v240
    v_mul_f32 v187, v187, v240
    v_mul_f32 v188, v188, v240
    v_mul_f32 v189, v189, v240
    v_mul_f32 v190, v190, v240
    v_mul_f32 v191, v191, v240
    v_cvt_pk_bf16_f32 v164, v184, v185
    v_cvt_pk_bf16_f32 v165, v186, v187
    v_cvt_pk_bf16_f32 v166, v188, v189
    v_cvt_pk_bf16_f32 v167, v190, v191
    s_add_u32 s61, s68, 2162688
    buffer_store_dwordx4 v[164:167], v7, s[36:39], s61 offen sc1
    v_mul_f32 v192, v192, v240
    v_mul_f32 v193, v193, v240
    v_mul_f32 v194, v194, v240
    v_mul_f32 v195, v195, v240
    v_mul_f32 v196, v196, v240
    v_mul_f32 v197, v197, v240
    v_mul_f32 v198, v198, v240
    v_mul_f32 v199, v199, v240
    v_cvt_pk_bf16_f32 v168, v192, v193
    v_cvt_pk_bf16_f32 v169, v194, v195
    v_cvt_pk_bf16_f32 v170, v196, v197
    v_cvt_pk_bf16_f32 v171, v198, v199
    s_add_u32 s61, s68, 2228224
    buffer_store_dwordx4 v[168:171], v7, s[36:39], s61 offen sc1
    v_mul_f32 v200, v200, v240
    v_mul_f32 v201, v201, v240
    v_mul_f32 v202, v202, v240
    v_mul_f32 v203, v203, v240
    v_mul_f32 v204, v204, v240
    v_mul_f32 v205, v205, v240
    v_mul_f32 v206, v206, v240
    v_mul_f32 v207, v207, v240
    v_cvt_pk_bf16_f32 v172, v200, v201
    v_cvt_pk_bf16_f32 v173, v202, v203
    v_cvt_pk_bf16_f32 v174, v204, v205
    v_cvt_pk_bf16_f32 v175, v206, v207
    s_add_u32 s61, s68, 2293760
    buffer_store_dwordx4 v[172:175], v7, s[36:39], s61 offen sc1
    s_waitcnt lgkmcnt(0)
    s_barrier
    s_waitcnt vmcnt(0)
    s_add_u32 s61, s48, 20185088
    v_lshlrev_b32 v11, 2, v1
    v_mov_b32 v12, s100
    s_mov_b32 exec_hi, 0
    buffer_store_dword v12, v11, s[36:39], s61 offen sc1
    s_mov_b64 exec, -1
    s_add_u32 m0, s65, 0
    s_mov_b32 s60, s58
    buffer_load_dwordx4 v3, s[32:35], s60 offen lds
    s_add_u32 m0, s65, 1024
    s_addk_i32 s60, 28672
    buffer_load_dwordx4 v3, s[32:35], s60 offen lds
    s_add_u32 m0, s65, 2048
    s_addk_i32 s60, 28672
    buffer_load_dwordx4 v3, s[32:35], s60 offen lds
    s_add_u32 m0, s65, 3072
    s_addk_i32 s60, 28672
    buffer_load_dwordx4 v3, s[32:35], s60 offen lds
    s_add_u32 m0, s65, 4096
    s_addk_i32 s60, 28672
    buffer_load_dwordx4 v3, s[32:35], s60 offen lds
    s_add_u32 m0, s65, 5120
    s_addk_i32 s60, 28672
    buffer_load_dwordx4 v3, s[32:35], s60 offen lds
    s_add_u32 m0, s65, 6144
    s_addk_i32 s60, 28672
    buffer_load_dwordx4 v3, s[32:35], s60 offen lds
    s_add_u32 m0, s65, 7168
    s_addk_i32 s60, 28672
    buffer_load_dwordx4 v3, s[32:35], s60 offen lds
    s_add_u32 m0, s65, 32768
    s_add_u32 s60, s58, 917504
    buffer_load_dwordx4 v3, s[32:35], s60 offen lds
    s_add_u32 m0, s65, 33792
    s_addk_i32 s60, 28672
    buffer_load_dwordx4 v3, s[32:35], s60 offen lds
    s_add_u32 m0, s65, 34816
    s_addk_i32 s60, 28672
    buffer_load_dwordx4 v3, s[32:35], s60 offen lds
    s_add_u32 m0, s65, 35840
    s_addk_i32 s60, 28672
    buffer_load_dwordx4 v3, s[32:35], s60 offen lds
    s_add_u32 m0, s65, 36864
    s_addk_i32 s60, 28672
    buffer_load_dwordx4 v3, s[32:35], s60 offen lds
    s_add_u32 m0, s65, 37888
    s_addk_i32 s60, 28672
    buffer_load_dwordx4 v3, s[32:35], s60 offen lds
    s_add_u32 m0, s65, 38912
    s_addk_i32 s60, 28672
    buffer_load_dwordx4 v3, s[32:35], s60 offen lds
    s_add_u32 m0, s65, 39936
    s_addk_i32 s60, 28672
    buffer_load_dwordx4 v3, s[32:35], s60 offen lds
    s_waitcnt vmcnt(8)
    s_waitcnt lgkmcnt(0)
    s_barrier
    s_setprio 3
    ds_read_b64_tr_b16 v[144:145], v208 offset:0
    ds_read_b64_tr_b16 v[146:147], v208 offset:256
    ds_read_b64_tr_b16 v[148:149], v208 offset:512
    ds_read_b64_tr_b16 v[150:151], v208 offset:768
    ds_read_b64_tr_b16 v[152:153], v208 offset:1024
    ds_read_b64_tr_b16 v[154:155], v208 offset:1280
    ds_read_b64_tr_b16 v[156:157], v208 offset:1536
    ds_read_b64_tr_b16 v[158:159], v208 offset:1792
    ds_read_b64_tr_b16 v[160:161], v208 offset:16384
    ds_read_b64_tr_b16 v[162:163], v208 offset:16640
    ds_read_b64_tr_b16 v[164:165], v208 offset:16896
    ds_read_b64_tr_b16 v[166:167], v208 offset:17152
    ds_read_b64_tr_b16 v[168:169], v208 offset:17408
    ds_read_b64_tr_b16 v[170:171], v208 offset:17664
    s_waitcnt lgkmcnt(12)
    v_mfma_f32_32x32x16_bf16 v[176:191], v[144:147], v[16:19], 0
    v_mfma_f32_16x16x32_bf16 v[220:223], v[216:219], v[144:147], 0
    ds_read_b64_tr_b16 v[172:173], v208 offset:17920
    ds_read_b64_tr_b16 v[174:175], v208 offset:18176
    s_waitcnt lgkmcnt(12)
    v_mfma_f32_32x32x16_bf16 v[192:207], v[148:151], v[16:19], 0
    v_mfma_f32_16x16x32_bf16 v[224:227], v[216:219], v[148:151], 0
    ds_read_b64_tr_b16 v[144:145], v209 offset:0
    ds_read_b64_tr_b16 v[146:147], v209 offset:256
    s_waitcnt lgkmcnt(12)
    v_mfma_f32_32x32x16_bf16 v[176:191], v[152:155], v[20:23], v[176:191]
    v_mfma_f32_16x16x32_bf16 v[220:223], v[216:219], v[152:155], v[220:223]
    ds_read_b64_tr_b16 v[148:149], v209 offset:512
    ds_read_b64_tr_b16 v[150:151], v209 offset:768
    s_waitcnt lgkmcnt(12)
    v_mfma_f32_32x32x16_bf16 v[192:207], v[156:159], v[20:23], v[192:207]
    v_mfma_f32_16x16x32_bf16 v[224:227], v[216:219], v[156:159], v[224:227]
    ds_read_b64_tr_b16 v[152:153], v209 offset:1024
    ds_read_b64_tr_b16 v[154:155], v209 offset:1280
    s_waitcnt lgkmcnt(12)
    v_mfma_f32_32x32x16_bf16 v[176:191], v[160:163], v[24:27], v[176:191]
    v_mfma_f32_16x16x32_bf16 v[220:223], v[216:219], v[160:163], v[220:223]
    ds_read_b64_tr_b16 v[156:157], v209 offset:1536
    ds_read_b64_tr_b16 v[158:159], v209 offset:1792
    s_waitcnt lgkmcnt(12)
    v_mfma_f32_32x32x16_bf16 v[192:207], v[164:167], v[24:27], v[192:207]
    v_mfma_f32_16x16x32_bf16 v[224:227], v[216:219], v[164:167], v[224:227]
    ds_read_b64_tr_b16 v[160:161], v209 offset:16384
    ds_read_b64_tr_b16 v[162:163], v209 offset:16640
    s_waitcnt lgkmcnt(12)
    v_mfma_f32_32x32x16_bf16 v[176:191], v[168:171], v[28:31], v[176:191]
    v_mfma_f32_16x16x32_bf16 v[220:223], v[216:219], v[168:171], v[220:223]
    ds_read_b64_tr_b16 v[164:165], v209 offset:16896
    ds_read_b64_tr_b16 v[166:167], v209 offset:17152
    s_waitcnt lgkmcnt(12)
    v_mfma_f32_32x32x16_bf16 v[192:207], v[172:175], v[28:31], v[192:207]
    v_mfma_f32_16x16x32_bf16 v[224:227], v[216:219], v[172:175], v[224:227]
    ds_read_b64_tr_b16 v[168:169], v209 offset:17408
    ds_read_b64_tr_b16 v[170:171], v209 offset:17664
    s_waitcnt lgkmcnt(12)
    v_mfma_f32_32x32x16_bf16 v[176:191], v[144:147], v[32:35], v[176:191]
    ds_read_b64_tr_b16 v[172:173], v209 offset:17920
    ds_read_b64_tr_b16 v[174:175], v209 offset:18176
    s_waitcnt lgkmcnt(12)
    v_mfma_f32_32x32x16_bf16 v[192:207], v[148:151], v[32:35], v[192:207]
    ds_read_b64_tr_b16 v[144:145], v210 offset:0
    ds_read_b64_tr_b16 v[146:147], v210 offset:256
    s_waitcnt lgkmcnt(12)
    v_mfma_f32_32x32x16_bf16 v[176:191], v[152:155], v[36:39], v[176:191]
    ds_read_b64_tr_b16 v[148:149], v210 offset:512
    ds_read_b64_tr_b16 v[150:151], v210 offset:768
    s_waitcnt lgkmcnt(12)
    v_mfma_f32_32x32x16_bf16 v[192:207], v[156:159], v[36:39], v[192:207]
    ds_read_b64_tr_b16 v[152:153], v210 offset:1024
    ds_read_b64_tr_b16 v[154:155], v210 offset:1280
    s_waitcnt lgkmcnt(12)
    v_mfma_f32_32x32x16_bf16 v[176:191], v[160:163], v[40:43], v[176:191]
    ds_read_b64_tr_b16 v[156:157], v210 offset:1536
    ds_read_b64_tr_b16 v[158:159], v210 offset:1792
    s_waitcnt lgkmcnt(12)
    v_mfma_f32_32x32x16_bf16 v[192:207], v[164:167], v[40:43], v[192:207]
    ds_read_b64_tr_b16 v[160:161], v210 offset:16384
    ds_read_b64_tr_b16 v[162:163], v210 offset:16640
    s_waitcnt lgkmcnt(12)
    v_mfma_f32_32x32x16_bf16 v[176:191], v[168:171], v[44:47], v[176:191]
    ds_read_b64_tr_b16 v[164:165], v210 offset:16896
    ds_read_b64_tr_b16 v[166:167], v210 offset:17152
    s_waitcnt lgkmcnt(12)
    v_mfma_f32_32x32x16_bf16 v[192:207], v[172:175], v[44:47], v[192:207]
    ds_read_b64_tr_b16 v[168:169], v210 offset:17408
    ds_read_b64_tr_b16 v[170:171], v210 offset:17664
    s_waitcnt lgkmcnt(12)
    v_mfma_f32_32x32x16_bf16 v[176:191], v[144:147], v[48:51], v[176:191]
    ds_read_b64_tr_b16 v[172:173], v210 offset:17920
    ds_read_b64_tr_b16 v[174:175], v210 offset:18176
    s_waitcnt lgkmcnt(12)
    v_mfma_f32_32x32x16_bf16 v[192:207], v[148:151], v[48:51], v[192:207]
    ds_read_b64_tr_b16 v[144:145], v211 offset:0
    ds_read_b64_tr_b16 v[146:147], v211 offset:256
    s_waitcnt lgkmcnt(12)
    v_mfma_f32_32x32x16_bf16 v[176:191], v[152:155], v[52:55], v[176:191]
    ds_read_b64_tr_b16 v[148:149], v211 offset:512
    ds_read_b64_tr_b16 v[150:151], v211 offset:768
    s_waitcnt lgkmcnt(12)
    v_mfma_f32_32x32x16_bf16 v[192:207], v[156:159], v[52:55], v[192:207]
    ds_read_b64_tr_b16 v[152:153], v211 offset:1024
    ds_read_b64_tr_b16 v[154:155], v211 offset:1280
    s_waitcnt lgkmcnt(12)
    v_mfma_f32_32x32x16_bf16 v[176:191], v[160:163], v[56:59], v[176:191]
    ds_read_b64_tr_b16 v[156:157], v211 offset:1536
    ds_read_b64_tr_b16 v[158:159], v211 offset:1792
    s_waitcnt lgkmcnt(12)
    v_mfma_f32_32x32x16_bf16 v[192:207], v[164:167], v[56:59], v[192:207]
    ds_read_b64_tr_b16 v[160:161], v211 offset:16384
    ds_read_b64_tr_b16 v[162:163], v211 offset:16640
    s_waitcnt lgkmcnt(12)
    v_mfma_f32_32x32x16_bf16 v[176:191], v[168:171], v[60:63], v[176:191]
    ds_read_b64_tr_b16 v[164:165], v211 offset:16896
    ds_read_b64_tr_b16 v[166:167], v211 offset:17152
    s_waitcnt lgkmcnt(12)
    v_mfma_f32_32x32x16_bf16 v[192:207], v[172:175], v[60:63], v[192:207]
    ds_read_b64_tr_b16 v[168:169], v211 offset:17408
    ds_read_b64_tr_b16 v[170:171], v211 offset:17664
    s_waitcnt lgkmcnt(12)
    v_mfma_f32_32x32x16_bf16 v[176:191], v[144:147], v[64:67], v[176:191]
    ds_read_b64_tr_b16 v[172:173], v211 offset:17920
    ds_read_b64_tr_b16 v[174:175], v211 offset:18176
    s_waitcnt lgkmcnt(12)
    v_mfma_f32_32x32x16_bf16 v[192:207], v[148:151], v[64:67], v[192:207]
    s_waitcnt lgkmcnt(10)
    v_mfma_f32_32x32x16_bf16 v[176:191], v[152:155], v[68:71], v[176:191]
    s_waitcnt lgkmcnt(8)
    v_mfma_f32_32x32x16_bf16 v[192:207], v[156:159], v[68:71], v[192:207]
    s_waitcnt vmcnt(0)
    s_waitcnt lgkmcnt(0)
    s_barrier
    ds_read_b64_tr_b16 v[144:145], v208 offset:32768
    ds_read_b64_tr_b16 v[146:147], v208 offset:33024
    ds_read_b64_tr_b16 v[148:149], v208 offset:33280
    ds_read_b64_tr_b16 v[150:151], v208 offset:33536
    ds_read_b64_tr_b16 v[152:153], v208 offset:33792
    ds_read_b64_tr_b16 v[154:155], v208 offset:34048
    v_mfma_f32_32x32x16_bf16 v[176:191], v[160:163], v[72:75], v[176:191]
    ds_read_b64_tr_b16 v[156:157], v208 offset:34304
    ds_read_b64_tr_b16 v[158:159], v208 offset:34560
    v_mfma_f32_32x32x16_bf16 v[192:207], v[164:167], v[72:75], v[192:207]
    ds_read_b64_tr_b16 v[160:161], v208 offset:49152
    ds_read_b64_tr_b16 v[162:163], v208 offset:49408
    v_mfma_f32_32x32x16_bf16 v[176:191], v[168:171], v[76:79], v[176:191]
    ds_read_b64_tr_b16 v[164:165], v208 offset:49664
    ds_read_b64_tr_b16 v[166:167], v208 offset:49920
    v_mfma_f32_32x32x16_bf16 v[192:207], v[172:175], v[76:79], v[192:207]
    ds_read_b64_tr_b16 v[168:169], v208 offset:50176
    ds_read_b64_tr_b16 v[170:171], v208 offset:50432
    s_waitcnt lgkmcnt(12)
    v_mfma_f32_32x32x16_bf16 v[176:191], v[144:147], v[80:83], v[176:191]
    v_mfma_f32_16x16x32_bf16 v[220:223], v[216:219], v[144:147], v[220:223]
    ds_read_b64_tr_b16 v[172:173], v208 offset:50688
    ds_read_b64_tr_b16 v[174:175], v208 offset:50944
    s_waitcnt lgkmcnt(12)
    v_mfma_f32_32x32x16_bf16 v[192:207], v[148:151], v[80:83], v[192:207]
    v_mfma_f32_16x16x32_bf16 v[224:227], v[216:219], v[148:151], v[224:227]
    ds_read_b64_tr_b16 v[144:145], v209 offset:32768
    ds_read_b64_tr_b16 v[146:147], v209 offset:33024
    s_waitcnt lgkmcnt(12)
    v_mfma_f32_32x32x16_bf16 v[176:191], v[152:155], v[84:87], v[176:191]
    v_mfma_f32_16x16x32_bf16 v[220:223], v[216:219], v[152:155], v[220:223]
    ds_read_b64_tr_b16 v[148:149], v209 offset:33280
    ds_read_b64_tr_b16 v[150:151], v209 offset:33536
    s_waitcnt lgkmcnt(12)
    v_mfma_f32_32x32x16_bf16 v[192:207], v[156:159], v[84:87], v[192:207]
    v_mfma_f32_16x16x32_bf16 v[224:227], v[216:219], v[156:159], v[224:227]
    ds_read_b64_tr_b16 v[152:153], v209 offset:33792
    ds_read_b64_tr_b16 v[154:155], v209 offset:34048
    s_waitcnt lgkmcnt(12)
    v_mfma_f32_32x32x16_bf16 v[176:191], v[160:163], v[88:91], v[176:191]
    v_mfma_f32_16x16x32_bf16 v[220:223], v[216:219], v[160:163], v[220:223]
    ds_read_b64_tr_b16 v[156:157], v209 offset:34304
    ds_read_b64_tr_b16 v[158:159], v209 offset:34560
    s_waitcnt lgkmcnt(12)
    v_mfma_f32_32x32x16_bf16 v[192:207], v[164:167], v[88:91], v[192:207]
    v_mfma_f32_16x16x32_bf16 v[224:227], v[216:219], v[164:167], v[224:227]
    ds_read_b64_tr_b16 v[160:161], v209 offset:49152
    ds_read_b64_tr_b16 v[162:163], v209 offset:49408
    s_waitcnt lgkmcnt(12)
    v_mfma_f32_32x32x16_bf16 v[176:191], v[168:171], v[92:95], v[176:191]
    v_mfma_f32_16x16x32_bf16 v[220:223], v[216:219], v[168:171], v[220:223]
    ds_read_b64_tr_b16 v[164:165], v209 offset:49664
    ds_read_b64_tr_b16 v[166:167], v209 offset:49920
    s_waitcnt lgkmcnt(12)
    v_mfma_f32_32x32x16_bf16 v[192:207], v[172:175], v[92:95], v[192:207]
    v_mfma_f32_16x16x32_bf16 v[224:227], v[216:219], v[172:175], v[224:227]
    ds_read_b64_tr_b16 v[168:169], v209 offset:50176
    ds_read_b64_tr_b16 v[170:171], v209 offset:50432
    s_waitcnt lgkmcnt(12)
    v_mfma_f32_32x32x16_bf16 v[176:191], v[144:147], v[96:99], v[176:191]
    ds_read_b64_tr_b16 v[172:173], v209 offset:50688
    ds_read_b64_tr_b16 v[174:175], v209 offset:50944
    s_waitcnt lgkmcnt(12)
    v_mfma_f32_32x32x16_bf16 v[192:207], v[148:151], v[96:99], v[192:207]
    ds_read_b64_tr_b16 v[144:145], v210 offset:32768
    ds_read_b64_tr_b16 v[146:147], v210 offset:33024
    s_waitcnt lgkmcnt(12)
    v_mfma_f32_32x32x16_bf16 v[176:191], v[152:155], v[100:103], v[176:191]
    ds_read_b64_tr_b16 v[148:149], v210 offset:33280
    ds_read_b64_tr_b16 v[150:151], v210 offset:33536
    s_waitcnt lgkmcnt(12)
    v_mfma_f32_32x32x16_bf16 v[192:207], v[156:159], v[100:103], v[192:207]
    ds_read_b64_tr_b16 v[152:153], v210 offset:33792
    ds_read_b64_tr_b16 v[154:155], v210 offset:34048
    s_waitcnt lgkmcnt(12)
    v_mfma_f32_32x32x16_bf16 v[176:191], v[160:163], v[104:107], v[176:191]
    ds_read_b64_tr_b16 v[156:157], v210 offset:34304
    ds_read_b64_tr_b16 v[158:159], v210 offset:34560
    s_waitcnt lgkmcnt(12)
    v_mfma_f32_32x32x16_bf16 v[192:207], v[164:167], v[104:107], v[192:207]
    ds_read_b64_tr_b16 v[160:161], v210 offset:49152
    ds_read_b64_tr_b16 v[162:163], v210 offset:49408
    s_waitcnt lgkmcnt(12)
    v_mfma_f32_32x32x16_bf16 v[176:191], v[168:171], v[108:111], v[176:191]
    ds_read_b64_tr_b16 v[164:165], v210 offset:49664
    ds_read_b64_tr_b16 v[166:167], v210 offset:49920
    s_waitcnt lgkmcnt(12)
    v_mfma_f32_32x32x16_bf16 v[192:207], v[172:175], v[108:111], v[192:207]
    ds_read_b64_tr_b16 v[168:169], v210 offset:50176
    ds_read_b64_tr_b16 v[170:171], v210 offset:50432
    s_waitcnt lgkmcnt(12)
    v_mfma_f32_32x32x16_bf16 v[176:191], v[144:147], v[112:115], v[176:191]
    ds_read_b64_tr_b16 v[172:173], v210 offset:50688
    ds_read_b64_tr_b16 v[174:175], v210 offset:50944
    s_waitcnt lgkmcnt(12)
    v_mfma_f32_32x32x16_bf16 v[192:207], v[148:151], v[112:115], v[192:207]
    v_cndmask_b32 v11, v220, v221, s[52:53]
    ds_write_b32 v5, v11 offset:2048
    ds_read_b64_tr_b16 v[144:145], v211 offset:32768
    ds_read_b64_tr_b16 v[146:147], v211 offset:33024
    s_waitcnt lgkmcnt(13)
    v_mfma_f32_32x32x16_bf16 v[176:191], v[152:155], v[116:119], v[176:191]
    ds_read_b64_tr_b16 v[148:149], v211 offset:33280
    ds_read_b64_tr_b16 v[150:151], v211 offset:33536
    s_waitcnt lgkmcnt(13)
    v_mfma_f32_32x32x16_bf16 v[192:207], v[156:159], v[116:119], v[192:207]
    v_cndmask_b32 v12, v224, v225, s[52:53]
    ds_write_b32 v5, v12 offset:2560
    ds_read_b64_tr_b16 v[152:153], v211 offset:33792
    ds_read_b64_tr_b16 v[154:155], v211 offset:34048
    s_waitcnt lgkmcnt(14)
    v_mfma_f32_32x32x16_bf16 v[176:191], v[160:163], v[120:123], v[176:191]
    ds_read_b64_tr_b16 v[156:157], v211 offset:34304
    ds_read_b64_tr_b16 v[158:159], v211 offset:34560
    s_waitcnt lgkmcnt(14)
    v_mfma_f32_32x32x16_bf16 v[192:207], v[164:167], v[120:123], v[192:207]
    ds_read_b64_tr_b16 v[160:161], v211 offset:49152
    ds_read_b64_tr_b16 v[162:163], v211 offset:49408
    s_waitcnt lgkmcnt(14)
    v_mfma_f32_32x32x16_bf16 v[176:191], v[168:171], v[124:127], v[176:191]
    ds_read_b64_tr_b16 v[164:165], v211 offset:49664
    ds_read_b64_tr_b16 v[166:167], v211 offset:49920
    s_waitcnt lgkmcnt(14)
    v_mfma_f32_32x32x16_bf16 v[192:207], v[172:175], v[124:127], v[192:207]
    ds_read_b64_tr_b16 v[168:169], v211 offset:50176
    ds_read_b64_tr_b16 v[170:171], v211 offset:50432
    s_waitcnt lgkmcnt(13)
    v_mfma_f32_32x32x16_bf16 v[176:191], v[144:147], v[128:131], v[176:191]
    ds_read_b64_tr_b16 v[172:173], v211 offset:50688
    ds_read_b64_tr_b16 v[174:175], v211 offset:50944
    s_waitcnt lgkmcnt(13)
    v_mfma_f32_32x32x16_bf16 v[192:207], v[148:151], v[128:131], v[192:207]
    s_waitcnt lgkmcnt(10)
    v_mfma_f32_32x32x16_bf16 v[176:191], v[152:155], v[132:135], v[176:191]
    s_waitcnt lgkmcnt(8)
    v_mfma_f32_32x32x16_bf16 v[192:207], v[156:159], v[132:135], v[192:207]
    s_waitcnt lgkmcnt(0)
    s_barrier
    v_mfma_f32_32x32x16_bf16 v[176:191], v[160:163], v[136:139], v[176:191]
    v_mfma_f32_32x32x16_bf16 v[192:207], v[164:167], v[136:139], v[192:207]
    v_mfma_f32_32x32x16_bf16 v[176:191], v[168:171], v[140:143], v[176:191]
    v_mfma_f32_32x32x16_bf16 v[192:207], v[172:175], v[140:143], v[192:207]
    s_setprio 0
    s_setprio 2
    ds_read_b128 v[160:163], v6 offset:2048
    ds_read_b128 v[164:167], v6 offset:2560
    s_waitcnt lgkmcnt(0)
    v_add_f32 v160, v160, v161
    v_add_f32 v162, v162, v163
    v_add_f32 v144, v160, v162
    v_and_b32 v145, 0xffff0000, v144
    v_sub_f32 v146, v144, v145
    v_and_b32 v147, 0xffff0000, v146
    v_sub_f32 v146, v146, v147
    v_lshrrev_b32 v145, 16, v145
    v_or_b32 v232, v145, v147
    v_lshrrev_b32 v146, 16, v146
    v_lshl_or_b32 v233, v248, 16, v146
    v_add_f32 v164, v164, v165
    v_add_f32 v166, v166, v167
    v_add_f32 v144, v164, v166
    v_and_b32 v145, 0xffff0000, v144
    v_sub_f32 v146, v144, v145
    v_and_b32 v147, 0xffff0000, v146
    v_sub_f32 v146, v146, v147
    v_lshrrev_b32 v145, 16, v145
    v_or_b32 v236, v145, v147
    v_lshrrev_b32 v146, 16, v146
    v_lshl_or_b32 v237, v249, 16, v146
    v_mfma_f32_32x32x16_bf16 v[176:191], v[232:235], v[228:231], v[176:191]
    s_nop 0
    v_mfma_f32_32x32x16_bf16 v[192:207], v[236:239], v[228:231], v[192:207]
    s_nop 9
    v_mul_f32 v144, v176, v176
    v_mul_f32 v145, v177, v177
    v_mul_f32 v146, v178, v178
    v_mul_f32 v147, v179, v179
    v_mul_f32 v148, v180, v180
    v_mul_f32 v149, v181, v181
    v_mul_f32 v150, v182, v182
    v_mul_f32 v151, v183, v183
    v_fma_f32 v144, v144, v243, v242
    v_fma_f32 v145, v145, v243, v242
    v_fma_f32 v146, v146, v243, v242
    v_fma_f32 v147, v147, v243, v242
    v_fma_f32 v148, v148, v243, v242
    v_fma_f32 v149, v149, v243, v242
    v_fma_f32 v150, v150, v243, v242
    v_fma_f32 v151, v151, v243, v242
    v_mul_f32 v144, v144, v176
    v_mul_f32 v145, v145, v177
    v_mul_f32 v146, v146, v178
    v_mul_f32 v147, v147, v179
    v_mul_f32 v148, v148, v180
    v_mul_f32 v149, v149, v181
    v_mul_f32 v150, v150, v182
    v_mul_f32 v151, v151, v183
    v_exp_f32 v144, v144
    v_exp_f32 v145, v145
    v_exp_f32 v146, v146
    v_exp_f32 v147, v147
    v_exp_f32 v148, v148
    v_exp_f32 v149, v149
    v_exp_f32 v150, v150
    v_exp_f32 v151, v151
    v_fma_f32 v144, v144, v241, v241
    v_fma_f32 v145, v145, v241, v241
    v_fma_f32 v146, v146, v241, v241
    v_fma_f32 v147, v147, v241, v241
    v_fma_f32 v148, v148, v241, v241
    v_fma_f32 v149, v149, v241, v241
    v_lshlrev_b32 v14, 8, v1
    s_cmp_eq_u32 s27, 0
    s_cselect_b32 s62, s47, 268435456
    buffer_load_dword v254, v14, s[36:39], s62 offen offset:0 sc1
    buffer_load_dword v255, v14, s[36:39], s62 offen offset:128 sc1
    v_fma_f32 v150, v150, v241, v241
    v_fma_f32 v151, v151, v241, v241
    v_rcp_f32 v144, v144
    v_rcp_f32 v145, v145
    v_rcp_f32 v146, v146
    v_rcp_f32 v147, v147
    v_rcp_f32 v148, v148
    v_rcp_f32 v149, v149
    v_rcp_f32 v150, v150
    v_rcp_f32 v151, v151
    v_mul_f32 v144, v144, v176
    v_mul_f32 v145, v145, v177
    v_mul_f32 v146, v146, v178
    v_mul_f32 v147, v147, v179
    v_mul_f32 v148, v148, v180
    v_mul_f32 v149, v149, v181
    v_mul_f32 v150, v150, v182
    v_mul_f32 v151, v151, v183
    v_cvt_pk_bf16_f32 v160, v144, v145
    v_cvt_pk_bf16_f32 v161, v146, v147
    v_cvt_pk_bf16_f32 v162, v148, v149
    v_cvt_pk_bf16_f32 v163, v150, v151
    buffer_store_dwordx4 v[160:163], v2, s[36:39], s66 offen offset:0 sc1
    v_mul_f32 v144, v184, v184
    v_mul_f32 v145, v185, v185
    v_mul_f32 v146, v186, v186
    v_mul_f32 v147, v187, v187
    v_mul_f32 v148, v188, v188
    v_mul_f32 v149, v189, v189
    v_mul_f32 v150, v190, v190
    v_mul_f32 v151, v191, v191
    v_fma_f32 v144, v144, v243, v242
    v_fma_f32 v145, v145, v243, v242
    v_fma_f32 v146, v146, v243, v242
    v_fma_f32 v147, v147, v243, v242
    v_fma_f32 v148, v148, v243, v242
    v_fma_f32 v149, v149, v243, v242
    v_fma_f32 v150, v150, v243, v242
    v_fma_f32 v151, v151, v243, v242
    v_mul_f32 v144, v144, v184
    v_mul_f32 v145, v145, v185
    v_mul_f32 v146, v146, v186
    v_mul_f32 v147, v147, v187
    v_mul_f32 v148, v148, v188
    v_mul_f32 v149, v149, v189
    v_mul_f32 v150, v150, v190
    v_mul_f32 v151, v151, v191
    v_exp_f32 v144, v144
    v_exp_f32 v145, v145
    v_exp_f32 v146, v146
    v_exp_f32 v147, v147
    v_exp_f32 v148, v148
    v_exp_f32 v149, v149
    v_exp_f32 v150, v150
    v_exp_f32 v151, v151
    v_fma_f32 v144, v144, v241, v241
    v_fma_f32 v145, v145, v241, v241
    v_fma_f32 v146, v146, v241, v241
    v_fma_f32 v147, v147, v241, v241
    v_fma_f32 v148, v148, v241, v241
    v_fma_f32 v149, v149, v241, v241
    v_fma_f32 v150, v150, v241, v241
    v_fma_f32 v151, v151, v241, v241
    s_waitcnt lgkmcnt(0)
    s_barrier
    s_setprio 3
    s_cmp_lg_u32 s27, 0
    s_cbranch_scc1 L_k1_fkvy1x
    s_mov_b32 s62, 0x40000
    s_waitcnt vmcnt(1)
L_k1_fkvy1:
    v_xor_b32 v254, s100, v254
    v_xor_b32 v255, s100, v255
    v_or_b32 v254, v254, v255
    v_cmp_ne_u32 vcc, 0, v254
    s_sub_u32 s62, s62, 1
    s_cbranch_scc1 L_k1_fkvy1d
    s_nop 3
    s_cbranch_vccz L_k1_fkvy1d
    s_sleep 4
    buffer_load_dword v254, v14, s[36:39], s47 offen offset:0 sc1
    buffer_load_dword v255, v14, s[36:39], s47 offen offset:128 sc1
    s_waitcnt vmcnt(0)
    s_branch L_k1_fkvy1
L_k1_fkvy1d:
    v_mov_b32 v254, 96256
    v_mov_b32 v255, 1
    ds_write_b32 v254, v255 offset:28
L_k1_fkvy1x:
    v_mov_b32 v11, 96256
L_k1_qwy128:
    ds_read_b32 v12, v11 offset:28
    s_waitcnt lgkmcnt(0)
    v_readfirstlane_b32 s62, v12
    s_nop 0
    s_cmp_eq_u32 s62, 0
    s_cbranch_scc1 L_k1_qwy128
    s_add_u32 s63, s85, 0
    s_add_u32 m0, s65, 131072
    s_nop 0
    buffer_load_dwordx4 v2, s[36:39], s63 offen offset:0 sc1 lds
    v_rcp_f32 v144, v144
    v_rcp_f32 v145, v145
    v_rcp_f32 v146, v146
    s_add_u32 m0, s65, 131072
    s_nop 0
    buffer_load_dwordx4 v2, s[36:39], s63 offen offset:1024 sc1 lds
    v_rcp_f32 v147, v147
    v_rcp_f32 v148, v148
    s_add_u32 m0, s65, 131072
    s_nop 0
    buffer_load_dwordx4 v2, s[36:39], s63 offen offset:2048 sc1 lds
    v_rcp_f32 v149, v149
    v_rcp_f32 v150, v150
    v_rcp_f32 v151, v151
    s_add_u32 m0, s65, 131072
    s_nop 0
    buffer_load_dwordx4 v2, s[36:39], s63 offen offset:3072 sc1 lds
    v_mul_f32 v144, v144, v184
    v_mul_f32 v145, v145, v185
    v_mul_f32 v146, v146, v186
    v_mul_f32 v147, v147, v187
    s_add_u32 s63, s85, 4096
    s_add_u32 m0, s65, 135168
    s_nop 0
    buffer_load_dwordx4 v2, s[36:39], s63 offen offset:0 sc1 lds
    v_mul_f32 v148, v148, v188
    v_mul_f32 v149, v149, v189
    v_mul_f32 v150, v150, v190
    v_mul_f32 v151, v151, v191
    v_cvt_pk_bf16_f32 v164, v144, v145
    s_add_u32 m0, s65, 135168
    s_nop 0
    buffer_load_dwordx4 v2, s[36:39], s63 offen offset:1024 sc1 lds
    v_cvt_pk_bf16_f32 v165, v146, v147
    v_cvt_pk_bf16_f32 v166, v148, v149
    v_cvt_pk_bf16_f32 v167, v150, v151
    buffer_store_dwordx4 v[164:167], v2, s[36:39], s66 offen offset:1024 sc1
    s_add_u32 m0, s65, 135168
    s_nop 0
    buffer_load_dwordx4 v2, s[36:39], s63 offen offset:2048 sc1 lds
    s_add_u32 m0, s65, 135168
    s_nop 0
    buffer_load_dwordx4 v2, s[36:39], s63 offen offset:3072 sc1 lds
    v_mul_f32 v144, v192, v192
    v_mul_f32 v145, v193, v193
    v_mul_f32 v146, v194, v194
    v_mul_f32 v147, v195, v195
    v_mul_f32 v148, v196, v196
    v_mul_f32 v149, v197, v197
    v_mul_f32 v150, v198, v198
    v_mul_f32 v151, v199, v199
    v_fma_f32 v144, v144, v243, v242
    v_fma_f32 v145, v145, v243, v242
    v_fma_f32 v146, v146, v243, v242
    v_fma_f32 v147, v147, v243, v242
    s_add_u32 s63, s85, 8192
    s_add_u32 m0, s65, 0
    s_nop 0
    buffer_load_dwordx4 v2, s[36:39], s63 offen offset:0 sc1 lds
    v_fma_f32 v148, v148, v243, v242
    v_fma_f32 v149, v149, v243, v242
    v_fma_f32 v150, v150, v243, v242
    v_fma_f32 v151, v151, v243, v242
    v_mul_f32 v144, v144, v192
    v_mul_f32 v145, v145, v193
    v_mul_f32 v146, v146, v194
    v_mul_f32 v147, v147, v195
    s_add_u32 m0, s65, 0
    s_nop 0
    buffer_load_dwordx4 v2, s[36:39], s63 offen offset:1024 sc1 lds
    v_mul_f32 v148, v148, v196
    v_mul_f32 v149, v149, v197
    v_mul_f32 v150, v150, v198
    v_mul_f32 v151, v151, v199
    v_exp_f32 v144, v144
    v_exp_f32 v145, v145
    s_add_u32 m0, s65, 0
    s_nop 0
    buffer_load_dwordx4 v2, s[36:39], s63 offen offset:2048 sc1 lds
    v_exp_f32 v146, v146
    v_exp_f32 v147, v147
    v_exp_f32 v148, v148
    v_exp_f32 v149, v149
    s_add_u32 m0, s65, 0
    s_nop 0
    buffer_load_dwordx4 v2, s[36:39], s63 offen offset:3072 sc1 lds
    v_exp_f32 v150, v150
    v_exp_f32 v151, v151
    v_fma_f32 v144, v144, v241, v241
    v_fma_f32 v145, v145, v241, v241
    s_add_u32 s63, s85, 12288
    s_add_u32 m0, s65, 4096
    s_nop 0
    buffer_load_dwordx4 v2, s[36:39], s63 offen offset:0 sc1 lds
    v_fma_f32 v146, v146, v241, v241
    v_fma_f32 v147, v147, v241, v241
    v_fma_f32 v148, v148, v241, v241
    v_fma_f32 v149, v149, v241, v241
    v_fma_f32 v150, v150, v241, v241
    v_fma_f32 v151, v151, v241, v241
    v_rcp_f32 v144, v144
    s_add_u32 m0, s65, 4096
    s_nop 0
    buffer_load_dwordx4 v2, s[36:39], s63 offen offset:1024 sc1 lds
    v_rcp_f32 v145, v145
    v_rcp_f32 v146, v146
    v_rcp_f32 v147, v147
    v_rcp_f32 v148, v148
    s_add_u32 m0, s65, 4096
    s_nop 0
    buffer_load_dwordx4 v2, s[36:39], s63 offen offset:2048 sc1 lds
    v_rcp_f32 v149, v149
    v_rcp_f32 v150, v150
    v_rcp_f32 v151, v151
    v_mul_f32 v144, v144, v192
    s_add_u32 m0, s65, 4096
    s_nop 0
    buffer_load_dwordx4 v2, s[36:39], s63 offen offset:3072 sc1 lds
    v_mul_f32 v145, v145, v193
    v_mul_f32 v146, v146, v194
    v_mul_f32 v147, v147, v195
    v_mul_f32 v148, v148, v196
    v_mul_f32 v149, v149, v197
    v_mul_f32 v150, v150, v198
    v_mul_f32 v151, v151, v199
    v_cvt_pk_bf16_f32 v168, v144, v145
    v_cvt_pk_bf16_f32 v169, v146, v147
    v_cvt_pk_bf16_f32 v170, v148, v149
    v_cvt_pk_bf16_f32 v171, v150, v151
    buffer_store_dwordx4 v[168:171], v2, s[36:39], s66 offen offset:2048 sc1
    v_mul_f32 v144, v200, v200
    s_waitcnt vmcnt(9)
    v_mov_b32 v11, 96256
    v_mov_b32 v12, 1
    s_mov_b64 exec, 1
    ds_add_u32 v11, v12 offset:0
    s_mov_b64 exec, -1
    v_mov_b32 v11, 96256
L_k1_qwy120:
    ds_read_b32 v12, v11 offset:20
    s_waitcnt lgkmcnt(0)
    v_readfirstlane_b32 s62, v12
    s_nop 0
    s_cmp_eq_u32 s62, 0
    s_cbranch_scc1 L_k1_qwy120
    buffer_load_dwordx4 v[16:19], v2, s[36:39], s88 offen offset:0 sc1
    buffer_load_dwordx4 v[20:23], v2, s[36:39], s88 offen offset:1024 sc1
    v_mul_f32 v145, v201, v201
    v_mul_f32 v146, v202, v202
    v_mul_f32 v147, v203, v203
    v_mul_f32 v148, v204, v204
    v_mul_f32 v149, v205, v205
    v_mul_f32 v150, v206, v206
    v_mul_f32 v151, v207, v207
    v_fma_f32 v144, v144, v243, v242
    v_fma_f32 v145, v145, v243, v242
    v_fma_f32 v146, v146, v243, v242
    v_fma_f32 v147, v147, v243, v242
    v_fma_f32 v148, v148, v243, v242
    v_fma_f32 v149, v149, v243, v242
    v_fma_f32 v150, v150, v243, v242
    v_fma_f32 v151, v151, v243, v242
    v_mul_f32 v144, v144, v200
    v_mul_f32 v145, v145, v201
    v_mul_f32 v146, v146, v202
    v_mul_f32 v147, v147, v203
    v_mul_f32 v148, v148, v204
    v_mul_f32 v149, v149, v205
    v_mul_f32 v150, v150, v206
    v_mul_f32 v151, v151, v207
    v_exp_f32 v144, v144
    v_exp_f32 v145, v145
    v_exp_f32 v146, v146
    v_exp_f32 v147, v147
    v_exp_f32 v148, v148
    v_exp_f32 v149, v149
    v_exp_f32 v150, v150
    v_exp_f32 v151, v151
    v_fma_f32 v144, v144, v241, v241
    v_fma_f32 v145, v145, v241, v241
    v_fma_f32 v146, v146, v241, v241
    v_fma_f32 v147, v147, v241, v241
    v_fma_f32 v148, v148, v241, v241
    v_fma_f32 v149, v149, v241, v241
    v_fma_f32 v150, v150, v241, v241
    v_fma_f32 v151, v151, v241, v241
    v_rcp_f32 v144, v144
    v_rcp_f32 v145, v145
    v_rcp_f32 v146, v146
    v_rcp_f32 v147, v147
    v_rcp_f32 v148, v148
    v_rcp_f32 v149, v149
    v_rcp_f32 v150, v150
    v_rcp_f32 v151, v151
    v_mul_f32 v144, v144, v200
    v_mul_f32 v145, v145, v201
    v_mul_f32 v146, v146, v202
    v_mul_f32 v147, v147, v203
    v_mul_f32 v148, v148, v204
    v_mul_f32 v149, v149, v205
    v_mul_f32 v150, v150, v206
    v_mul_f32 v151, v151, v207
    v_cvt_pk_bf16_f32 v172, v144, v145
    v_cvt_pk_bf16_f32 v173, v146, v147
    v_cvt_pk_bf16_f32 v174, v148, v149
    v_cvt_pk_bf16_f32 v175, v150, v151
    buffer_store_dwordx4 v[172:175], v2, s[36:39], s66 offen offset:3072 sc1
    s_mov_b32 s96, s85
    s_mov_b32 s97, 1
    s_add_u32 s94, s72, 0
    s_mov_b32 s95, 268435456
    s_branch L_p2
L_p2:
    s_and_b32 s48, s2, 7
    s_lshl_b32 s45, s48, 2
    s_lshr_b32 s50, s2, 6
    s_add_u32 s45, s45, s50
    s_bfe_u32 s46, s2, 0x30003
    s_lshl_b32 s59, s45, 16
    s_lshl_b32 s51, s46, 3
    s_lshl_b32 s48, s27, 1
    s_add_u32 s51, s51, s48
    s_mul_i32 s54, s51, 144
    s_add_u32 s54, s54, s45
    s_lshl_b32 s54, s54, 10
    s_add_u32 s54, s54, 6291456
    s_lshl_b32 s70, s51, 12
    s_lshl_b32 s50, s45, 7
    s_add_u32 s70, s70, s50
    s_add_u32 s70, s70, 19922944
    s_lshr_b32 s62, s26, 1
    s_lshl_b32 s48, s45, 1
    s_and_b32 s49, s26, 1
    s_add_u32 s48, s48, s49
    s_lshl_b32 s71, s45, 13
    s_add_u32 s71, s71, 20447232
    s_lshr_b32 s72, s46, 1
    s_lshl_b32 s72, s72, 14
    s_add_u32 s72, s72, 20709376
    s_mul_i32 s48, s48, 147456
    s_add_u32 s48, s48, 6291456
    s_mul_i32 s49, s46, 294912
    s_add_u32 s49, s49, 16777216
    s_mul_i32 s50, s62, 28672
    s_add_u32 s50, s50, 32768
    s_add_u32 s56, s49, s50
    s_add_u32 s57, s48, s50
    s_lshl_b32 s50, s62, 13
    s_add_u32 s67, s49, s50
    s_add_u32 s68, s48, s50
    s_lshl_b32 s69, s45, 13
    s_add_u32 s69, s69, 19922944
    s_mov_b32 s28, s4
    s_and_b32 s29, s5, 0xffff
    s_mov_b32 s30, 2097152
    s_mov_b32 s31, 0x20000
    s_mov_b32 s32, s18
    s_and_b32 s33, s19, 0xffff
    s_mov_b32 s34, 1024
    s_mov_b32 s35, 0x20000
    s_mov_b32 s40, s20
    s_and_b32 s41, s21, 0xffff
    s_mov_b32 s42, 2097152
    s_mov_b32 s43, 0x20000
    s_lshl_b32 s64, s45, 16
    s_lshl_b32 s50, s26, 13
    s_add_u32 s64, s64, s50
    s_lshl_b32 s65, s46, 7
    s_add_u32 s64, s64, s65
    s_lshl_b32 s48, s44, 13
    v_add_u32 v4, s48, v2
    v_add_u32 v5, 98304, v4
    v_lshrrev_b32 v11, 5, v1
    v_and_b32 v10, 15, v1
    v_lshl_add_u32 v10, v11, 4, v10
    v_lshlrev_b32 v10, 4, v10
    s_add_u32 s48, s48, 16384
    v_add_u32 v6, s48, v10
    v_add_u32 v7, 98304, v6
    s_mul_i32 s48, s27, 6144
    s_add_u32 s48, s48, 65536
    v_add_u32 v8, s48, v2
    v_mov_b32 v3, 0xdddd
    s_mov_b32 s52, 0xffff
    s_mov_b32 s53, 0xffff
    v_and_b32 v10, 27, v1
    v_cmp_eq_u32 vcc, 16, v10
    v_mov_b32 v10, 0x3f803f80
    s_nop 0
    v_cndmask_b32 v10, 0, v10, vcc
    v_mov_b32 v32, v10
    v_mov_b32 v33, v10
    v_mov_b32 v34, v10
    v_mov_b32 v35, v10
    v_mov_b32 v36, v10
    v_mov_b32 v37, v10
    v_mov_b32 v38, v10
    v_mov_b32 v39, v10
    v_mov_b32 v40, v10
    v_mov_b32 v41, v10
    v_mov_b32 v42, v10
    v_mov_b32 v43, v10
    v_mov_b32 v44, v10
    v_mov_b32 v45, v10
    v_mov_b32 v46, v10
    v_mov_b32 v47, v10
    v_mov_b32 v80, 0
    v_mov_b32 v81, 0
    v_mov_b32 v82, 0
    v_mov_b32 v83, 0
    v_mov_b32 v84, 0
    v_mov_b32 v85, 0
    v_mov_b32 v86, 0
    v_mov_b32 v87, 0
    v_mov_b32 v88, 0
    v_mov_b32 v89, 0
    v_mov_b32 v90, 0
    v_mov_b32 v91, 0
    v_mov_b32 v92, 0
    v_mov_b32 v93, 0
    v_mov_b32 v94, 0
    v_mov_b32 v95, 0
    v_mov_b32 v96, 0
    v_mov_b32 v97, 0
    v_mov_b32 v98, 0
    v_mov_b32 v99, 0
    v_mov_b32 v100, 0
    v_mov_b32 v101, 0
    v_mov_b32 v102, 0
    v_mov_b32 v103, 0
    v_mov_b32 v104, 0
    v_mov_b32 v105, 0
    v_mov_b32 v106, 0
    v_mov_b32 v107, 0
    v_mov_b32 v108, 0
    v_mov_b32 v109, 0
    v_mov_b32 v110, 0
    v_mov_b32 v111, 0
    v_mov_b32 v12, 96256
    v_mov_b32 v13, s97
    s_waitcnt vmcnt(0)
    s_mov_b64 exec, 1
    ds_add_u32 v12, v13 offset:4
    s_mov_b64 exec, -1
    s_cmp_eq_u32 s94, 268435456
    s_cbranch_scc1 L_p2_np
    v_lshlrev_b32 v10, 2, v1
    v_mov_b32 v11, s100
    s_mov_b32 exec_hi, 0
    buffer_store_dword v11, v10, s[36:39], s94 offen sc1
    buffer_store_dword v11, v10, s[36:39], s95 offen sc1
    s_mov_b64 exec, -1
L_p2_np:
    s_setprio 2
    v_mov_b32 v10, 96256
L_k2_poll0:
    ds_read_b32 v11, v10 offset:0
    s_waitcnt lgkmcnt(0)
    v_readfirstlane_b32 s66, v11
    s_nop 0
    s_cmp_lt_u32 s66, 4
    s_cbranch_scc1 L_k2_poll0
    ds_read_b128 v[24:27], v5 offset:32768
    s_mov_b64 exec, s[52:53]
    ds_read_b128 v[32:35], v7 offset:32768
    ds_read_b128 v[36:39], v7 offset:33280
    s_mov_b64 exec, -1
    ds_read_b128 v[28:31], v5 offset:33792
    s_waitcnt lgkmcnt(3)
    v_mfma_f32_32x32x16_bf16 v[48:63], v[24:27], v[16:19], 0
    v_mfma_f32_32x32x16_bf16 v[64:79], v[24:27], v[20:23], 0
    s_setprio 2
    s_nop 9
    v_exp_f32 v48, v48
    v_exp_f32 v49, v49
    s_mov_b64 exec, s[52:53]
    ds_read_b128 v[40:43], v7 offset:33792
    ds_read_b128 v[44:47], v7 offset:34304
    s_mov_b64 exec, -1
    v_exp_f32 v50, v50
    v_exp_f32 v51, v51
    v_exp_f32 v52, v52
    v_exp_f32 v53, v53
    ds_read_b128 v[24:27], v5 offset:34816
    v_exp_f32 v54, v54
    v_exp_f32 v55, v55
    v_exp_f32 v56, v56
    v_exp_f32 v57, v57
    s_waitcnt lgkmcnt(4)
    v_smfmac_f32_32x32x32_bf16 v[80:95], v[32:35], v[48:55], v3
    v_exp_f32 v58, v58
    v_exp_f32 v59, v59
    v_exp_f32 v60, v60
    v_exp_f32 v61, v61
    v_exp_f32 v62, v62
    v_exp_f32 v63, v63
    v_exp_f32 v64, v64
    v_exp_f32 v65, v65
    v_smfmac_f32_32x32x32_bf16 v[80:95], v[36:39], v[56:63], v3
    v_exp_f32 v66, v66
    v_exp_f32 v67, v67
    v_exp_f32 v68, v68
    v_exp_f32 v69, v69
    s_waitcnt lgkmcnt(3)
    v_mfma_f32_32x32x16_bf16 v[48:63], v[28:31], v[16:19], 0
    v_exp_f32 v70, v70
    v_exp_f32 v71, v71
    v_exp_f32 v72, v72
    v_exp_f32 v73, v73
    v_smfmac_f32_32x32x32_bf16 v[96:111], v[32:35], v[64:71], v3
    v_exp_f32 v74, v74
    v_exp_f32 v75, v75
    v_exp_f32 v76, v76
    v_exp_f32 v77, v77
    v_exp_f32 v78, v78
    v_exp_f32 v79, v79
    s_nop 0
    v_exp_f32 v48, v48
    v_exp_f32 v49, v49
    v_smfmac_f32_32x32x32_bf16 v[96:111], v[36:39], v[72:79], v3
    s_mov_b64 exec, s[52:53]
    ds_read_b128 v[32:35], v7 offset:34816
    ds_read_b128 v[36:39], v7 offset:35328
    s_mov_b64 exec, -1
    v_exp_f32 v50, v50
    v_exp_f32 v51, v51
    v_exp_f32 v52, v52
    v_exp_f32 v53, v53
    v_mfma_f32_32x32x16_bf16 v[64:79], v[28:31], v[20:23], 0
    ds_read_b128 v[28:31], v5 offset:35840
    v_exp_f32 v54, v54
    v_exp_f32 v55, v55
    v_exp_f32 v56, v56
    v_exp_f32 v57, v57
    s_waitcnt lgkmcnt(4)
    v_smfmac_f32_32x32x32_bf16 v[80:95], v[40:43], v[48:55], v3
    s_lshl_b32 s48, s44, 12
    s_add_u32 s49, s96, s48
    s_add_u32 s49, s49, 16384
    s_lshl_b32 s50, s27, 13
    s_add_u32 s48, s48, s50
    s_add_u32 m0, s48, 32768
    s_nop 0
    buffer_load_dwordx4 v2, s[36:39], s49 offen offset:0 sc1 lds
    buffer_load_dwordx4 v2, s[36:39], s49 offen offset:1024 sc1 lds
    buffer_load_dwordx4 v2, s[36:39], s49 offen offset:2048 sc1 lds
    buffer_load_dwordx4 v2, s[36:39], s49 offen offset:3072 sc1 lds
    v_exp_f32 v58, v58
    v_exp_f32 v59, v59
    v_exp_f32 v60, v60
    v_exp_f32 v61, v61
    v_exp_f32 v62, v62
    v_exp_f32 v63, v63
    v_exp_f32 v64, v64
    v_exp_f32 v65, v65
    v_smfmac_f32_32x32x32_bf16 v[80:95], v[44:47], v[56:63], v3
    v_exp_f32 v66, v66
    v_exp_f32 v67, v67
    v_exp_f32 v68, v68
    v_exp_f32 v69, v69
    s_waitcnt lgkmcnt(3)
    v_mfma_f32_32x32x16_bf16 v[48:63], v[24:27], v[16:19], 0
    v_exp_f32 v70, v70
    v_exp_f32 v71, v71
    v_exp_f32 v72, v72
    v_exp_f32 v73, v73
    v_smfmac_f32_32x32x32_bf16 v[96:111], v[40:43], v[64:71], v3
    v_exp_f32 v74, v74
    v_exp_f32 v75, v75
    v_exp_f32 v76, v76
    v_exp_f32 v77, v77
    v_exp_f32 v78, v78
    v_exp_f32 v79, v79
    s_nop 0
    v_exp_f32 v48, v48
    v_exp_f32 v49, v49
    v_smfmac_f32_32x32x32_bf16 v[96:111], v[44:47], v[72:79], v3
    s_mov_b64 exec, s[52:53]
    ds_read_b128 v[40:43], v7 offset:35840
    ds_read_b128 v[44:47], v7 offset:36352
    s_mov_b64 exec, -1
    v_exp_f32 v50, v50
    v_exp_f32 v51, v51
    v_exp_f32 v52, v52
    v_exp_f32 v53, v53
    v_mfma_f32_32x32x16_bf16 v[64:79], v[24:27], v[20:23], 0
    ds_read_b128 v[24:27], v5 offset:36864
    v_exp_f32 v54, v54
    v_exp_f32 v55, v55
    v_exp_f32 v56, v56
    v_exp_f32 v57, v57
    s_waitcnt lgkmcnt(4)
    v_smfmac_f32_32x32x32_bf16 v[80:95], v[32:35], v[48:55], v3
    v_exp_f32 v58, v58
    v_exp_f32 v59, v59
    v_exp_f32 v60, v60
    v_exp_f32 v61, v61
    v_exp_f32 v62, v62
    v_exp_f32 v63, v63
    v_exp_f32 v64, v64
    v_exp_f32 v65, v65
    v_smfmac_f32_32x32x32_bf16 v[80:95], v[36:39], v[56:63], v3
    v_exp_f32 v66, v66
    v_exp_f32 v67, v67
    v_exp_f32 v68, v68
    v_exp_f32 v69, v69
    s_waitcnt lgkmcnt(3)
    v_mfma_f32_32x32x16_bf16 v[48:63], v[28:31], v[16:19], 0
    v_exp_f32 v70, v70
    v_exp_f32 v71, v71
    v_exp_f32 v72, v72
    v_exp_f32 v73, v73
    v_smfmac_f32_32x32x32_bf16 v[96:111], v[32:35], v[64:71], v3
    v_exp_f32 v74, v74
    v_exp_f32 v75, v75
    v_exp_f32 v76, v76
    v_exp_f32 v77, v77
    v_exp_f32 v78, v78
    v_exp_f32 v79, v79
    s_nop 0
    v_exp_f32 v48, v48
    v_exp_f32 v49, v49
    v_smfmac_f32_32x32x32_bf16 v[96:111], v[36:39], v[72:79], v3
    s_mov_b64 exec, s[52:53]
    ds_read_b128 v[32:35], v7 offset:36864
    ds_read_b128 v[36:39], v7 offset:37376
    s_mov_b64 exec, -1
    v_exp_f32 v50, v50
    v_exp_f32 v51, v51
    v_exp_f32 v52, v52
    v_exp_f32 v53, v53
    v_mfma_f32_32x32x16_bf16 v[64:79], v[28:31], v[20:23], 0
    ds_read_b128 v[28:31], v5 offset:37888
    v_exp_f32 v54, v54
    v_exp_f32 v55, v55
    v_exp_f32 v56, v56
    v_exp_f32 v57, v57
    s_waitcnt lgkmcnt(4)
    v_smfmac_f32_32x32x32_bf16 v[80:95], v[40:43], v[48:55], v3
    s_lshl_b32 s48, s44, 12
    s_add_u32 s49, s96, s48
    s_add_u32 s49, s49, 24576
    s_lshl_b32 s50, s27, 13
    s_add_u32 s48, s48, s50
    s_add_u32 m0, s48, 98304
    s_nop 0
    buffer_load_dwordx4 v2, s[36:39], s49 offen offset:0 sc1 lds
    buffer_load_dwordx4 v2, s[36:39], s49 offen offset:1024 sc1 lds
    buffer_load_dwordx4 v2, s[36:39], s49 offen offset:2048 sc1 lds
    buffer_load_dwordx4 v2, s[36:39], s49 offen offset:3072 sc1 lds
    v_exp_f32 v58, v58
    v_exp_f32 v59, v59
    v_exp_f32 v60, v60
    v_exp_f32 v61, v61
    v_exp_f32 v62, v62
    v_exp_f32 v63, v63
    v_exp_f32 v64, v64
    v_exp_f32 v65, v65
    v_smfmac_f32_32x32x32_bf16 v[80:95], v[44:47], v[56:63], v3
    v_exp_f32 v66, v66
    v_exp_f32 v67, v67
    v_exp_f32 v68, v68
    v_exp_f32 v69, v69
    s_waitcnt lgkmcnt(3)
    v_mfma_f32_32x32x16_bf16 v[48:63], v[24:27], v[16:19], 0
    v_exp_f32 v70, v70
    v_exp_f32 v71, v71
    v_exp_f32 v72, v72
    v_exp_f32 v73, v73
    v_smfmac_f32_32x32x32_bf16 v[96:111], v[40:43], v[64:71], v3
    v_exp_f32 v74, v74
    v_exp_f32 v75, v75
    v_exp_f32 v76, v76
    v_exp_f32 v77, v77
    v_exp_f32 v78, v78
    v_exp_f32 v79, v79
    s_nop 0
    v_exp_f32 v48, v48
    v_exp_f32 v49, v49
    v_smfmac_f32_32x32x32_bf16 v[96:111], v[44:47], v[72:79], v3
    s_mov_b64 exec, s[52:53]
    ds_read_b128 v[40:43], v7 offset:37888
    ds_read_b128 v[44:47], v7 offset:38400
    s_mov_b64 exec, -1
    v_exp_f32 v50, v50
    v_exp_f32 v51, v51
    v_exp_f32 v52, v52
    v_exp_f32 v53, v53
    v_mfma_f32_32x32x16_bf16 v[64:79], v[24:27], v[20:23], 0
    ds_read_b128 v[24:27], v5 offset:38912
    v_exp_f32 v54, v54
    v_exp_f32 v55, v55
    v_exp_f32 v56, v56
    v_exp_f32 v57, v57
    s_waitcnt lgkmcnt(4)
    v_smfmac_f32_32x32x32_bf16 v[80:95], v[32:35], v[48:55], v3
    v_exp_f32 v58, v58
    v_exp_f32 v59, v59
    v_exp_f32 v60, v60
    v_exp_f32 v61, v61
    v_exp_f32 v62, v62
    v_exp_f32 v63, v63
    v_exp_f32 v64, v64
    v_exp_f32 v65, v65
    v_smfmac_f32_32x32x32_bf16 v[80:95], v[36:39], v[56:63], v3
    v_exp_f32 v66, v66
    v_exp_f32 v67, v67
    v_exp_f32 v68, v68
    v_exp_f32 v69, v69
    s_waitcnt lgkmcnt(3)
    v_mfma_f32_32x32x16_bf16 v[48:63], v[28:31], v[16:19], 0
    v_exp_f32 v70, v70
    v_exp_f32 v71, v71
    v_exp_f32 v72, v72
    v_exp_f32 v73, v73
    v_smfmac_f32_32x32x32_bf16 v[96:111], v[32:35], v[64:71], v3
    v_exp_f32 v74, v74
    v_exp_f32 v75, v75
    v_exp_f32 v76, v76
    v_exp_f32 v77, v77
    v_exp_f32 v78, v78
    v_exp_f32 v79, v79
    v_mov_b32 v10, 96256
L_k2_poll1:
    ds_read_b32 v11, v10 offset:4
    s_waitcnt lgkmcnt(0)
    v_readfirstlane_b32 s66, v11
    s_nop 0
    s_cmp_lt_u32 s66, 4
    s_cbranch_scc1 L_k2_poll1
    v_exp_f32 v48, v48
    v_exp_f32 v49, v49
    v_smfmac_f32_32x32x32_bf16 v[96:111], v[36:39], v[72:79], v3
    s_mov_b64 exec, s[52:53]
    ds_read_b128 v[32:35], v7 offset:38912
    ds_read_b128 v[36:39], v7 offset:39424
    s_mov_b64 exec, -1
    v_exp_f32 v50, v50
    v_exp_f32 v51, v51
    v_exp_f32 v52, v52
    v_exp_f32 v53, v53
    v_mfma_f32_32x32x16_bf16 v[64:79], v[28:31], v[20:23], 0
    ds_read_b128 v[28:31], v5 offset:39936
    v_exp_f32 v54, v54
    v_exp_f32 v55, v55
    v_exp_f32 v56, v56
    v_exp_f32 v57, v57
    v_smfmac_f32_32x32x32_bf16 v[80:95], v[40:43], v[48:55], v3
    v_exp_f32 v58, v58
    v_exp_f32 v59, v59
    v_exp_f32 v60, v60
    v_exp_f32 v61, v61
    v_exp_f32 v62, v62
    v_exp_f32 v63, v63
    v_exp_f32 v64, v64
    v_exp_f32 v65, v65
    v_smfmac_f32_32x32x32_bf16 v[80:95], v[44:47], v[56:63], v3
    v_exp_f32 v66, v66
    v_exp_f32 v67, v67
    v_exp_f32 v68, v68
    v_exp_f32 v69, v69
    v_mfma_f32_32x32x16_bf16 v[48:63], v[24:27], v[16:19], 0
    v_exp_f32 v70, v70
    v_exp_f32 v71, v71
    v_exp_f32 v72, v72
    v_exp_f32 v73, v73
    v_smfmac_f32_32x32x32_bf16 v[96:111], v[40:43], v[64:71], v3
    v_exp_f32 v74, v74
    v_exp_f32 v75, v75
    v_exp_f32 v76, v76
    v_exp_f32 v77, v77
    v_exp_f32 v78, v78
    v_exp_f32 v79, v79
    s_nop 0
    v_exp_f32 v48, v48
    v_exp_f32 v49, v49
    v_smfmac_f32_32x32x32_bf16 v[96:111], v[44:47], v[72:79], v3
    s_mov_b64 exec, s[52:53]
    ds_read_b128 v[40:43], v7 offset:39936
    ds_read_b128 v[44:47], v7 offset:40448
    s_mov_b64 exec, -1
    v_exp_f32 v50, v50
    v_exp_f32 v51, v51
    v_exp_f32 v52, v52
    v_exp_f32 v53, v53
    v_mfma_f32_32x32x16_bf16 v[64:79], v[24:27], v[20:23], 0
    ds_read_b128 v[24:27], v4 offset:0
    v_exp_f32 v54, v54
    v_exp_f32 v55, v55
    v_exp_f32 v56, v56
    v_exp_f32 v57, v57
    s_waitcnt lgkmcnt(4)
    v_smfmac_f32_32x32x32_bf16 v[80:95], v[32:35], v[48:55], v3
    s_waitcnt vmcnt(0)
    v_mov_b32 v12, 96256
    v_mov_b32 v13, 1
    s_mov_b64 exec, 1
    ds_add_u32 v12, v13 offset:8
    s_mov_b64 exec, -1
    v_exp_f32 v58, v58
    v_exp_f32 v59, v59
    v_exp_f32 v60, v60
    v_exp_f32 v61, v61
    v_exp_f32 v62, v62
    v_exp_f32 v63, v63
    v_exp_f32 v64, v64
    v_exp_f32 v65, v65
    v_smfmac_f32_32x32x32_bf16 v[80:95], v[36:39], v[56:63], v3
    v_exp_f32 v66, v66
    v_exp_f32 v67, v67
    v_exp_f32 v68, v68
    v_exp_f32 v69, v69
    s_waitcnt lgkmcnt(4)
    v_mfma_f32_32x32x16_bf16 v[48:63], v[28:31], v[16:19], 0
    v_exp_f32 v70, v70
    v_exp_f32 v71, v71
    v_exp_f32 v72, v72
    v_exp_f32 v73, v73
    v_smfmac_f32_32x32x32_bf16 v[96:111], v[32:35], v[64:71], v3
    v_exp_f32 v74, v74
    v_exp_f32 v75, v75
    v_exp_f32 v76, v76
    v_exp_f32 v77, v77
    v_exp_f32 v78, v78
    v_exp_f32 v79, v79
    s_nop 0
    v_exp_f32 v48, v48
    v_exp_f32 v49, v49
    v_smfmac_f32_32x32x32_bf16 v[96:111], v[36:39], v[72:79], v3
    s_mov_b64 exec, s[52:53]
    ds_read_b128 v[32:35], v6 offset:0
    ds_read_b128 v[36:39], v6 offset:512
    s_mov_b64 exec, -1
    v_exp_f32 v50, v50
    v_exp_f32 v51, v51
    v_exp_f32 v52, v52
    v_exp_f32 v53, v53
    v_mfma_f32_32x32x16_bf16 v[64:79], v[28:31], v[20:23], 0
    ds_read_b128 v[28:31], v4 offset:1024
    v_exp_f32 v54, v54
    v_exp_f32 v55, v55
    v_exp_f32 v56, v56
    v_exp_f32 v57, v57
    s_waitcnt lgkmcnt(5)
    v_smfmac_f32_32x32x32_bf16 v[80:95], v[40:43], v[48:55], v3
    s_cmp_lg_u32 s27, 0
    s_cbranch_scc1 L_p2_gx
    v_lshlrev_b32 v11, 7, v1
    v_min_u32 v12, 896, v11
    v_add_u32 v12, 8192, v12
    s_mov_b32 s55, 0x40000
L_p2_g:
    buffer_load_dword v144, v11, s[36:39], s71 offen sc1
    buffer_load_dword v145, v11, s[36:39], s72 offen sc1
    buffer_load_dword v146, v12, s[36:39], s72 offen sc1
    s_waitcnt vmcnt(0)
    v_xor_b32 v144, s100, v144
    v_xor_b32 v145, s100, v145
    v_xor_b32 v146, s100, v146
    v_or3_b32 v144, v144, v145, v146
    v_cmp_ne_u32 vcc, 0, v144
    s_sub_u32 s55, s55, 1
    s_cbranch_scc1 L_p2_gd
    s_nop 3
    s_cbranch_vccz L_p2_gd
    s_sleep 8
    s_branch L_p2_g
L_p2_gd:
    v_mov_b32 v11, 96256
    v_mov_b32 v12, 1
    ds_write_b32 v11, v12 offset:24
    s_waitcnt lgkmcnt(0)
L_p2_gx:
    v_exp_f32 v58, v58
    v_exp_f32 v59, v59
    v_exp_f32 v60, v60
    v_exp_f32 v61, v61
    v_exp_f32 v62, v62
    v_exp_f32 v63, v63
    v_exp_f32 v64, v64
    v_exp_f32 v65, v65
    v_smfmac_f32_32x32x32_bf16 v[80:95], v[44:47], v[56:63], v3
    v_exp_f32 v66, v66
    v_exp_f32 v67, v67
    v_exp_f32 v68, v68
    v_exp_f32 v69, v69
    s_waitcnt lgkmcnt(4)
    v_mfma_f32_32x32x16_bf16 v[48:63], v[24:27], v[16:19], 0
    v_exp_f32 v70, v70
    v_exp_f32 v71, v71
    v_exp_f32 v72, v72
    v_exp_f32 v73, v73
    v_smfmac_f32_32x32x32_bf16 v[96:111], v[40:43], v[64:71], v3
    v_exp_f32 v74, v74
    v_exp_f32 v75, v75
    v_exp_f32 v76, v76
    v_exp_f32 v77, v77
    v_exp_f32 v78, v78
    v_exp_f32 v79, v79
    s_nop 0
    v_exp_f32 v48, v48
    v_exp_f32 v49, v49
    v_smfmac_f32_32x32x32_bf16 v[96:111], v[44:47], v[72:79], v3
    s_mov_b64 exec, s[52:53]
    ds_read_b128 v[40:43], v6 offset:1024
    ds_read_b128 v[44:47], v6 offset:1536
    s_mov_b64 exec, -1
    v_exp_f32 v50, v50
    v_exp_f32 v51, v51
    v_exp_f32 v52, v52
    v_exp_f32 v53, v53
    v_mfma_f32_32x32x16_bf16 v[64:79], v[24:27], v[20:23], 0
    ds_read_b128 v[24:27], v4 offset:2048
    v_exp_f32 v54, v54
    v_exp_f32 v55, v55
    v_exp_f32 v56, v56
    v_exp_f32 v57, v57
    s_waitcnt lgkmcnt(4)
    v_smfmac_f32_32x32x32_bf16 v[80:95], v[32:35], v[48:55], v3
    v_exp_f32 v58, v58
    v_exp_f32 v59, v59
    v_exp_f32 v60, v60
    v_exp_f32 v61, v61
    v_exp_f32 v62, v62
    v_exp_f32 v63, v63
    v_exp_f32 v64, v64
    v_exp_f32 v65, v65
    v_smfmac_f32_32x32x32_bf16 v[80:95], v[36:39], v[56:63], v3
    v_exp_f32 v66, v66
    v_exp_f32 v67, v67
    v_exp_f32 v68, v68
    v_exp_f32 v69, v69
    s_waitcnt lgkmcnt(3)
    v_mfma_f32_32x32x16_bf16 v[48:63], v[28:31], v[16:19], 0
    v_exp_f32 v70, v70
    v_exp_f32 v71, v71
    v_exp_f32 v72, v72
    v_exp_f32 v73, v73
    v_smfmac_f32_32x32x32_bf16 v[96:111], v[32:35], v[64:71], v3
    v_exp_f32 v74, v74
    v_exp_f32 v75, v75
    v_exp_f32 v76, v76
    v_exp_f32 v77, v77
    v_exp_f32 v78, v78
    v_exp_f32 v79, v79
    s_nop 0
    v_exp_f32 v48, v48
    v_exp_f32 v49, v49
    v_smfmac_f32_32x32x32_bf16 v[96:111], v[36:39], v[72:79], v3
    s_mov_b64 exec, s[52:53]
    ds_read_b128 v[32:35], v6 offset:2048
    ds_read_b128 v[36:39], v6 offset:2560
    s_mov_b64 exec, -1
    v_exp_f32 v50, v50
    v_exp_f32 v51, v51
    v_exp_f32 v52, v52
    v_exp_f32 v53, v53
    v_mfma_f32_32x32x16_bf16 v[64:79], v[28:31], v[20:23], 0
    ds_read_b128 v[28:31], v4 offset:3072
    v_exp_f32 v54, v54
    v_exp_f32 v55, v55
    v_exp_f32 v56, v56
    v_exp_f32 v57, v57
    s_waitcnt lgkmcnt(4)
    v_smfmac_f32_32x32x32_bf16 v[80:95], v[40:43], v[48:55], v3
    v_mov_b32 v10, 96256
L_k2_poll2:
    ds_read_b32 v11, v10 offset:24
    s_waitcnt lgkmcnt(0)
    v_readfirstlane_b32 s66, v11
    s_nop 0
    s_cmp_lt_u32 s66, 1
    s_cbranch_scc1 L_k2_poll2
    v_exp_f32 v58, v58
    v_exp_f32 v59, v59
    v_exp_f32 v60, v60
    v_exp_f32 v61, v61
    s_add_u32 s58, s56, 147456
    buffer_load_dwordx4 v[144:147], v2, s[36:39], s57 offen offset:0 sc1
    v_exp_f32 v62, v62
    v_exp_f32 v63, v63
    v_exp_f32 v64, v64
    v_exp_f32 v65, v65
    v_smfmac_f32_32x32x32_bf16 v[80:95], v[44:47], v[56:63], v3
    buffer_load_dwordx4 v[148:151], v2, s[36:39], s56 offen offset:0
    v_exp_f32 v66, v66
    v_exp_f32 v67, v67
    v_exp_f32 v68, v68
    v_exp_f32 v69, v69
    v_mfma_f32_32x32x16_bf16 v[48:63], v[24:27], v[16:19], 0
    buffer_load_dwordx4 v[152:155], v2, s[36:39], s58 offen offset:0
    v_exp_f32 v70, v70
    v_exp_f32 v71, v71
    v_exp_f32 v72, v72
    v_exp_f32 v73, v73
    v_smfmac_f32_32x32x32_bf16 v[96:111], v[40:43], v[64:71], v3
    buffer_load_dwordx4 v[156:159], v2, s[36:39], s57 offen offset:1024 sc1
    v_exp_f32 v74, v74
    v_exp_f32 v75, v75
    v_exp_f32 v76, v76
    v_exp_f32 v77, v77
    buffer_load_dwordx4 v[160:163], v2, s[36:39], s56 offen offset:1024
    v_exp_f32 v78, v78
    v_exp_f32 v79, v79
    v_exp_f32 v48, v48
    v_exp_f32 v49, v49
    v_smfmac_f32_32x32x32_bf16 v[96:111], v[44:47], v[72:79], v3
    s_mov_b64 exec, s[52:53]
    ds_read_b128 v[40:43], v6 offset:3072
    ds_read_b128 v[44:47], v6 offset:3584
    s_mov_b64 exec, -1
    buffer_load_dwordx4 v[164:167], v2, s[36:39], s58 offen offset:1024
    v_exp_f32 v50, v50
    v_exp_f32 v51, v51
    v_exp_f32 v52, v52
    v_exp_f32 v53, v53
    v_mfma_f32_32x32x16_bf16 v[64:79], v[24:27], v[20:23], 0
    ds_read_b128 v[24:27], v4 offset:4096
    buffer_load_dwordx4 v[168:171], v2, s[36:39], s57 offen offset:2048 sc1
    v_exp_f32 v54, v54
    v_exp_f32 v55, v55
    v_exp_f32 v56, v56
    v_exp_f32 v57, v57
    v_smfmac_f32_32x32x32_bf16 v[80:95], v[32:35], v[48:55], v3
    buffer_load_dwordx4 v[172:175], v2, s[36:39], s56 offen offset:2048
    v_exp_f32 v58, v58
    v_exp_f32 v59, v59
    v_exp_f32 v60, v60
    v_exp_f32 v61, v61
    buffer_load_dwordx4 v[176:179], v2, s[36:39], s58 offen offset:2048
    v_exp_f32 v62, v62
    v_exp_f32 v63, v63
    v_exp_f32 v64, v64
    v_exp_f32 v65, v65
    v_smfmac_f32_32x32x32_bf16 v[80:95], v[36:39], v[56:63], v3
    buffer_load_dwordx4 v[180:183], v2, s[36:39], s57 offen offset:3072 sc1
    v_exp_f32 v66, v66
    v_exp_f32 v67, v67
    v_exp_f32 v68, v68
    v_exp_f32 v69, v69
    v_mfma_f32_32x32x16_bf16 v[48:63], v[28:31], v[16:19], 0
    buffer_load_dwordx4 v[184:187], v2, s[36:39], s56 offen offset:3072
    v_exp_f32 v70, v70
    v_exp_f32 v71, v71
    v_exp_f32 v72, v72
    v_exp_f32 v73, v73
    v_smfmac_f32_32x32x32_bf16 v[96:111], v[32:35], v[64:71], v3
    buffer_load_dwordx4 v[188:191], v2, s[36:39], s58 offen offset:3072
    v_exp_f32 v74, v74
    v_exp_f32 v75, v75
    v_exp_f32 v76, v76
    v_exp_f32 v77, v77
    v_exp_f32 v78, v78
    v_exp_f32 v79, v79
    v_exp_f32 v48, v48
    v_exp_f32 v49, v49
    v_smfmac_f32_32x32x32_bf16 v[96:111], v[36:39], v[72:79], v3
    s_mov_b64 exec, s[52:53]
    ds_read_b128 v[32:35], v6 offset:4096
    ds_read_b128 v[36:39], v6 offset:4608
    s_mov_b64 exec, -1
    v_exp_f32 v50, v50
    v_exp_f32 v51, v51
    v_exp_f32 v52, v52
    v_mfma_f32_32x32x16_bf16 v[64:79], v[28:31], v[20:23], 0
    ds_read_b128 v[28:31], v4 offset:5120
    v_exp_f32 v53, v53
    v_exp_f32 v54, v54
    v_exp_f32 v55, v55
    s_waitcnt vmcnt(10)
    v_mfma_f32_32x32x16_bf16 v[112:127], v[148:151], v[144:147], 0
    v_exp_f32 v56, v56
    v_exp_f32 v57, v57
    v_exp_f32 v58, v58
    s_waitcnt lgkmcnt(4)
    v_smfmac_f32_32x32x32_bf16 v[80:95], v[40:43], v[48:55], v3
    v_exp_f32 v59, v59
    v_exp_f32 v60, v60
    v_exp_f32 v61, v61
    s_waitcnt vmcnt(7)
    v_mfma_f32_32x32x16_bf16 v[112:127], v[160:163], v[156:159], v[112:127]
    s_add_u32 s51, s67, 0
    buffer_load_dwordx4 v[192:195], v2, s[36:39], s51 offen offset:0
    v_exp_f32 v62, v62
    v_exp_f32 v63, v63
    v_exp_f32 v64, v64
    v_exp_f32 v65, v65
    v_smfmac_f32_32x32x32_bf16 v[80:95], v[44:47], v[56:63], v3
    v_exp_f32 v66, v66
    v_exp_f32 v67, v67
    v_exp_f32 v68, v68
    s_waitcnt lgkmcnt(3)
    v_mfma_f32_32x32x16_bf16 v[48:63], v[24:27], v[16:19], 0
    v_exp_f32 v69, v69
    v_exp_f32 v70, v70
    v_exp_f32 v71, v71
    v_mfma_f32_32x32x16_bf16 v[128:143], v[152:155], v[144:147], 0
    v_exp_f32 v72, v72
    v_exp_f32 v73, v73
    v_exp_f32 v74, v74
    v_smfmac_f32_32x32x32_bf16 v[96:111], v[40:43], v[64:71], v3
    v_exp_f32 v75, v75
    v_exp_f32 v76, v76
    v_exp_f32 v77, v77
    s_waitcnt vmcnt(7)
    v_mfma_f32_32x32x16_bf16 v[128:143], v[164:167], v[156:159], v[128:143]
    v_exp_f32 v78, v78
    v_exp_f32 v79, v79
    v_exp_f32 v48, v48
    v_exp_f32 v49, v49
    v_smfmac_f32_32x32x32_bf16 v[96:111], v[44:47], v[72:79], v3
    s_mov_b64 exec, s[52:53]
    ds_read_b128 v[40:43], v6 offset:5120
    ds_read_b128 v[44:47], v6 offset:5632
    s_mov_b64 exec, -1
    v_exp_f32 v50, v50
    v_exp_f32 v51, v51
    v_exp_f32 v52, v52
    v_exp_f32 v53, v53
    v_mfma_f32_32x32x16_bf16 v[64:79], v[24:27], v[20:23], 0
    ds_read_b128 v[24:27], v4 offset:6144
    v_exp_f32 v54, v54
    v_exp_f32 v55, v55
    v_exp_f32 v56, v56
    v_exp_f32 v57, v57
    s_waitcnt lgkmcnt(4)
    v_smfmac_f32_32x32x32_bf16 v[80:95], v[32:35], v[48:55], v3
    v_exp_f32 v58, v58
    v_exp_f32 v59, v59
    v_exp_f32 v60, v60
    v_exp_f32 v61, v61
    s_waitcnt vmcnt(5)
    v_mfma_f32_32x32x16_bf16 v[112:127], v[172:175], v[168:171], v[112:127]
    s_add_u32 s56, s56, 4096
    s_add_u32 s57, s57, 4096
    s_add_u32 s58, s56, 147456
    buffer_load_dwordx4 v[144:147], v2, s[36:39], s57 offen offset:0 sc1
    v_exp_f32 v62, v62
    v_exp_f32 v63, v63
    v_exp_f32 v64, v64
    v_exp_f32 v65, v65
    v_smfmac_f32_32x32x32_bf16 v[80:95], v[36:39], v[56:63], v3
    buffer_load_dwordx4 v[148:151], v2, s[36:39], s56 offen offset:0
    v_exp_f32 v66, v66
    v_exp_f32 v67, v67
    v_exp_f32 v68, v68
    v_exp_f32 v69, v69
    s_waitcnt lgkmcnt(3)
    v_mfma_f32_32x32x16_bf16 v[48:63], v[28:31], v[16:19], 0
    buffer_load_dwordx4 v[152:155], v2, s[36:39], s58 offen offset:0
    v_exp_f32 v70, v70
    v_exp_f32 v71, v71
    v_exp_f32 v72, v72
    v_exp_f32 v73, v73
    v_smfmac_f32_32x32x32_bf16 v[96:111], v[32:35], v[64:71], v3
    buffer_load_dwordx4 v[156:159], v2, s[36:39], s57 offen offset:1024 sc1
    v_exp_f32 v74, v74
    v_exp_f32 v75, v75
    v_exp_f32 v76, v76
    v_exp_f32 v77, v77
    s_waitcnt vmcnt(8)
    v_mfma_f32_32x32x16_bf16 v[128:143], v[176:179], v[168:171], v[128:143]
    buffer_load_dwordx4 v[160:163], v2, s[36:39], s56 offen offset:1024
    v_exp_f32 v78, v78
    v_exp_f32 v79, v79
    v_mov_b32 v10, 96256
L_k2_poll3:
    ds_read_b32 v11, v10 offset:8
    s_waitcnt lgkmcnt(0)
    v_readfirstlane_b32 s66, v11
    s_nop 0
    s_cmp_lt_u32 s66, 8
    s_cbranch_scc1 L_k2_poll3
    v_exp_f32 v48, v48
    v_exp_f32 v49, v49
    v_smfmac_f32_32x32x32_bf16 v[96:111], v[36:39], v[72:79], v3
    s_mov_b64 exec, s[52:53]
    ds_read_b128 v[32:35], v6 offset:6144
    ds_read_b128 v[36:39], v6 offset:6656
    s_mov_b64 exec, -1
    buffer_load_dwordx4 v[164:167], v2, s[36:39], s58 offen offset:1024
    v_exp_f32 v50, v50
    v_exp_f32 v51, v51
    v_exp_f32 v52, v52
    v_exp_f32 v53, v53
    v_mfma_f32_32x32x16_bf16 v[64:79], v[28:31], v[20:23], 0
    ds_read_b128 v[28:31], v4 offset:7168
    buffer_load_dwordx4 v[196:199], v2, s[36:39], s51 offen offset:1024
    v_exp_f32 v54, v54
    v_exp_f32 v55, v55
    v_exp_f32 v56, v56
    v_exp_f32 v57, v57
    v_smfmac_f32_32x32x32_bf16 v[80:95], v[40:43], v[48:55], v3
    v_exp_f32 v58, v58
    v_exp_f32 v59, v59
    v_exp_f32 v60, v60
    v_exp_f32 v61, v61
    s_waitcnt vmcnt(9)
    v_mfma_f32_32x32x16_bf16 v[112:127], v[184:187], v[180:183], v[112:127]
    buffer_load_dwordx4 v[168:171], v2, s[36:39], s57 offen offset:2048 sc1
    v_exp_f32 v62, v62
    v_exp_f32 v63, v63
    v_exp_f32 v64, v64
    v_exp_f32 v65, v65
    v_smfmac_f32_32x32x32_bf16 v[80:95], v[44:47], v[56:63], v3
    buffer_load_dwordx4 v[172:175], v2, s[36:39], s56 offen offset:2048
    v_exp_f32 v66, v66
    v_exp_f32 v67, v67
    v_exp_f32 v68, v68
    v_exp_f32 v69, v69
    v_mfma_f32_32x32x16_bf16 v[48:63], v[24:27], v[16:19], 0
    buffer_load_dwordx4 v[176:179], v2, s[36:39], s58 offen offset:2048
    v_exp_f32 v70, v70
    v_exp_f32 v71, v71
    v_exp_f32 v72, v72
    v_exp_f32 v73, v73
    v_smfmac_f32_32x32x32_bf16 v[96:111], v[40:43], v[64:71], v3
    buffer_load_dwordx4 v[200:203], v2, s[36:39], s51 offen offset:2048
    v_exp_f32 v74, v74
    v_exp_f32 v75, v75
    v_exp_f32 v76, v76
    v_exp_f32 v77, v77
    s_waitcnt vmcnt(12)
    v_mfma_f32_32x32x16_bf16 v[128:143], v[188:191], v[180:183], v[128:143]
    v_exp_f32 v78, v78
    v_exp_f32 v79, v79
    v_exp_f32 v48, v48
    v_exp_f32 v49, v49
    v_smfmac_f32_32x32x32_bf16 v[96:111], v[44:47], v[72:79], v3
    s_mov_b64 exec, s[52:53]
    ds_read_b128 v[40:43], v6 offset:7168
    ds_read_b128 v[44:47], v6 offset:7680
    s_mov_b64 exec, -1
    v_exp_f32 v50, v50
    v_exp_f32 v51, v51
    v_exp_f32 v52, v52
    v_mfma_f32_32x32x16_bf16 v[64:79], v[24:27], v[20:23], 0
    ds_read_b128 v[24:27], v4 offset:32768
    v_exp_f32 v53, v53
    v_exp_f32 v54, v54
    v_exp_f32 v55, v55
    s_waitcnt vmcnt(9)
    v_mfma_f32_32x32x16_bf16 v[112:127], v[148:151], v[144:147], v[112:127]
    v_exp_f32 v56, v56
    v_exp_f32 v57, v57
    v_exp_f32 v58, v58
    s_waitcnt lgkmcnt(4)
    v_smfmac_f32_32x32x32_bf16 v[80:95], v[32:35], v[48:55], v3
    v_exp_f32 v59, v59
    v_exp_f32 v60, v60
    v_exp_f32 v61, v61
    s_waitcnt vmcnt(6)
    v_mfma_f32_32x32x16_bf16 v[112:127], v[160:163], v[156:159], v[112:127]
    buffer_load_dwordx4 v[180:183], v2, s[36:39], s57 offen offset:3072 sc1
    v_exp_f32 v62, v62
    v_exp_f32 v63, v63
    v_exp_f32 v64, v64
    v_exp_f32 v65, v65
    v_smfmac_f32_32x32x32_bf16 v[80:95], v[36:39], v[56:63], v3
    buffer_load_dwordx4 v[184:187], v2, s[36:39], s56 offen offset:3072
    v_exp_f32 v66, v66
    v_exp_f32 v67, v67
    v_exp_f32 v68, v68
    s_waitcnt lgkmcnt(3)
    v_mfma_f32_32x32x16_bf16 v[48:63], v[28:31], v[16:19], 0
    buffer_load_dwordx4 v[188:191], v2, s[36:39], s58 offen offset:3072
    v_exp_f32 v69, v69
    v_exp_f32 v70, v70
    v_exp_f32 v71, v71
    v_mfma_f32_32x32x16_bf16 v[128:143], v[152:155], v[144:147], v[128:143]
    v_exp_f32 v72, v72
    v_exp_f32 v73, v73
    v_exp_f32 v74, v74
    v_smfmac_f32_32x32x32_bf16 v[96:111], v[32:35], v[64:71], v3
    buffer_load_dwordx4 v[204:207], v2, s[36:39], s51 offen offset:3072
    v_exp_f32 v75, v75
    v_exp_f32 v76, v76
    v_exp_f32 v77, v77
    s_waitcnt vmcnt(9)
    v_mfma_f32_32x32x16_bf16 v[128:143], v[164:167], v[156:159], v[128:143]
    v_exp_f32 v78, v78
    v_exp_f32 v79, v79
    v_exp_f32 v48, v48
    v_exp_f32 v49, v49
    v_smfmac_f32_32x32x32_bf16 v[96:111], v[36:39], v[72:79], v3
    s_mov_b64 exec, s[52:53]
    ds_read_b128 v[32:35], v6 offset:32768
    ds_read_b128 v[36:39], v6 offset:33280
    s_mov_b64 exec, -1
    v_exp_f32 v50, v50
    v_exp_f32 v51, v51
    v_exp_f32 v52, v52
    v_exp_f32 v53, v53
    v_mfma_f32_32x32x16_bf16 v[64:79], v[28:31], v[20:23], 0
    ds_read_b128 v[28:31], v4 offset:33792
    v_exp_f32 v54, v54
    v_exp_f32 v55, v55
    v_exp_f32 v56, v56
    v_exp_f32 v57, v57
    s_waitcnt lgkmcnt(4)
    v_smfmac_f32_32x32x32_bf16 v[80:95], v[40:43], v[48:55], v3
    v_exp_f32 v58, v58
    v_exp_f32 v59, v59
    v_exp_f32 v60, v60
    v_exp_f32 v61, v61
    s_waitcnt vmcnt(6)
    v_mfma_f32_32x32x16_bf16 v[112:127], v[172:175], v[168:171], v[112:127]
    s_add_u32 s56, s56, 4096
    s_add_u32 s57, s57, 4096
    s_add_u32 s58, s56, 147456
    buffer_load_dwordx4 v[144:147], v2, s[36:39], s57 offen offset:0 sc1
    v_exp_f32 v62, v62
    v_exp_f32 v63, v63
    v_exp_f32 v64, v64
    v_exp_f32 v65, v65
    v_smfmac_f32_32x32x32_bf16 v[80:95], v[44:47], v[56:63], v3
    buffer_load_dwordx4 v[148:151], v2, s[36:39], s56 offen offset:0
    v_exp_f32 v66, v66
    v_exp_f32 v67, v67
    v_exp_f32 v68, v68
    v_exp_f32 v69, v69
    s_waitcnt lgkmcnt(3)
    v_mfma_f32_32x32x16_bf16 v[48:63], v[24:27], v[16:19], 0
    buffer_load_dwordx4 v[152:155], v2, s[36:39], s58 offen offset:0
    v_exp_f32 v70, v70
    v_exp_f32 v71, v71
    v_exp_f32 v72, v72
    v_exp_f32 v73, v73
    v_smfmac_f32_32x32x32_bf16 v[96:111], v[40:43], v[64:71], v3
    buffer_load_dwordx4 v[156:159], v2, s[36:39], s57 offen offset:1024 sc1
    v_exp_f32 v74, v74
    v_exp_f32 v75, v75
    v_exp_f32 v76, v76
    v_exp_f32 v77, v77
    s_waitcnt vmcnt(9)
    v_mfma_f32_32x32x16_bf16 v[128:143], v[176:179], v[168:171], v[128:143]
    buffer_load_dwordx4 v[160:163], v2, s[36:39], s56 offen offset:1024
    v_exp_f32 v78, v78
    v_exp_f32 v79, v79
    v_exp_f32 v48, v48
    v_exp_f32 v49, v49
    v_smfmac_f32_32x32x32_bf16 v[96:111], v[44:47], v[72:79], v3
    s_mov_b64 exec, s[52:53]
    ds_read_b128 v[40:43], v6 offset:33792
    ds_read_b128 v[44:47], v6 offset:34304
    s_mov_b64 exec, -1
    buffer_load_dwordx4 v[164:167], v2, s[36:39], s58 offen offset:1024
    v_exp_f32 v50, v50
    v_exp_f32 v51, v51
    v_exp_f32 v52, v52
    v_exp_f32 v53, v53
    v_mfma_f32_32x32x16_bf16 v[64:79], v[24:27], v[20:23], 0
    ds_read_b128 v[24:27], v4 offset:34816
    s_add_u32 s51, s67, 4096
    buffer_load_dwordx4 v[208:211], v2, s[36:39], s51 offen offset:0
    v_exp_f32 v54, v54
    v_exp_f32 v55, v55
    v_exp_f32 v56, v56
    v_exp_f32 v57, v57
    s_waitcnt lgkmcnt(4)
    v_smfmac_f32_32x32x32_bf16 v[80:95], v[32:35], v[48:55], v3
    v_exp_f32 v58, v58
    v_exp_f32 v59, v59
    v_exp_f32 v60, v60
    v_exp_f32 v61, v61
    s_waitcnt vmcnt(9)
    v_mfma_f32_32x32x16_bf16 v[112:127], v[184:187], v[180:183], v[112:127]
    buffer_load_dwordx4 v[168:171], v2, s[36:39], s57 offen offset:2048 sc1
    v_exp_f32 v62, v62
    v_exp_f32 v63, v63
    v_exp_f32 v64, v64
    v_exp_f32 v65, v65
    v_smfmac_f32_32x32x32_bf16 v[80:95], v[36:39], v[56:63], v3
    buffer_load_dwordx4 v[172:175], v2, s[36:39], s56 offen offset:2048
    v_exp_f32 v66, v66
    v_exp_f32 v67, v67
    v_exp_f32 v68, v68
    v_exp_f32 v69, v69
    s_waitcnt lgkmcnt(3)
    v_mfma_f32_32x32x16_bf16 v[48:63], v[28:31], v[16:19], 0
    buffer_load_dwordx4 v[176:179], v2, s[36:39], s58 offen offset:2048
    v_exp_f32 v70, v70
    v_exp_f32 v71, v71
    v_exp_f32 v72, v72
    v_exp_f32 v73, v73
    v_smfmac_f32_32x32x32_bf16 v[96:111], v[32:35], v[64:71], v3
    buffer_load_dwordx4 v[212:215], v2, s[36:39], s51 offen offset:1024
    v_exp_f32 v74, v74
    v_exp_f32 v75, v75
    v_exp_f32 v76, v76
    v_exp_f32 v77, v77
    s_waitcnt vmcnt(12)
    v_mfma_f32_32x32x16_bf16 v[128:143], v[188:191], v[180:183], v[128:143]
    v_exp_f32 v78, v78
    v_exp_f32 v79, v79
    v_exp_f32 v48, v48
    v_exp_f32 v49, v49
    v_smfmac_f32_32x32x32_bf16 v[96:111], v[36:39], v[72:79], v3
    s_mov_b64 exec, s[52:53]
    ds_read_b128 v[32:35], v6 offset:34816
    ds_read_b128 v[36:39], v6 offset:35328
    s_mov_b64 exec, -1
    v_exp_f32 v50, v50
    v_exp_f32 v51, v51
    v_exp_f32 v52, v52
    v_exp_f32 v53, v53
    v_mfma_f32_32x32x16_bf16 v[64:79], v[28:31], v[20:23], 0
    ds_read_b128 v[28:31], v4 offset:35840
    v_exp_f32 v54, v54
    v_exp_f32 v55, v55
    v_exp_f32 v56, v56
    v_exp_f32 v57, v57
    s_waitcnt lgkmcnt(4)
    v_smfmac_f32_32x32x32_bf16 v[80:95], v[40:43], v[48:55], v3
    v_exp_f32 v58, v58
    v_exp_f32 v59, v59
    v_exp_f32 v60, v60
    v_exp_f32 v61, v61
    s_waitcnt vmcnt(9)
    v_mfma_f32_32x32x16_bf16 v[112:127], v[148:151], v[144:147], v[112:127]
    buffer_load_dwordx4 v[180:183], v2, s[36:39], s57 offen offset:3072 sc1
    v_exp_f32 v62, v62
    v_exp_f32 v63, v63
    v_exp_f32 v64, v64
    v_exp_f32 v65, v65
    v_smfmac_f32_32x32x32_bf16 v[80:95], v[44:47], v[56:63], v3
    buffer_load_dwordx4 v[184:187], v2, s[36:39], s56 offen offset:3072
    v_exp_f32 v66, v66
    v_exp_f32 v67, v67
    v_exp_f32 v68, v68
    v_exp_f32 v69, v69
    s_waitcnt lgkmcnt(3)
    v_mfma_f32_32x32x16_bf16 v[48:63], v[24:27], v[16:19], 0
    buffer_load_dwordx4 v[188:191], v2, s[36:39], s58 offen offset:3072
    v_exp_f32 v70, v70
    v_exp_f32 v71, v71
    v_exp_f32 v72, v72
    v_exp_f32 v73, v73
    v_smfmac_f32_32x32x32_bf16 v[96:111], v[40:43], v[64:71], v3
    buffer_load_dwordx4 v[216:219], v2, s[36:39], s51 offen offset:2048
    v_exp_f32 v74, v74
    v_exp_f32 v75, v75
    v_exp_f32 v76, v76
    v_exp_f32 v77, v77
    s_waitcnt vmcnt(12)
    v_mfma_f32_32x32x16_bf16 v[128:143], v[152:155], v[144:147], v[128:143]
    v_exp_f32 v78, v78
    v_exp_f32 v79, v79
    v_exp_f32 v48, v48
    v_exp_f32 v49, v49
    v_smfmac_f32_32x32x32_bf16 v[96:111], v[44:47], v[72:79], v3
    s_mov_b64 exec, s[52:53]
    ds_read_b128 v[40:43], v6 offset:35840
    ds_read_b128 v[44:47], v6 offset:36352
    s_mov_b64 exec, -1
    v_exp_f32 v50, v50
    v_exp_f32 v51, v51
    v_exp_f32 v52, v52
    v_mfma_f32_32x32x16_bf16 v[64:79], v[24:27], v[20:23], 0
    ds_read_b128 v[24:27], v4 offset:36864
    v_exp_f32 v53, v53
    v_exp_f32 v54, v54
    v_exp_f32 v55, v55
    s_waitcnt vmcnt(10)
    v_mfma_f32_32x32x16_bf16 v[112:127], v[160:163], v[156:159], v[112:127]
    v_exp_f32 v56, v56
    v_exp_f32 v57, v57
    v_exp_f32 v58, v58
    s_waitcnt lgkmcnt(4)
    v_smfmac_f32_32x32x32_bf16 v[80:95], v[32:35], v[48:55], v3
    v_exp_f32 v59, v59
    v_exp_f32 v60, v60
    v_exp_f32 v61, v61
    s_waitcnt vmcnt(6)
    v_mfma_f32_32x32x16_bf16 v[112:127], v[172:175], v[168:171], v[112:127]
    s_add_u32 s56, s56, 4096
    s_add_u32 s57, s57, 4096
    s_add_u32 s58, s56, 147456
    buffer_load_dwordx4 v[144:147], v2, s[36:39], s57 offen offset:0 sc1
    v_exp_f32 v62, v62
    v_exp_f32 v63, v63
    v_exp_f32 v64, v64
    v_exp_f32 v65, v65
    v_smfmac_f32_32x32x32_bf16 v[80:95], v[36:39], v[56:63], v3
    buffer_load_dwordx4 v[148:151], v2, s[36:39], s56 offen offset:0
    v_exp_f32 v66, v66
    v_exp_f32 v67, v67
    v_exp_f32 v68, v68
    s_waitcnt lgkmcnt(3)
    v_mfma_f32_32x32x16_bf16 v[48:63], v[28:31], v[16:19], 0
    buffer_load_dwordx4 v[152:155], v2, s[36:39], s58 offen offset:0
    v_exp_f32 v69, v69
    v_exp_f32 v70, v70
    v_exp_f32 v71, v71
    v_mfma_f32_32x32x16_bf16 v[128:143], v[164:167], v[156:159], v[128:143]
    v_exp_f32 v72, v72
    v_exp_f32 v73, v73
    v_exp_f32 v74, v74
    v_smfmac_f32_32x32x32_bf16 v[96:111], v[32:35], v[64:71], v3
    buffer_load_dwordx4 v[220:223], v2, s[36:39], s51 offen offset:3072
    v_exp_f32 v75, v75
    v_exp_f32 v76, v76
    v_exp_f32 v77, v77
    s_waitcnt vmcnt(9)
    v_mfma_f32_32x32x16_bf16 v[128:143], v[176:179], v[168:171], v[128:143]
    v_exp_f32 v78, v78
    v_exp_f32 v79, v79
    v_exp_f32 v48, v48
    v_exp_f32 v49, v49
    v_smfmac_f32_32x32x32_bf16 v[96:111], v[36:39], v[72:79], v3
    s_mov_b64 exec, s[52:53]
    ds_read_b128 v[32:35], v6 offset:36864
    ds_read_b128 v[36:39], v6 offset:37376
    s_mov_b64 exec, -1
    v_exp_f32 v50, v50
    v_exp_f32 v51, v51
    v_exp_f32 v52, v52
    v_exp_f32 v53, v53
    v_mfma_f32_32x32x16_bf16 v[64:79], v[28:31], v[20:23], 0
    ds_read_b128 v[28:31], v4 offset:37888
    v_exp_f32 v54, v54
    v_exp_f32 v55, v55
    v_exp_f32 v56, v56
    v_exp_f32 v57, v57
    s_waitcnt lgkmcnt(4)
    v_smfmac_f32_32x32x32_bf16 v[80:95], v[40:43], v[48:55], v3
    v_exp_f32 v58, v58
    v_exp_f32 v59, v59
    v_exp_f32 v60, v60
    v_exp_f32 v61, v61
    s_waitcnt vmcnt(6)
    v_mfma_f32_32x32x16_bf16 v[112:127], v[184:187], v[180:183], v[112:127]
    buffer_load_dwordx4 v[156:159], v2, s[36:39], s57 offen offset:1024 sc1
    v_exp_f32 v62, v62
    v_exp_f32 v63, v63
    v_exp_f32 v64, v64
    v_exp_f32 v65, v65
    v_smfmac_f32_32x32x32_bf16 v[80:95], v[44:47], v[56:63], v3
    buffer_load_dwordx4 v[160:163], v2, s[36:39], s56 offen offset:1024
    v_exp_f32 v66, v66
    v_exp_f32 v67, v67
    v_exp_f32 v68, v68
    v_exp_f32 v69, v69
    s_waitcnt lgkmcnt(3)
    v_mfma_f32_32x32x16_bf16 v[48:63], v[24:27], v[16:19], 0
    buffer_load_dwordx4 v[164:167], v2, s[36:39], s58 offen offset:1024
    v_exp_f32 v70, v70
    v_exp_f32 v71, v71
    v_exp_f32 v72, v72
    v_exp_f32 v73, v73
    v_smfmac_f32_32x32x32_bf16 v[96:111], v[40:43], v[64:71], v3
    buffer_load_dwordx4 v[168:171], v2, s[36:39], s57 offen offset:2048 sc1
    v_exp_f32 v74, v74
    v_exp_f32 v75, v75
    v_exp_f32 v76, v76
    v_exp_f32 v77, v77
    s_waitcnt vmcnt(9)
    v_mfma_f32_32x32x16_bf16 v[128:143], v[188:191], v[180:183], v[128:143]
    buffer_load_dwordx4 v[172:175], v2, s[36:39], s56 offen offset:2048
    v_exp_f32 v78, v78
    v_exp_f32 v79, v79
    s_setprio 1
    v_exp_f32 v48, v48
    v_exp_f32 v49, v49
    v_smfmac_f32_32x32x32_bf16 v[96:111], v[44:47], v[72:79], v3
    s_mov_b64 exec, s[52:53]
    ds_read_b128 v[40:43], v6 offset:37888
    ds_read_b128 v[44:47], v6 offset:38400
    s_mov_b64 exec, -1
    buffer_load_dwordx4 v[176:179], v2, s[36:39], s58 offen offset:2048
    v_exp_f32 v50, v50
    v_exp_f32 v51, v51
    v_exp_f32 v52, v52
    v_exp_f32 v53, v53
    v_mfma_f32_32x32x16_bf16 v[64:79], v[24:27], v[20:23], 0
    ds_read_b128 v[24:27], v4 offset:38912
    s_add_u32 s51, s67, 147456
    buffer_load_dwordx4 v[224:227], v2, s[36:39], s51 offen offset:0
    v_exp_f32 v54, v54
    v_exp_f32 v55, v55
    v_exp_f32 v56, v56
    v_exp_f32 v57, v57
    s_waitcnt lgkmcnt(4)
    v_smfmac_f32_32x32x32_bf16 v[80:95], v[32:35], v[48:55], v3
    v_exp_f32 v58, v58
    v_exp_f32 v59, v59
    v_exp_f32 v60, v60
    v_exp_f32 v61, v61
    s_waitcnt vmcnt(9)
    v_mfma_f32_32x32x16_bf16 v[112:127], v[148:151], v[144:147], v[112:127]
    buffer_load_dwordx4 v[180:183], v2, s[36:39], s57 offen offset:3072 sc1
    v_exp_f32 v62, v62
    v_exp_f32 v63, v63
    v_exp_f32 v64, v64
    v_exp_f32 v65, v65
    v_smfmac_f32_32x32x32_bf16 v[80:95], v[36:39], v[56:63], v3
    buffer_load_dwordx4 v[184:187], v2, s[36:39], s56 offen offset:3072
    v_exp_f32 v66, v66
    v_exp_f32 v67, v67
    v_exp_f32 v68, v68
    v_exp_f32 v69, v69
    s_waitcnt lgkmcnt(3)
    v_mfma_f32_32x32x16_bf16 v[48:63], v[28:31], v[16:19], 0
    buffer_load_dwordx4 v[188:191], v2, s[36:39], s58 offen offset:3072
    v_exp_f32 v70, v70
    v_exp_f32 v71, v71
    v_exp_f32 v72, v72
    v_exp_f32 v73, v73
    v_smfmac_f32_32x32x32_bf16 v[96:111], v[32:35], v[64:71], v3
    buffer_load_dwordx4 v[228:231], v2, s[36:39], s51 offen offset:1024
    v_exp_f32 v74, v74
    v_exp_f32 v75, v75
    v_exp_f32 v76, v76
    v_exp_f32 v77, v77
    s_waitcnt vmcnt(12)
    v_mfma_f32_32x32x16_bf16 v[128:143], v[152:155], v[144:147], v[128:143]
    v_exp_f32 v78, v78
    v_exp_f32 v79, v79
    v_exp_f32 v48, v48
    v_exp_f32 v49, v49
    v_smfmac_f32_32x32x32_bf16 v[96:111], v[36:39], v[72:79], v3
    s_mov_b64 exec, s[52:53]
    ds_read_b128 v[32:35], v6 offset:38912
    ds_read_b128 v[36:39], v6 offset:39424
    s_mov_b64 exec, -1
    v_exp_f32 v50, v50
    v_exp_f32 v51, v51
    v_exp_f32 v52, v52
    v_exp_f32 v53, v53
    v_mfma_f32_32x32x16_bf16 v[64:79], v[28:31], v[20:23], 0
    ds_read_b128 v[28:31], v4 offset:39936
    v_exp_f32 v54, v54
    v_exp_f32 v55, v55
    v_exp_f32 v56, v56
    v_exp_f32 v57, v57
    s_waitcnt lgkmcnt(4)
    v_smfmac_f32_32x32x32_bf16 v[80:95], v[40:43], v[48:55], v3
    v_exp_f32 v58, v58
    v_exp_f32 v59, v59
    v_exp_f32 v60, v60
    v_exp_f32 v61, v61
    s_waitcnt vmcnt(9)
    v_mfma_f32_32x32x16_bf16 v[112:127], v[160:163], v[156:159], v[112:127]
    s_add_u32 s56, s56, 4096
    s_add_u32 s57, s57, 4096
    s_add_u32 s58, s56, 147456
    buffer_load_dwordx4 v[144:147], v2, s[36:39], s57 offen offset:0 sc1
    v_exp_f32 v62, v62
    v_exp_f32 v63, v63
    v_exp_f32 v64, v64
    v_exp_f32 v65, v65
    v_smfmac_f32_32x32x32_bf16 v[80:95], v[44:47], v[56:63], v3
    buffer_load_dwordx4 v[148:151], v2, s[36:39], s56 offen offset:0
    v_exp_f32 v66, v66
    v_exp_f32 v67, v67
    v_exp_f32 v68, v68
    v_exp_f32 v69, v69
    s_waitcnt lgkmcnt(3)
    v_mfma_f32_32x32x16_bf16 v[48:63], v[24:27], v[16:19], 0
    buffer_load_dwordx4 v[152:155], v2, s[36:39], s58 offen offset:0
    v_exp_f32 v70, v70
    v_exp_f32 v71, v71
    v_exp_f32 v72, v72
    v_exp_f32 v73, v73
    v_smfmac_f32_32x32x32_bf16 v[96:111], v[40:43], v[64:71], v3
    buffer_load_dwordx4 v[232:235], v2, s[36:39], s51 offen offset:2048
    v_exp_f32 v74, v74
    v_exp_f32 v75, v75
    v_exp_f32 v76, v76
    v_exp_f32 v77, v77
    s_waitcnt vmcnt(12)
    v_mfma_f32_32x32x16_bf16 v[128:143], v[164:167], v[156:159], v[128:143]
    v_exp_f32 v78, v78
    v_exp_f32 v79, v79
    v_exp_f32 v48, v48
    v_exp_f32 v49, v49
    v_smfmac_f32_32x32x32_bf16 v[96:111], v[44:47], v[72:79], v3
    s_mov_b64 exec, s[52:53]
    ds_read_b128 v[40:43], v6 offset:39936
    ds_read_b128 v[44:47], v6 offset:40448
    s_mov_b64 exec, -1
    v_exp_f32 v50, v50
    v_exp_f32 v51, v51
    v_exp_f32 v52, v52
    v_mfma_f32_32x32x16_bf16 v[64:79], v[24:27], v[20:23], 0
    ds_read_b128 v[24:27], v5 offset:0
    v_exp_f32 v53, v53
    v_exp_f32 v54, v54
    v_exp_f32 v55, v55
    s_waitcnt vmcnt(10)
    v_mfma_f32_32x32x16_bf16 v[112:127], v[172:175], v[168:171], v[112:127]
    v_exp_f32 v56, v56
    v_exp_f32 v57, v57
    v_exp_f32 v58, v58
    s_waitcnt lgkmcnt(4)
    v_smfmac_f32_32x32x32_bf16 v[80:95], v[32:35], v[48:55], v3
    v_exp_f32 v59, v59
    v_exp_f32 v60, v60
    v_exp_f32 v61, v61
    s_waitcnt vmcnt(6)
    v_mfma_f32_32x32x16_bf16 v[112:127], v[184:187], v[180:183], v[112:127]
    buffer_load_dwordx4 v[156:159], v2, s[36:39], s57 offen offset:1024 sc1
    v_exp_f32 v62, v62
    v_exp_f32 v63, v63
    v_exp_f32 v64, v64
    v_exp_f32 v65, v65
    v_smfmac_f32_32x32x32_bf16 v[80:95], v[36:39], v[56:63], v3
    buffer_load_dwordx4 v[160:163], v2, s[36:39], s56 offen offset:1024
    v_exp_f32 v66, v66
    v_exp_f32 v67, v67
    v_exp_f32 v68, v68
    s_waitcnt lgkmcnt(3)
    v_mfma_f32_32x32x16_bf16 v[48:63], v[28:31], v[16:19], 0
    buffer_load_dwordx4 v[164:167], v2, s[36:39], s58 offen offset:1024
    v_exp_f32 v69, v69
    v_exp_f32 v70, v70
    v_exp_f32 v71, v71
    v_mfma_f32_32x32x16_bf16 v[128:143], v[176:179], v[168:171], v[128:143]
    v_exp_f32 v72, v72
    v_exp_f32 v73, v73
    v_exp_f32 v74, v74
    v_smfmac_f32_32x32x32_bf16 v[96:111], v[32:35], v[64:71], v3
    buffer_load_dwordx4 v[236:239], v2, s[36:39], s51 offen offset:3072
    v_exp_f32 v75, v75
    v_exp_f32 v76, v76
    v_exp_f32 v77, v77
    s_waitcnt vmcnt(9)
    v_mfma_f32_32x32x16_bf16 v[128:143], v[188:191], v[180:183], v[128:143]
    v_exp_f32 v78, v78
    v_exp_f32 v79, v79
    v_exp_f32 v48, v48
    v_exp_f32 v49, v49
    v_smfmac_f32_32x32x32_bf16 v[96:111], v[36:39], v[72:79], v3
    s_mov_b64 exec, s[52:53]
    ds_read_b128 v[32:35], v7 offset:0
    ds_read_b128 v[36:39], v7 offset:512
    s_mov_b64 exec, -1
    v_exp_f32 v50, v50
    v_exp_f32 v51, v51
    v_exp_f32 v52, v52
    v_exp_f32 v53, v53
    v_mfma_f32_32x32x16_bf16 v[64:79], v[28:31], v[20:23], 0
    ds_read_b128 v[28:31], v5 offset:1024
    v_exp_f32 v54, v54
    v_exp_f32 v55, v55
    v_exp_f32 v56, v56
    v_exp_f32 v57, v57
    s_waitcnt lgkmcnt(4)
    v_smfmac_f32_32x32x32_bf16 v[80:95], v[40:43], v[48:55], v3
    v_exp_f32 v58, v58
    v_exp_f32 v59, v59
    v_exp_f32 v60, v60
    v_exp_f32 v61, v61
    s_waitcnt vmcnt(6)
    v_mfma_f32_32x32x16_bf16 v[112:127], v[148:151], v[144:147], v[112:127]
    buffer_load_dwordx4 v[168:171], v2, s[36:39], s57 offen offset:2048 sc1
    v_exp_f32 v62, v62
    v_exp_f32 v63, v63
    v_exp_f32 v64, v64
    v_exp_f32 v65, v65
    v_smfmac_f32_32x32x32_bf16 v[80:95], v[44:47], v[56:63], v3
    buffer_load_dwordx4 v[172:175], v2, s[36:39], s56 offen offset:2048
    v_exp_f32 v66, v66
    v_exp_f32 v67, v67
    v_exp_f32 v68, v68
    v_exp_f32 v69, v69
    s_waitcnt lgkmcnt(3)
    v_mfma_f32_32x32x16_bf16 v[48:63], v[24:27], v[16:19], 0
    buffer_load_dwordx4 v[176:179], v2, s[36:39], s58 offen offset:2048
    v_exp_f32 v70, v70
    v_exp_f32 v71, v71
    v_exp_f32 v72, v72
    v_exp_f32 v73, v73
    v_smfmac_f32_32x32x32_bf16 v[96:111], v[40:43], v[64:71], v3
    buffer_load_dwordx4 v[180:183], v2, s[36:39], s57 offen offset:3072 sc1
    v_exp_f32 v74, v74
    v_exp_f32 v75, v75
    v_exp_f32 v76, v76
    v_exp_f32 v77, v77
    s_waitcnt vmcnt(9)
    v_mfma_f32_32x32x16_bf16 v[128:143], v[152:155], v[144:147], v[128:143]
    buffer_load_dwordx4 v[184:187], v2, s[36:39], s56 offen offset:3072
    v_exp_f32 v78, v78
    v_exp_f32 v79, v79
    v_exp_f32 v48, v48
    v_exp_f32 v49, v49
    v_smfmac_f32_32x32x32_bf16 v[96:111], v[44:47], v[72:79], v3
    s_mov_b64 exec, s[52:53]
    ds_read_b128 v[40:43], v7 offset:1024
    ds_read_b128 v[44:47], v7 offset:1536
    s_mov_b64 exec, -1
    buffer_load_dwordx4 v[188:191], v2, s[36:39], s58 offen offset:3072
    v_exp_f32 v50, v50
    v_exp_f32 v51, v51
    v_exp_f32 v52, v52
    v_exp_f32 v53, v53
    v_mfma_f32_32x32x16_bf16 v[64:79], v[24:27], v[20:23], 0
    ds_read_b128 v[24:27], v5 offset:2048
    s_add_u32 s51, s67, 151552
    buffer_load_dwordx4 v[240:243], v2, s[36:39], s51 offen offset:0
    v_exp_f32 v54, v54
    v_exp_f32 v55, v55
    v_exp_f32 v56, v56
    v_exp_f32 v57, v57
    s_waitcnt lgkmcnt(4)
    v_smfmac_f32_32x32x32_bf16 v[80:95], v[32:35], v[48:55], v3
    v_exp_f32 v58, v58
    v_exp_f32 v59, v59
    v_exp_f32 v60, v60
    v_exp_f32 v61, v61
    s_waitcnt vmcnt(9)
    v_mfma_f32_32x32x16_bf16 v[112:127], v[160:163], v[156:159], v[112:127]
    s_add_u32 s56, s56, 4096
    s_add_u32 s57, s57, 4096
    s_add_u32 s58, s56, 147456
    buffer_load_dwordx4 v[144:147], v2, s[36:39], s57 offen offset:0 sc1
    v_exp_f32 v62, v62
    v_exp_f32 v63, v63
    v_exp_f32 v64, v64
    v_exp_f32 v65, v65
    v_smfmac_f32_32x32x32_bf16 v[80:95], v[36:39], v[56:63], v3
    buffer_load_dwordx4 v[148:151], v2, s[36:39], s56 offen offset:0
    v_exp_f32 v66, v66
    v_exp_f32 v67, v67
    v_exp_f32 v68, v68
    v_exp_f32 v69, v69
    s_waitcnt lgkmcnt(3)
    v_mfma_f32_32x32x16_bf16 v[48:63], v[28:31], v[16:19], 0
    buffer_load_dwordx4 v[152:155], v2, s[36:39], s58 offen offset:0
    v_exp_f32 v70, v70
    v_exp_f32 v71, v71
    v_exp_f32 v72, v72
    v_exp_f32 v73, v73
    v_smfmac_f32_32x32x32_bf16 v[96:111], v[32:35], v[64:71], v3
    buffer_load_dwordx4 v[244:247], v2, s[36:39], s51 offen offset:1024
    v_exp_f32 v74, v74
    v_exp_f32 v75, v75
    v_exp_f32 v76, v76
    v_exp_f32 v77, v77
    s_waitcnt vmcnt(12)
    v_mfma_f32_32x32x16_bf16 v[128:143], v[164:167], v[156:159], v[128:143]
    v_exp_f32 v78, v78
    v_exp_f32 v79, v79
    v_exp_f32 v48, v48
    v_exp_f32 v49, v49
    v_smfmac_f32_32x32x32_bf16 v[96:111], v[36:39], v[72:79], v3
    s_mov_b64 exec, s[52:53]
    ds_read_b128 v[32:35], v7 offset:2048
    ds_read_b128 v[36:39], v7 offset:2560
    s_mov_b64 exec, -1
    v_exp_f32 v50, v50
    v_exp_f32 v51, v51
    v_exp_f32 v52, v52
    v_exp_f32 v53, v53
    v_mfma_f32_32x32x16_bf16 v[64:79], v[28:31], v[20:23], 0
    ds_read_b128 v[28:31], v5 offset:3072
    v_exp_f32 v54, v54
    v_exp_f32 v55, v55
    v_exp_f32 v56, v56
    v_exp_f32 v57, v57
    s_waitcnt lgkmcnt(4)
    v_smfmac_f32_32x32x32_bf16 v[80:95], v[40:43], v[48:55], v3
    v_exp_f32 v58, v58
    v_exp_f32 v59, v59
    v_exp_f32 v60, v60
    v_exp_f32 v61, v61
    s_waitcnt vmcnt(9)
    v_mfma_f32_32x32x16_bf16 v[112:127], v[172:175], v[168:171], v[112:127]
    buffer_load_dwordx4 v[156:159], v2, s[36:39], s57 offen offset:1024 sc1
    v_exp_f32 v62, v62
    v_exp_f32 v63, v63
    v_exp_f32 v64, v64
    v_exp_f32 v65, v65
    v_smfmac_f32_32x32x32_bf16 v[80:95], v[44:47], v[56:63], v3
    buffer_load_dwordx4 v[160:163], v2, s[36:39], s56 offen offset:1024
    v_exp_f32 v66, v66
    v_exp_f32 v67, v67
    v_exp_f32 v68, v68
    v_exp_f32 v69, v69
    s_waitcnt lgkmcnt(3)
    v_mfma_f32_32x32x16_bf16 v[48:63], v[24:27], v[16:19], 0
    buffer_load_dwordx4 v[164:167], v2, s[36:39], s58 offen offset:1024
    v_exp_f32 v70, v70
    v_exp_f32 v71, v71
    v_exp_f32 v72, v72
    v_exp_f32 v73, v73
    v_smfmac_f32_32x32x32_bf16 v[96:111], v[40:43], v[64:71], v3
    buffer_load_dwordx4 v[248:251], v2, s[36:39], s51 offen offset:2048
    v_exp_f32 v74, v74
    v_exp_f32 v75, v75
    v_exp_f32 v76, v76
    v_exp_f32 v77, v77
    s_waitcnt vmcnt(12)
    v_mfma_f32_32x32x16_bf16 v[128:143], v[176:179], v[168:171], v[128:143]
    v_exp_f32 v78, v78
    v_exp_f32 v79, v79
    v_exp_f32 v48, v48
    v_exp_f32 v49, v49
    v_smfmac_f32_32x32x32_bf16 v[96:111], v[44:47], v[72:79], v3
    s_mov_b64 exec, s[52:53]
    ds_read_b128 v[40:43], v7 offset:3072
    ds_read_b128 v[44:47], v7 offset:3584
    s_mov_b64 exec, -1
    v_exp_f32 v50, v50
    v_exp_f32 v51, v51
    v_exp_f32 v52, v52
    v_mfma_f32_32x32x16_bf16 v[64:79], v[24:27], v[20:23], 0
    ds_read_b128 v[24:27], v5 offset:4096
    v_exp_f32 v53, v53
    v_exp_f32 v54, v54
    v_exp_f32 v55, v55
    s_waitcnt vmcnt(10)
    v_mfma_f32_32x32x16_bf16 v[112:127], v[184:187], v[180:183], v[112:127]
    v_exp_f32 v56, v56
    v_exp_f32 v57, v57
    v_exp_f32 v58, v58
    s_waitcnt lgkmcnt(4)
    v_smfmac_f32_32x32x32_bf16 v[80:95], v[32:35], v[48:55], v3
    v_exp_f32 v59, v59
    v_exp_f32 v60, v60
    v_exp_f32 v61, v61
    s_waitcnt vmcnt(6)
    v_mfma_f32_32x32x16_bf16 v[112:127], v[148:151], v[144:147], v[112:127]
    buffer_load_dwordx4 v[168:171], v2, s[36:39], s57 offen offset:2048 sc1
    v_exp_f32 v62, v62
    v_exp_f32 v63, v63
    v_exp_f32 v64, v64
    v_exp_f32 v65, v65
    v_smfmac_f32_32x32x32_bf16 v[80:95], v[36:39], v[56:63], v3
    buffer_load_dwordx4 v[172:175], v2, s[36:39], s56 offen offset:2048
    v_exp_f32 v66, v66
    v_exp_f32 v67, v67
    v_exp_f32 v68, v68
    s_waitcnt lgkmcnt(3)
    v_mfma_f32_32x32x16_bf16 v[48:63], v[28:31], v[16:19], 0
    buffer_load_dwordx4 v[176:179], v2, s[36:39], s58 offen offset:2048
    v_exp_f32 v69, v69
    v_exp_f32 v70, v70
    v_exp_f32 v71, v71
    v_mfma_f32_32x32x16_bf16 v[128:143], v[188:191], v[180:183], v[128:143]
    v_exp_f32 v72, v72
    v_exp_f32 v73, v73
    v_exp_f32 v74, v74
    v_smfmac_f32_32x32x32_bf16 v[96:111], v[32:35], v[64:71], v3
    buffer_load_dwordx4 v[252:255], v2, s[36:39], s51 offen offset:3072
    v_exp_f32 v75, v75
    v_exp_f32 v76, v76
    v_exp_f32 v77, v77
    s_waitcnt vmcnt(9)
    v_mfma_f32_32x32x16_bf16 v[128:143], v[152:155], v[144:147], v[128:143]
    v_exp_f32 v78, v78
    v_exp_f32 v79, v79
    v_exp_f32 v48, v48
    v_exp_f32 v49, v49
    v_smfmac_f32_32x32x32_bf16 v[96:111], v[36:39], v[72:79], v3
    s_mov_b64 exec, s[52:53]
    ds_read_b128 v[32:35], v7 offset:4096
    ds_read_b128 v[36:39], v7 offset:4608
    s_mov_b64 exec, -1
    v_exp_f32 v50, v50
    v_exp_f32 v51, v51
    v_exp_f32 v52, v52
    v_exp_f32 v53, v53
    v_mfma_f32_32x32x16_bf16 v[64:79], v[28:31], v[20:23], 0
    ds_read_b128 v[28:31], v5 offset:5120
    v_exp_f32 v54, v54
    v_exp_f32 v55, v55
    v_exp_f32 v56, v56
    v_exp_f32 v57, v57
    s_waitcnt lgkmcnt(4)
    v_smfmac_f32_32x32x32_bf16 v[80:95], v[40:43], v[48:55], v3
    v_exp_f32 v58, v58
    v_exp_f32 v59, v59
    v_exp_f32 v60, v60
    v_exp_f32 v61, v61
    s_waitcnt vmcnt(6)
    v_mfma_f32_32x32x16_bf16 v[112:127], v[160:163], v[156:159], v[112:127]
    buffer_load_dwordx4 v[180:183], v2, s[36:39], s57 offen offset:3072 sc1
    v_exp_f32 v62, v62
    v_exp_f32 v63, v63
    v_exp_f32 v64, v64
    v_exp_f32 v65, v65
    v_smfmac_f32_32x32x32_bf16 v[80:95], v[44:47], v[56:63], v3
    buffer_load_dwordx4 v[184:187], v2, s[36:39], s56 offen offset:3072
    v_exp_f32 v66, v66
    v_exp_f32 v67, v67
    v_exp_f32 v68, v68
    v_exp_f32 v69, v69
    s_waitcnt lgkmcnt(3)
    v_mfma_f32_32x32x16_bf16 v[48:63], v[24:27], v[16:19], 0
    buffer_load_dwordx4 v[188:191], v2, s[36:39], s58 offen offset:3072
    v_exp_f32 v70, v70
    v_exp_f32 v71, v71
    v_exp_f32 v72, v72
    v_exp_f32 v73, v73
    v_smfmac_f32_32x32x32_bf16 v[96:111], v[40:43], v[64:71], v3
    s_add_u32 s56, s56, 4096
    s_add_u32 s57, s57, 4096
    s_add_u32 s58, s56, 147456
    buffer_load_dwordx4 v[144:147], v2, s[36:39], s57 offen offset:0 sc1
    v_exp_f32 v74, v74
    v_exp_f32 v75, v75
    v_exp_f32 v76, v76
    v_exp_f32 v77, v77
    s_waitcnt vmcnt(9)
    v_mfma_f32_32x32x16_bf16 v[128:143], v[164:167], v[156:159], v[128:143]
    buffer_load_dwordx4 v[148:151], v2, s[36:39], s56 offen offset:0
    v_exp_f32 v78, v78
    v_exp_f32 v79, v79
    v_exp_f32 v48, v48
    v_exp_f32 v49, v49
    v_smfmac_f32_32x32x32_bf16 v[96:111], v[44:47], v[72:79], v3
    s_mov_b64 exec, s[52:53]
    ds_read_b128 v[40:43], v7 offset:5120
    ds_read_b128 v[44:47], v7 offset:5632
    s_mov_b64 exec, -1
    buffer_load_dwordx4 v[152:155], v2, s[36:39], s58 offen offset:0
    v_exp_f32 v50, v50
    v_exp_f32 v51, v51
    v_exp_f32 v52, v52
    v_exp_f32 v53, v53
    v_mfma_f32_32x32x16_bf16 v[64:79], v[24:27], v[20:23], 0
    ds_read_b128 v[24:27], v5 offset:6144
    v_exp_f32 v54, v54
    v_exp_f32 v55, v55
    v_exp_f32 v56, v56
    v_exp_f32 v57, v57
    s_waitcnt lgkmcnt(4)
    v_smfmac_f32_32x32x32_bf16 v[80:95], v[32:35], v[48:55], v3
    v_exp_f32 v58, v58
    v_exp_f32 v59, v59
    v_exp_f32 v60, v60
    v_exp_f32 v61, v61
    s_waitcnt vmcnt(8)
    v_mfma_f32_32x32x16_bf16 v[112:127], v[172:175], v[168:171], v[112:127]
    buffer_load_dwordx4 v[156:159], v2, s[36:39], s57 offen offset:1024 sc1
    v_exp_f32 v62, v62
    v_exp_f32 v63, v63
    v_exp_f32 v64, v64
    v_exp_f32 v65, v65
    v_smfmac_f32_32x32x32_bf16 v[80:95], v[36:39], v[56:63], v3
    buffer_load_dwordx4 v[160:163], v2, s[36:39], s56 offen offset:1024
    v_exp_f32 v66, v66
    v_exp_f32 v67, v67
    v_exp_f32 v68, v68
    v_exp_f32 v69, v69
    s_waitcnt lgkmcnt(3)
    v_mfma_f32_32x32x16_bf16 v[48:63], v[28:31], v[16:19], 0
    buffer_load_dwordx4 v[164:167], v2, s[36:39], s58 offen offset:1024
    v_exp_f32 v70, v70
    v_exp_f32 v71, v71
    v_exp_f32 v72, v72
    v_exp_f32 v73, v73
    v_smfmac_f32_32x32x32_bf16 v[96:111], v[32:35], v[64:71], v3
    v_exp_f32 v74, v74
    v_exp_f32 v75, v75
    v_exp_f32 v76, v76
    v_exp_f32 v77, v77
    s_waitcnt vmcnt(10)
    v_mfma_f32_32x32x16_bf16 v[128:143], v[176:179], v[168:171], v[128:143]
    v_exp_f32 v78, v78
    v_exp_f32 v79, v79
    s_setprio 0
    v_exp_f32 v48, v48
    v_exp_f32 v49, v49
    v_smfmac_f32_32x32x32_bf16 v[96:111], v[36:39], v[72:79], v3
    s_mov_b64 exec, s[52:53]
    ds_read_b128 v[32:35], v7 offset:6144
    ds_read_b128 v[36:39], v7 offset:6656
    s_mov_b64 exec, -1
    v_exp_f32 v50, v50
    v_exp_f32 v51, v51
    v_exp_f32 v52, v52
    v_exp_f32 v53, v53
    v_mfma_f32_32x32x16_bf16 v[64:79], v[28:31], v[20:23], 0
    ds_read_b128 v[28:31], v5 offset:7168
    v_exp_f32 v54, v54
    v_exp_f32 v55, v55
    v_exp_f32 v56, v56
    v_exp_f32 v57, v57
    s_waitcnt lgkmcnt(4)
    v_smfmac_f32_32x32x32_bf16 v[80:95], v[40:43], v[48:55], v3
    v_exp_f32 v58, v58
    v_exp_f32 v59, v59
    v_exp_f32 v60, v60
    v_exp_f32 v61, v61
    s_waitcnt vmcnt(7)
    v_mfma_f32_32x32x16_bf16 v[112:127], v[184:187], v[180:183], v[112:127]
    buffer_load_dwordx4 v[168:171], v2, s[36:39], s57 offen offset:2048 sc1
    v_exp_f32 v62, v62
    v_exp_f32 v63, v63
    v_exp_f32 v64, v64
    v_exp_f32 v65, v65
    v_smfmac_f32_32x32x32_bf16 v[80:95], v[44:47], v[56:63], v3
    buffer_load_dwordx4 v[172:175], v2, s[36:39], s56 offen offset:2048
    v_exp_f32 v66, v66
    v_exp_f32 v67, v67
    v_exp_f32 v68, v68
    v_exp_f32 v69, v69
    s_waitcnt lgkmcnt(3)
    v_mfma_f32_32x32x16_bf16 v[48:63], v[24:27], v[16:19], 0
    buffer_load_dwordx4 v[176:179], v2, s[36:39], s58 offen offset:2048
    v_exp_f32 v70, v70
    v_exp_f32 v71, v71
    v_exp_f32 v72, v72
    v_exp_f32 v73, v73
    v_smfmac_f32_32x32x32_bf16 v[96:111], v[40:43], v[64:71], v3
    v_exp_f32 v74, v74
    v_exp_f32 v75, v75
    v_exp_f32 v76, v76
    v_exp_f32 v77, v77
    s_waitcnt vmcnt(9)
    v_mfma_f32_32x32x16_bf16 v[128:143], v[188:191], v[180:183], v[128:143]
    v_exp_f32 v78, v78
    v_exp_f32 v79, v79
    v_exp_f32 v48, v48
    v_exp_f32 v49, v49
    v_smfmac_f32_32x32x32_bf16 v[96:111], v[44:47], v[72:79], v3
    s_mov_b64 exec, s[52:53]
    ds_read_b128 v[40:43], v7 offset:7168
    ds_read_b128 v[44:47], v7 offset:7680
    s_mov_b64 exec, -1
    v_exp_f32 v50, v50
    v_exp_f32 v51, v51
    v_exp_f32 v52, v52
    v_exp_f32 v53, v53
    v_mfma_f32_32x32x16_bf16 v[64:79], v[24:27], v[20:23], 0
    v_exp_f32 v54, v54
    v_exp_f32 v55, v55
    v_exp_f32 v56, v56
    v_exp_f32 v57, v57
    s_waitcnt lgkmcnt(3)
    v_smfmac_f32_32x32x32_bf16 v[80:95], v[32:35], v[48:55], v3
    v_exp_f32 v58, v58
    v_exp_f32 v59, v59
    v_exp_f32 v60, v60
    v_exp_f32 v61, v61
    buffer_load_dwordx4 v[180:183], v2, s[36:39], s57 offen offset:3072 sc1
    v_exp_f32 v62, v62
    v_exp_f32 v63, v63
    v_exp_f32 v64, v64
    v_exp_f32 v65, v65
    v_smfmac_f32_32x32x32_bf16 v[80:95], v[36:39], v[56:63], v3
    buffer_load_dwordx4 v[184:187], v2, s[36:39], s56 offen offset:3072
    v_exp_f32 v66, v66
    v_exp_f32 v67, v67
    v_exp_f32 v68, v68
    v_exp_f32 v69, v69
    s_waitcnt lgkmcnt(2)
    v_mfma_f32_32x32x16_bf16 v[48:63], v[28:31], v[16:19], 0
    buffer_load_dwordx4 v[188:191], v2, s[36:39], s58 offen offset:3072
    v_exp_f32 v70, v70
    v_exp_f32 v71, v71
    v_exp_f32 v72, v72
    v_exp_f32 v73, v73
    v_smfmac_f32_32x32x32_bf16 v[96:111], v[32:35], v[64:71], v3
    v_exp_f32 v74, v74
    v_exp_f32 v75, v75
    v_exp_f32 v76, v76
    v_exp_f32 v77, v77
    v_exp_f32 v78, v78
    v_exp_f32 v79, v79
    v_exp_f32 v48, v48
    v_exp_f32 v49, v49
    v_smfmac_f32_32x32x32_bf16 v[96:111], v[36:39], v[72:79], v3
    v_exp_f32 v50, v50
    v_exp_f32 v51, v51
    v_exp_f32 v52, v52
    v_exp_f32 v53, v53
    v_mfma_f32_32x32x16_bf16 v[64:79], v[28:31], v[20:23], 0
    v_exp_f32 v54, v54
    v_exp_f32 v55, v55
    v_exp_f32 v56, v56
    v_exp_f32 v57, v57
    s_waitcnt lgkmcnt(0)
    v_smfmac_f32_32x32x32_bf16 v[80:95], v[40:43], v[48:55], v3
    v_exp_f32 v58, v58
    v_exp_f32 v59, v59
    v_exp_f32 v60, v60
    v_exp_f32 v61, v61
    v_exp_f32 v62, v62
    v_exp_f32 v63, v63
    v_exp_f32 v64, v64
    v_exp_f32 v65, v65
    v_smfmac_f32_32x32x32_bf16 v[80:95], v[44:47], v[56:63], v3
    v_exp_f32 v66, v66
    v_exp_f32 v67, v67
    v_exp_f32 v68, v68
    v_exp_f32 v69, v69
    v_exp_f32 v70, v70
    v_exp_f32 v71, v71
    v_exp_f32 v72, v72
    v_exp_f32 v73, v73
    v_smfmac_f32_32x32x32_bf16 v[96:111], v[40:43], v[64:71], v3
    v_exp_f32 v74, v74
    v_exp_f32 v75, v75
    v_exp_f32 v76, v76
    v_exp_f32 v77, v77
    v_exp_f32 v78, v78
    v_exp_f32 v79, v79
    s_nop 1
    v_smfmac_f32_32x32x32_bf16 v[96:111], v[44:47], v[72:79], v3
    s_cmp_eq_u32 s44, 0
    s_cbranch_scc1 L_k2_lo
    s_nop 12
    ds_write_b128 v8, v[80:83] offset:0
    ds_write_b128 v8, v[84:87] offset:1024
    ds_write_b128 v8, v[88:91] offset:2048
    s_nop 2
    v_mov_b32 v80, v96
    v_mov_b32 v81, v97
    v_mov_b32 v82, v98
    v_mov_b32 v83, v99
    v_mov_b32 v84, v100
    v_mov_b32 v85, v101
    v_mov_b32 v86, v102
    v_mov_b32 v87, v103
    v_mov_b32 v88, v104
    v_mov_b32 v16, v20
    v_mov_b32 v17, v21
    v_mov_b32 v18, v22
    v_mov_b32 v19, v23
    v_add_u32 v8, 3072, v8
    s_add_u32 s54, s54, 147456
    s_add_u32 s70, s70, 4096
    s_branch L_k2_cmb
L_k2_lo:
    s_nop 12
    ds_write_b128 v8, v[96:99] offset:3072
    ds_write_b128 v8, v[100:103] offset:4096
    ds_write_b128 v8, v[104:107] offset:5120
L_k2_cmb:
    s_waitcnt lgkmcnt(0)
    s_barrier
    ds_read_b128 v[48:51], v8 offset:0
    ds_read_b128 v[52:55], v8 offset:1024
    ds_read_b128 v[56:59], v8 offset:2048
    v_mov_b32 v11, 0x21800000
    v_mov_b32 v12, 0x5d800000
    s_waitcnt lgkmcnt(0)
    v_add_f32 v80, v80, v48
    v_add_f32 v81, v81, v49
    v_add_f32 v82, v82, v50
    v_add_f32 v83, v83, v51
    v_add_f32 v84, v84, v52
    v_add_f32 v85, v85, v53
    v_add_f32 v86, v86, v54
    v_add_f32 v87, v87, v55
    v_add_f32 v88, v88, v56
    v_rcp_f32 v10, v88
    v_cmp_nge_f32 s[48:49], v88, v11
    v_cmp_nle_f32 s[50:51], v88, v12
    s_nop 0
    s_or_b64 s[48:49], s[48:49], s[50:51]
    v_max3_f32 v11, |v80|, |v81|, |v82|
    v_max3_f32 v12, |v83|, |v84|, |v85|
    v_max3_f32 v11, |v86|, |v87|, v11
    v_max_f32 v11, v11, v12
    v_add_f32 v13, v81, v80
    v_add_f32 v13, v82, v13
    v_add_f32 v13, v83, v13
    v_add_f32 v13, v84, v13
    v_add_f32 v13, v85, v13
    v_add_f32 v13, v86, v13
    v_add_f32 v13, v87, v13
    v_mov_b32 v12, 0x7f61b1e6
    v_cmp_nle_f32 s[50:51], v11, v12
    s_nop 0
    s_or_b64 s[48:49], s[48:49], s[50:51]
    v_cmp_u_f32 s[50:51], v13, v13
    s_nop 0
    s_or_b64 s[48:49], s[48:49], s[50:51]
    s_cmp_lg_u64 s[48:49], 0
    s_cbranch_scc1 L_k2_slow
L_k2_fin:
    s_nop 1
    v_mul_f32 v80, v80, v10
    v_mul_f32 v81, v81, v10
    v_mul_f32 v82, v82, v10
    v_mul_f32 v83, v83, v10
    v_mul_f32 v84, v84, v10
    v_mul_f32 v85, v85, v10
    v_mul_f32 v86, v86, v10
    v_mul_f32 v87, v87, v10
    v_cvt_pk_bf16_f32 v48, v80, v81
    v_cvt_pk_bf16_f32 v49, v82, v83
    v_cvt_pk_bf16_f32 v50, v84, v85
    v_cvt_pk_bf16_f32 v51, v86, v87
    buffer_store_dwordx4 v[48:51], v2, s[36:39], s54 offen sc1
    v_lshrrev_b32 v10, 3, v1
    v_and_b32 v11, 7, v1
    v_lshlrev_b32 v12, 4, v11
    v_lshl_add_u32 v9, v10, 10, v12
    s_lshl_b32 s48, s26, 13
    v_add_u32 v6, s48, v2
    v_lshlrev_b32 v13, 10, v11
    v_lshl_add_u32 v13, v10, 4, v13
    s_lshl_b32 s48, s44, 13
    s_lshl_b32 s49, s27, 7
    s_add_u32 s48, s48, s49
    v_add_u32 v8, s48, v13
    v_lshlrev_b32 v13, 5, v11
    v_xor_b32 v8, v13, v8
    v_lshlrev_b32 v10, 2, v1
    v_mov_b32 v11, s100
    s_waitcnt vmcnt(0) lgkmcnt(0)
    s_mov_b32 exec_hi, 0
    buffer_store_dword v11, v10, s[36:39], s70 offen sc1
    s_mov_b64 exec, -1
    v_mfma_f32_32x32x16_bf16 v[112:127], v[148:151], v[144:147], v[112:127]
    v_mfma_f32_32x32x16_bf16 v[128:143], v[152:155], v[144:147], v[128:143]
    v_mfma_f32_32x32x16_bf16 v[112:127], v[160:163], v[156:159], v[112:127]
    v_mfma_f32_32x32x16_bf16 v[128:143], v[164:167], v[156:159], v[128:143]
    v_mfma_f32_32x32x16_bf16 v[112:127], v[172:175], v[168:171], v[112:127]
    v_mfma_f32_32x32x16_bf16 v[128:143], v[176:179], v[168:171], v[128:143]
    v_mfma_f32_32x32x16_bf16 v[112:127], v[184:187], v[180:183], v[112:127]
    v_mfma_f32_32x32x16_bf16 v[128:143], v[188:191], v[180:183], v[128:143]
    buffer_load_dwordx4 v[32:35], v9, s[28:31], s64 offen
    buffer_load_dwordx4 v[36:39], v12, s[32:35], s65 offen
    v_mov_b32 v11, 96272
    s_cmp_lg_u32 s26, 7
    s_cbranch_scc1 L_k2_go2
    v_lshlrev_b32 v12, 7, v1
    s_mov_b32 s55, 0x40000
L_k2_wait:
    s_sleep 2
    buffer_load_dword v13, v12, s[36:39], s69 offen sc1
    s_waitcnt vmcnt(0)
    v_cmp_ne_u32 vcc, s100, v13
    s_sub_u32 s55, s55, 1
    s_cselect_b32 s49, 0, -1
    s_or_b32 s48, vcc_lo, vcc_hi
    s_and_b32 s48, s48, s49
    v_mov_b32 v13, s48
    ds_write_b32 v11, v13
    s_cmp_lg_u32 s48, 0
    s_cbranch_scc1 L_k2_wait
L_k2_go2:
    s_lshl_b32 s48, s62, 3
    s_lshl_b32 s48, 0xff, s48
L_k2_lw:
    ds_read_b32 v13, v11
    s_waitcnt vmcnt(0) lgkmcnt(0)
    v_readfirstlane_b32 s66, v13
    s_sleep 1
    s_and_b32 s66, s66, s48
    s_cbranch_scc1 L_k2_lw
    buffer_load_dwordx4 v[144:147], v2, s[36:39], s68 offen offset:0 sc1
    buffer_load_dwordx4 v[148:151], v2, s[36:39], s68 offen offset:1024 sc1
    buffer_load_dwordx4 v[152:155], v2, s[36:39], s68 offen offset:2048 sc1
    buffer_load_dwordx4 v[156:159], v2, s[36:39], s68 offen offset:3072 sc1
    s_add_u32 s68, s68, 4096
    buffer_load_dwordx4 v[160:163], v2, s[36:39], s68 offen offset:0 sc1
    buffer_load_dwordx4 v[164:167], v2, s[36:39], s68 offen offset:1024 sc1
    buffer_load_dwordx4 v[168:171], v2, s[36:39], s68 offen offset:2048 sc1
    buffer_load_dwordx4 v[172:175], v2, s[36:39], s68 offen offset:3072 sc1
    v_lshlrev_b32 v40, 16, v32
    v_lshlrev_b32 v10, 16, v36
    v_add_f32 v40, v40, v10
    v_and_b32 v41, 0xffff0000, v32
    v_and_b32 v10, 0xffff0000, v36
    v_add_f32 v41, v41, v10
    v_lshlrev_b32 v42, 16, v33
    v_lshlrev_b32 v10, 16, v37
    v_add_f32 v42, v42, v10
    v_and_b32 v43, 0xffff0000, v33
    v_and_b32 v10, 0xffff0000, v37
    v_add_f32 v43, v43, v10
    v_lshlrev_b32 v44, 16, v34
    v_lshlrev_b32 v10, 16, v38
    v_add_f32 v44, v44, v10
    v_and_b32 v45, 0xffff0000, v34
    v_and_b32 v10, 0xffff0000, v38
    v_add_f32 v45, v45, v10
    v_lshlrev_b32 v46, 16, v35
    v_lshlrev_b32 v10, 16, v39
    v_add_f32 v46, v46, v10
    v_and_b32 v47, 0xffff0000, v35
    v_and_b32 v10, 0xffff0000, v39
    v_add_f32 v47, v47, v10
    v_xor_b32 v16, 0, v6
    v_xor_b32 v17, 32, v6
    v_xor_b32 v18, 64, v6
    v_xor_b32 v19, 96, v6
    v_xor_b32 v20, 128, v6
    v_xor_b32 v21, 160, v6
    v_xor_b32 v22, 192, v6
    v_xor_b32 v23, 224, v6
    s_waitcnt vmcnt(7)
    v_mfma_f32_32x32x16_bf16 v[112:127], v[192:195], v[144:147], v[112:127]
    v_mfma_f32_32x32x16_bf16 v[128:143], v[224:227], v[144:147], v[128:143]
    s_waitcnt vmcnt(6)
    v_mfma_f32_32x32x16_bf16 v[112:127], v[196:199], v[148:151], v[112:127]
    v_mfma_f32_32x32x16_bf16 v[128:143], v[228:231], v[148:151], v[128:143]
    s_waitcnt vmcnt(5)
    v_mfma_f32_32x32x16_bf16 v[112:127], v[200:203], v[152:155], v[112:127]
    v_mfma_f32_32x32x16_bf16 v[128:143], v[232:235], v[152:155], v[128:143]
    s_waitcnt vmcnt(4)
    v_mfma_f32_32x32x16_bf16 v[112:127], v[204:207], v[156:159], v[112:127]
    v_mfma_f32_32x32x16_bf16 v[128:143], v[236:239], v[156:159], v[128:143]
    s_waitcnt vmcnt(3)
    v_mfma_f32_32x32x16_bf16 v[112:127], v[208:211], v[160:163], v[112:127]
    v_mfma_f32_32x32x16_bf16 v[128:143], v[240:243], v[160:163], v[128:143]
    s_waitcnt vmcnt(2)
    v_mfma_f32_32x32x16_bf16 v[112:127], v[212:215], v[164:167], v[112:127]
    v_mfma_f32_32x32x16_bf16 v[128:143], v[244:247], v[164:167], v[128:143]
    s_waitcnt vmcnt(1)
    v_mfma_f32_32x32x16_bf16 v[112:127], v[216:219], v[168:171], v[112:127]
    v_mfma_f32_32x32x16_bf16 v[128:143], v[248:251], v[168:171], v[128:143]
    s_waitcnt vmcnt(0)
    v_mfma_f32_32x32x16_bf16 v[112:127], v[220:223], v[172:175], v[112:127]
    v_mfma_f32_32x32x16_bf16 v[128:143], v[252:255], v[172:175], v[128:143]
    s_nop 10
    ds_write_b128 v16, v[112:115] offset:0
    ds_write_b128 v17, v[116:119] offset:1024
    ds_write_b128 v18, v[120:123] offset:2048
    ds_write_b128 v19, v[124:127] offset:3072
    ds_write_b128 v20, v[128:131] offset:4096
    ds_write_b128 v21, v[132:135] offset:5120
    ds_write_b128 v22, v[136:139] offset:6144
    ds_write_b128 v23, v[140:143] offset:7168
    s_waitcnt lgkmcnt(0)
    s_barrier
    ds_read_b128 v[48:51], v8 offset:0
    ds_read_b128 v[52:55], v8 offset:512
    ds_read_b128 v[56:59], v8 offset:16384
    ds_read_b128 v[60:63], v8 offset:16896
    ds_read_b128 v[64:67], v8 offset:32768
    ds_read_b128 v[68:71], v8 offset:33280
    ds_read_b128 v[72:75], v8 offset:49152
    ds_read_b128 v[76:79], v8 offset:49664
    s_waitcnt lgkmcnt(0)
    v_add_f32 v48, v48, v56
    v_add_f32 v64, v64, v72
    v_add_f32 v49, v49, v57
    v_add_f32 v65, v65, v73
    v_add_f32 v50, v50, v58
    v_add_f32 v66, v66, v74
    v_add_f32 v51, v51, v59
    v_add_f32 v67, v67, v75
    v_add_f32 v52, v52, v60
    v_add_f32 v68, v68, v76
    v_add_f32 v53, v53, v61
    v_add_f32 v69, v69, v77
    v_add_f32 v54, v54, v62
    v_add_f32 v70, v70, v78
    v_add_f32 v55, v55, v63
    v_add_f32 v71, v71, v79
    v_add_f32 v48, v48, v40
    v_add_f32 v49, v49, v41
    v_add_f32 v50, v50, v42
    v_add_f32 v51, v51, v43
    v_add_f32 v52, v52, v44
    v_add_f32 v53, v53, v45
    v_add_f32 v54, v54, v46
    v_add_f32 v55, v55, v47
    v_add_f32 v48, v48, v64
    v_add_f32 v49, v49, v65
    v_add_f32 v50, v50, v66
    v_add_f32 v51, v51, v67
    v_add_f32 v52, v52, v68
    v_add_f32 v53, v53, v69
    v_add_f32 v54, v54, v70
    v_add_f32 v55, v55, v71
    v_cvt_pk_bf16_f32 v56, v48, v49
    v_cvt_pk_bf16_f32 v57, v50, v51
    v_cvt_pk_bf16_f32 v58, v52, v53
    v_cvt_pk_bf16_f32 v59, v54, v55
    buffer_store_dwordx4 v[56:59], v9, s[40:43], s64 offen
    s_endpgm
L_k2_slow:
    v_mov_b32 v11, 0xff800000
    s_add_u32 s48, s59, 2097152
    s_mov_b32 s55, 64
L_k2_p1:
    buffer_load_dwordx4 v[24:27], v2, s[36:39], s48 offen sc1
    s_add_u32 s48, s48, 1024
    s_waitcnt vmcnt(0) lgkmcnt(0)
    v_mfma_f32_32x32x16_bf16 v[48:63], v[24:27], v[16:19], 0
    s_nop 11
    v_max3_f32 v11, v48, v49, v11
    v_max3_f32 v11, v50, v51, v11
    v_max3_f32 v11, v52, v53, v11
    v_max3_f32 v11, v54, v55, v11
    v_max3_f32 v11, v56, v57, v11
    v_max3_f32 v11, v58, v59, v11
    v_max3_f32 v11, v60, v61, v11
    v_max3_f32 v11, v62, v63, v11
    s_sub_u32 s55, s55, 1
    s_cmp_lg_u32 s55, 0
    s_cbranch_scc1 L_k2_p1
    v_mov_b32 v12, v11
    s_nop 1
    v_permlane32_swap_b32 v11, v12
    v_max_f32 v11, v11, v12
    v_sub_f32 v64, 0, v11
    v_mov_b32 v80, 0
    v_sub_f32 v65, 0, v11
    v_mov_b32 v81, 0
    v_sub_f32 v66, 0, v11
    v_mov_b32 v82, 0
    v_sub_f32 v67, 0, v11
    v_mov_b32 v83, 0
    v_sub_f32 v68, 0, v11
    v_mov_b32 v84, 0
    v_sub_f32 v69, 0, v11
    v_mov_b32 v85, 0
    v_sub_f32 v70, 0, v11
    v_mov_b32 v86, 0
    v_sub_f32 v71, 0, v11
    v_mov_b32 v87, 0
    v_sub_f32 v72, 0, v11
    v_mov_b32 v88, 0
    v_sub_f32 v73, 0, v11
    v_mov_b32 v89, 0
    v_sub_f32 v74, 0, v11
    v_mov_b32 v90, 0
    v_sub_f32 v75, 0, v11
    v_mov_b32 v91, 0
    v_sub_f32 v76, 0, v11
    v_mov_b32 v92, 0
    v_sub_f32 v77, 0, v11
    v_mov_b32 v93, 0
    v_sub_f32 v78, 0, v11
    v_mov_b32 v94, 0
    v_sub_f32 v79, 0, v11
    v_mov_b32 v95, 0
    v_and_b32 v13, 0x1ff, v6
    s_add_u32 s48, s59, 2097152
    s_add_u32 s49, s59, 4194304
    s_mov_b32 s55, 64
L_k2_p2:
    buffer_load_dwordx4 v[24:27], v2, s[36:39], s48 offen sc1
    s_mov_b64 exec, s[52:53]
    buffer_load_dwordx4 v[32:35], v13, s[36:39], s49 offen sc1
    buffer_load_dwordx4 v[36:39], v13, s[36:39], s49 offen offset:512 sc1
    s_mov_b64 exec, -1
    s_add_u32 s48, s48, 1024
    s_add_u32 s49, s49, 1024
    s_waitcnt vmcnt(0) lgkmcnt(0)
    v_mfma_f32_32x32x16_bf16 v[48:63], v[24:27], v[16:19], v[64:79]
    s_nop 11
    v_exp_f32 v48, v48
    v_exp_f32 v49, v49
    v_exp_f32 v50, v50
    v_exp_f32 v51, v51
    v_exp_f32 v52, v52
    v_exp_f32 v53, v53
    v_exp_f32 v54, v54
    v_exp_f32 v55, v55
    v_exp_f32 v56, v56
    v_exp_f32 v57, v57
    v_exp_f32 v58, v58
    v_exp_f32 v59, v59
    v_exp_f32 v60, v60
    v_exp_f32 v61, v61
    v_exp_f32 v62, v62
    v_exp_f32 v63, v63
    v_smfmac_f32_32x32x32_bf16 v[80:95], v[32:35], v[48:55], v3
    s_nop 0
    v_smfmac_f32_32x32x32_bf16 v[80:95], v[36:39], v[56:63], v3
    s_nop 15
    s_sub_u32 s55, s55, 1
    s_cmp_lg_u32 s55, 0
    s_cbranch_scc1 L_k2_p2
    v_rcp_f32 v10, v88
    s_branch L_k2_fin
L_k1_end:
    s_endpgm
L_code_end:
.section .rodata,"a"
.p2align 6
.amdhsa_kernel parallel_sum__softmax_full_mha__dense_activation_gelu__prompt_kernel
  .amdhsa_next_free_vgpr 256
  .amdhsa_next_free_sgpr 102
  .amdhsa_accum_offset 256
  .amdhsa_group_segment_fixed_size 0
  .amdhsa_kernarg_size 88
  .amdhsa_user_sgpr_count 2
  .amdhsa_user_sgpr_kernarg_segment_ptr 1
  .amdhsa_system_sgpr_workgroup_id_x 1
.end_amdhsa_kernel
```
